```python
import torch

def _softmax(x, axis=-1):
    return torch.softmax(x, dim=axis)
def _gelu(x):
    return torch.nn.functional.gelu(x, approximate="tanh")
def _silu(x):
    return torch.nn.functional.silu(x)
def _sigmoid(x):
    return torch.sigmoid(x)
def _layernorm(x, axis=-1, eps=1e-5):
    m = x.mean(dim=axis, keepdim=True)
    v = x.var(dim=axis, keepdim=True, unbiased=False)
    return (x - m) / torch.sqrt(v + eps)
def _scatter_add(tgt, idx, src, axis=0):
    return tgt.clone().index_add_(axis, idx, src)
def _segment_sum(src, seg, n):
    out = torch.zeros((n,) + src.shape[1:], dtype=src.dtype)
    return out.index_add_(0, seg, src)
def _pad(x, pw):
    flat = tuple(v for pair in reversed(pw) for v in pair)
    return torch.nn.functional.pad(x, flat)

kernel_name = 'standalone__mha_block_cached__near_ridge'

def setup_inputs():

    _w = (lambda a: (lambda t: t.to(torch.bfloat16) if t.is_floating_point() else t)(torch.as_tensor(a)))
    B, Sq, D = 32, 208, 512
    H, Sk, Dh = 32, 512, 128
    return {
        "x": _w((lambda *s: torch.randn(*s, dtype=torch.bfloat16) * 0.8)(B, Sq, D)),
        "k_cache": _w((lambda *s: torch.randn(*s, dtype=torch.bfloat16) * 0.8)(B, H, Sk, Dh)),
        "v_cache": _w((lambda *s: torch.randn(*s, dtype=torch.bfloat16) * 0.05)(B, H, Sk, Dh)),
        "wq": _w((lambda *s: torch.randn(*s, dtype=torch.bfloat16) * 0.8)(D, H * Dh) * (D ** -0.5)),
        "wo": _w((lambda *s: torch.randn(*s, dtype=torch.bfloat16) * 0.05)(H * Dh, D) * ((H * Dh) ** -0.5)),
    }

def reference(x, k_cache, v_cache, wq, wo):
    B, Sq, D = x.shape
    H, Dh = 32, 128
    q = (lambda x, *d: x.permute(*d))((x @ wq).reshape(B, Sq, H, Dh), 0, 2, 1, 3)
    scores = torch.einsum("bhqd,bhkd->bhqk", q, k_cache) * (Dh ** -0.5)
    p = _softmax(scores, axis=-1)
    o = torch.einsum("bhqk,bhkd->bhqd", p, v_cache)
    return (lambda x, *d: x.permute(*d))(o, 0, 2, 1, 3).reshape(B, Sq, H * Dh) @ wo
```

```asm
; @launch grid=(256,1,1) block=(256,1,1) lds=163840
.amdgcn_target "amdgcn-amd-amdhsa--gfx950"
.text
.globl standalone__mha_block_cached__near_ridge_kernel
.p2align 8
.type standalone__mha_block_cached__near_ridge_kernel,@function
standalone__mha_block_cached__near_ridge_kernel:
    s_cmp_ge_u32 s2, 256
    s_cbranch_scc1 L_exit
    s_load_dwordx4 s[4:7], s[0:1], 0
    s_load_dwordx4 s[72:75], s[0:1], 16
    s_load_dwordx2 s[76:77], s[0:1], 32
    s_load_dwordx2 s[78:79], s[0:1], 56
    s_load_dwordx4 s[68:71], s[0:1], 40
    s_and_b32 s80, s2, 7
    s_lshr_b32 s81, s2, 3
    s_and_b32 s39, s81, 7
    s_lshr_b32 s83, s81, 3
    s_lshl_b32 s83, s83, 3
    s_or_b32 s38, s83, s80
    s_getpc_b64 s[82:83]
L_pc:
    s_lshr_b32 s80, s2, 3
    s_and_b32 s80, s80, 31
    s_lshl_b32 s80, s80, 11
    v_lshlrev_b32 v8, 3, v0
    v_add_u32 v8, s80, v8
    v_min_u32 v8, L_code_end-L_pc-8, v8
    global_load_dwordx2 a[254:255], v8, s[82:83]
    v_lshrrev_b32 v1, 6, v0
    v_and_b32 v2, 63, v0
    v_readfirstlane_b32 s36, v1
    s_waitcnt lgkmcnt(0)
    s_mul_i32 s80, s38, 212992
    s_add_u32 s96, s4, s80
    s_addc_u32 s97, s5, 0
    s_mov_b32 s98, 212992
    s_mov_b32 s99, 0x20000
    s_lshl_b32 s81, s39, 10
    s_add_u32 s12, s74, s81
    s_addc_u32 s13, s75, 0
    s_sub_u32 s14, 0x400000, s81
    s_mov_b32 s15, 0x20000
    s_mov_b32 s32, s12
    s_mov_b32 s33, s13
    s_mov_b32 s34, s14
    s_mov_b32 s35, 0x20000
    s_lshl_b32 s41, s36, 12
    s_lshr_b32 s80, s36, 1
    s_lshl_b32 s80, s80, 18
    s_and_b32 s81, s36, 1
    s_lshl_b32 s81, s81, 15
    s_add_u32 s42, s80, s81
    s_add_u32 s58, s42, 256
    s_mov_b32 s44, 0x100000
    s_mov_b32 s63, 0x100000
    s_mov_b32 s60, 0x80000
    s_mov_b32 s45, 64512
    s_add_u32 s43, s42, s60
    s_lshl_b32 s59, s36, 14
    v_and_b32 v3, 15, v2
    v_lshrrev_b32 v4, 4, v2
    v_lshrrev_b32 v5, 2, v3
    v_and_b32 v6, 3, v3
    v_lshlrev_b32 v7, 1, v4
    v_xor_b32 v7, v7, v3
    v_lshlrev_b32 v7, 4, v7
    v_xor_b32 v8, 128, v7
    v_lshl_add_u32 v247, v4, 8, v7
    v_lshl_add_u32 v248, v4, 8, v8
    v_lshl_add_u32 v249, v4, 13, v7
    v_lshl_add_u32 v250, v4, 13, v8
    v_lshl_add_u32 v9, v4, 10, v7
    v_lshl_add_u32 v10, v4, 10, v8
    v_accvgpr_write_b32 a252, v9
    v_accvgpr_write_b32 a253, v10
    v_accvgpr_read_b32 v120, a252
    v_accvgpr_read_b32 v121, a253
    s_mul_i32 s64, s36, 49152
    s_add_u32 m0, s41, 0
    s_nop 0
    buffer_load_dwordx4 v249, s[32:35], s42 offen offset:0 lds
    s_add_u32 s47, s42, s45
    buffer_load_dwordx4 v250, s[32:35], s47 offen offset:1024 lds
    s_add_u32 s48, s47, s45
    buffer_load_dwordx4 v249, s[32:35], s48 offen offset:2048 lds
    s_add_u32 s49, s48, s45
    buffer_load_dwordx4 v250, s[32:35], s49 offen offset:3072 lds
    s_add_u32 s42, s42, s44
    s_add_u32 m0, s41, 65536
    s_nop 0
    buffer_load_dwordx4 v249, s[32:35], s43 offen offset:0 lds
    s_add_u32 s47, s43, s45
    buffer_load_dwordx4 v250, s[32:35], s47 offen offset:1024 lds
    s_add_u32 s48, s47, s45
    buffer_load_dwordx4 v249, s[32:35], s48 offen offset:2048 lds
    s_add_u32 s49, s48, s45
    buffer_load_dwordx4 v250, s[32:35], s49 offen offset:3072 lds
    s_add_u32 s43, s43, s44
    s_add_u32 m0, s41, 49152
    s_add_u32 s80, s64, 0
    buffer_load_dwordx4 v120, s[96:99], s80 offen offset:0 lds
    s_add_u32 s81, s64, 3072
    buffer_load_dwordx4 v121, s[96:99], s81 offen offset:1024 lds
    s_add_u32 s82, s64, 6144
    buffer_load_dwordx4 v120, s[96:99], s82 offen offset:2048 lds
    s_add_u32 s83, s64, 9216
    buffer_load_dwordx4 v121, s[96:99], s83 offen offset:3072 lds
    s_add_u32 m0, s41, 114688
    s_add_u32 s80, s64, 16384
    buffer_load_dwordx4 v120, s[96:99], s80 offen offset:0 lds
    s_add_u32 s81, s64, 19456
    buffer_load_dwordx4 v121, s[96:99], s81 offen offset:1024 lds
    s_add_u32 s82, s64, 22528
    buffer_load_dwordx4 v120, s[96:99], s82 offen offset:2048 lds
    s_add_u32 s83, s64, 25600
    buffer_load_dwordx4 v121, s[96:99], s83 offen offset:3072 lds
    s_add_u32 m0, s41, 147456
    s_add_u32 s80, s64, 32768
    buffer_load_dwordx4 v120, s[96:99], s80 offen offset:0 lds
    s_add_u32 s81, s64, 35840
    buffer_load_dwordx4 v121, s[96:99], s81 offen offset:1024 lds
    s_add_u32 s82, s64, 38912
    buffer_load_dwordx4 v120, s[96:99], s82 offen offset:2048 lds
    s_add_u32 s83, s64, 41984
    buffer_load_dwordx4 v121, s[96:99], s83 offen offset:3072 lds
    v_add_u32 v66, 192, v3
    v_lshlrev_b32 v66, 10, v66
    v_lshl_add_u32 v66, v4, 4, v66
    s_lshl_b32 s80, s36, 2
    s_add_u32 s80, s80, 0
    s_lshl_b32 s81, s80, 6
    s_lshl_b32 s80, s80, 10
    s_add_u32 m0, s80, 131072
    s_nop 0
    buffer_load_dwordx4 v66, s[96:99], s81 offen offset:0 lds
    s_lshl_b32 s80, s36, 2
    s_add_u32 s80, s80, 1
    s_lshl_b32 s81, s80, 6
    s_lshl_b32 s80, s80, 10
    s_add_u32 m0, s80, 131072
    s_nop 0
    buffer_load_dwordx4 v66, s[96:99], s81 offen offset:0 lds
    s_lshl_b32 s80, s36, 2
    s_add_u32 s80, s80, 2
    s_lshl_b32 s81, s80, 6
    s_lshl_b32 s80, s80, 10
    s_add_u32 m0, s80, 131072
    s_nop 0
    buffer_load_dwordx4 v66, s[96:99], s81 offen offset:0 lds
    s_lshl_b32 s80, s36, 2
    s_add_u32 s80, s80, 3
    s_lshl_b32 s81, s80, 6
    s_lshl_b32 s80, s80, 10
    s_add_u32 m0, s80, 131072
    s_nop 0
    buffer_load_dwordx4 v66, s[96:99], s81 offen offset:0 lds
    s_add_u32 m0, s41, 32768
    s_add_u32 s80, s64, 256
    buffer_load_dwordx4 v120, s[96:99], s80 offen offset:0 lds
    s_add_u32 s81, s64, 3328
    buffer_load_dwordx4 v121, s[96:99], s81 offen offset:1024 lds
    s_add_u32 s82, s64, 6400
    buffer_load_dwordx4 v120, s[96:99], s82 offen offset:2048 lds
    s_add_u32 s83, s64, 9472
    buffer_load_dwordx4 v121, s[96:99], s83 offen offset:3072 lds
    s_add_u32 m0, s41, 98304
    s_add_u32 s80, s64, 16640
    buffer_load_dwordx4 v120, s[96:99], s80 offen offset:0 lds
    s_add_u32 s81, s64, 19712
    buffer_load_dwordx4 v121, s[96:99], s81 offen offset:1024 lds
    s_add_u32 s82, s64, 22784
    buffer_load_dwordx4 v120, s[96:99], s82 offen offset:2048 lds
    s_add_u32 s83, s64, 25856
    buffer_load_dwordx4 v121, s[96:99], s83 offen offset:3072 lds
    s_add_u32 m0, s41, 16384
    s_nop 0
    buffer_load_dwordx4 v249, s[32:35], s42 offen offset:0 lds
    s_add_u32 s47, s42, s45
    buffer_load_dwordx4 v250, s[32:35], s47 offen offset:1024 lds
    s_add_u32 s48, s47, s45
    buffer_load_dwordx4 v249, s[32:35], s48 offen offset:2048 lds
    s_add_u32 s49, s48, s45
    buffer_load_dwordx4 v250, s[32:35], s49 offen offset:3072 lds
    s_add_u32 s42, s42, s63
    s_add_u32 m0, s41, 81920
    s_nop 0
    buffer_load_dwordx4 v249, s[32:35], s43 offen offset:0 lds
    s_add_u32 s47, s43, s45
    buffer_load_dwordx4 v250, s[32:35], s47 offen offset:1024 lds
    s_add_u32 s48, s47, s45
    buffer_load_dwordx4 v249, s[32:35], s48 offen offset:2048 lds
    s_add_u32 s49, s48, s45
    buffer_load_dwordx4 v250, s[32:35], s49 offen offset:3072 lds
    s_add_u32 s43, s43, s63
    s_mul_i32 s80, s38, 212992
    s_add_u32 s80, s80, 0x3800000
    s_add_u32 s8, s78, s80
    s_addc_u32 s9, s79, 0
    s_mov_b32 s10, 212992
    s_mov_b32 s11, 0x20000
    s_mov_b32 s92, 4096
    s_mov_b32 s93, 8192
    s_mov_b32 s94, 12288
    s_lshl_b32 s80, s38, 3
    s_add_u32 s80, s80, s39
    s_lshl_b32 s81, s80, 19
    s_lshr_b32 s82, s80, 13
    s_add_u32 s20, s6, s81
    s_addc_u32 s21, s7, s82
    s_mov_b32 s22, 0x80000
    s_mov_b32 s23, 0x20000
    s_add_u32 s24, s72, s81
    s_addc_u32 s25, s73, s82
    s_mov_b32 s26, 0x80000
    s_mov_b32 s27, 0x20000
    s_mul_i32 s81, s38, 1835008
    s_add_u32 s28, s78, s81
    s_addc_u32 s29, s79, 0
    s_mov_b32 s30, 1835008
    s_mov_b32 s31, 0x20000
    s_lshl_b32 s81, s39, 19
    s_add_u32 s16, s76, s81
    s_addc_u32 s17, s77, 0
    s_mov_b32 s18, 0x80000
    s_mov_b32 s19, 0x20000
    s_mul_i32 s80, s38, 212992
    s_add_u32 s72, s68, s80
    s_addc_u32 s73, s69, 0
    s_mov_b32 s74, 212992
    s_mov_b32 s75, 0x20000
    s_mov_b32 s4, s70
    s_mov_b32 s5, s71
    s_mov_b32 s6, 256
    s_mov_b32 s7, 0x20000
    s_mov_b32 s40, s41
    s_mov_b32 s37, 0
    s_mov_b32 s54, 0x3e0293ee
    s_mov_b32 s50, 0xffff0000
    s_mov_b32 s51, 0x0000ffff
    s_mov_b32 s89, 0x1000
    s_mov_b32 s55, 24576
    s_mov_b32 s61, 0x30800000
    s_mov_b32 s62, 0x4e800000
    v_and_b32 v7, 7, v3
    v_lshlrev_b32 v7, 1, v7
    s_xor_b32 s80, s36, 0
    s_lshl_b32 s80, s80, 2
    v_add_u32 v8, s80, v4
    v_xor_b32 v8, v8, v7
    v_lshlrev_b32 v8, 4, v8
    v_lshl_add_u32 v228, v3, 8, v8
    v_add_u32 v232, s41, v228
    s_xor_b32 s80, s36, 1
    s_lshl_b32 s80, s80, 2
    v_add_u32 v8, s80, v4
    v_xor_b32 v8, v8, v7
    v_lshlrev_b32 v8, 4, v8
    v_lshl_add_u32 v229, v3, 8, v8
    v_add_u32 v233, s41, v229
    s_xor_b32 s80, s36, 2
    s_lshl_b32 s80, s80, 2
    v_add_u32 v8, s80, v4
    v_xor_b32 v8, v8, v7
    v_lshlrev_b32 v8, 4, v8
    v_lshl_add_u32 v230, v3, 8, v8
    v_add_u32 v234, s41, v230
    s_xor_b32 s80, s36, 3
    s_lshl_b32 s80, s80, 2
    v_add_u32 v8, s80, v4
    v_xor_b32 v8, v8, v7
    v_lshlrev_b32 v8, 4, v8
    v_lshl_add_u32 v231, v3, 8, v8
    v_add_u32 v235, s41, v231
    v_lshl_add_u32 v7, v4, 2, v5
    v_and_b32 v8, 7, v7
    v_lshlrev_b32 v9, 8, v7
    v_lshl_add_u32 v9, v6, 3, v9
    v_add_u32 v9, 0x10000, v9
    s_lshl_b32 s81, s36, 1
    s_xor_b32 s80, s81, 0
    v_xor_b32 v10, s80, v8
    v_lshl_add_u32 v236, v10, 5, v9
    s_xor_b32 s80, s81, 1
    v_xor_b32 v10, s80, v8
    v_lshl_add_u32 v237, v10, 5, v9
    s_xor_b32 s80, s81, 2
    v_xor_b32 v10, s80, v8
    v_lshl_add_u32 v238, v10, 5, v9
    s_xor_b32 s80, s81, 3
    v_xor_b32 v10, s80, v8
    v_lshl_add_u32 v239, v10, 5, v9
    s_xor_b32 s80, s81, 4
    v_xor_b32 v10, s80, v8
    v_lshl_add_u32 v240, v10, 5, v9
    s_xor_b32 s80, s81, 5
    v_xor_b32 v10, s80, v8
    v_lshl_add_u32 v241, v10, 5, v9
    s_xor_b32 s80, s81, 6
    v_xor_b32 v10, s80, v8
    v_lshl_add_u32 v242, v10, 5, v9
    s_xor_b32 s80, s81, 7
    v_xor_b32 v10, s80, v8
    v_lshl_add_u32 v243, v10, 5, v9
    v_lshrrev_b32 v7, 1, v6
    v_and_b32 v8, 1, v6
    v_xor_b32 v9, v7, v8
    v_lshlrev_b32 v10, 3, v6
    v_lshlrev_b32 v11, 4, v8
    v_xor_b32 v12, 0, v9
    v_lshl_add_u32 v12, v12, 3, v11
    v_xor_b32 v12, v12, v10
    v_xor_b32 v13, 0, v7
    v_lshlrev_b32 v13, 5, v13
    v_xor_b32 v12, v12, v13
    v_xor_b32 v254, 0x10000, v12
    v_xor_b32 v12, 1, v9
    v_lshl_add_u32 v12, v12, 3, v11
    v_xor_b32 v12, v12, v10
    v_xor_b32 v13, 1, v7
    v_lshlrev_b32 v13, 5, v13
    v_xor_b32 v12, v12, v13
    v_xor_b32 v255, 0x10000, v12
    v_xor_b32 v236, v254, v236
    v_xor_b32 v237, v255, v237
    v_xor_b32 v238, v254, v238
    v_xor_b32 v239, v255, v239
    v_xor_b32 v240, v254, v240
    v_xor_b32 v241, v255, v241
    v_xor_b32 v242, v254, v242
    v_xor_b32 v243, v255, v243
    v_lshlrev_b32 v7, 4, v2
    v_add_u32 v244, 131072, v7
    s_lshl_b32 s80, s36, 10
    v_add_u32 v245, s80, v244
    s_lshr_b32 s80, s36, 1
    s_lshl_b32 s80, s80, 10
    s_and_b32 s81, s36, 1
    s_lshl_b32 s81, s81, 3
    s_add_u32 s80, s80, s81
    s_add_u32 s80, s80, 16384
    v_add_u32 v246, s80, v244
    v_add_u32 v41, s41, v244
    s_mul_i32 s80, s36, 49152
    v_lshlrev_b32 v7, 4, v2
    v_add_u32 v251, s80, v7
    v_add_u32 v252, 0x4000, v251
    v_add_u32 v253, 0x8000, v251
    v_add_u32 v204, 0x30000, v7
    s_lshl_b32 s80, s38, 10
    s_add_u32 s80, s80, 0x3f00000
    s_add_u32 s0, s78, s80
    s_addc_u32 s1, s79, 0
    s_mov_b32 s2, 1024
    s_mov_b32 s3, 0x20000
    v_mov_b32 v7, 0x3f803f80
    v_accvgpr_write_b32 a248, v7
    v_accvgpr_write_b32 a249, v7
    v_accvgpr_write_b32 a250, v7
    v_accvgpr_write_b32 a251, v7
    s_nop 4
    v_mov_b32 v63, 0
    v_mov_b32 v64, 0x1000
    s_lshl_b32 s80, s39, 2
    v_mov_b32 v65, s80
    v_cmp_eq_u32 vcc, 0, v0
    s_nop 1
    v_cndmask_b32 v64, v64, v65, vcc
    v_lshl_add_u32 v66, v0, 7, v65
    v_mov_b32 v64, 0x1000
    v_cmp_gt_u32 s[82:83], 8, v0
    s_nop 1
    v_cndmask_b32 v64, v64, v66, s[82:83]
    buffer_store_dword v63, v64, s[0:3], 0 offen offset:0 sc1
    v_and_b32 v7, 7, v3
    v_lshlrev_b32 v7, 1, v7
    v_lshlrev_b32 v8, 8, v3
    v_add_u32 v8, s41, v8
    s_and_b32 s82, s39, 3
    s_lshl_b32 s83, s82, 2
    v_add_u32 v9, 0, v4
    v_xor_b32 v9, v9, v7
    v_lshl_add_u32 v104, v9, 4, v8
    v_add_u32 v108, 0x10000, v104
    v_add_u32 v112, 0x20000, v104
    v_add_u32 v9, 4, v4
    v_xor_b32 v9, v9, v7
    v_lshl_add_u32 v105, v9, 4, v8
    v_add_u32 v109, 0x10000, v105
    v_add_u32 v113, 0x20000, v105
    v_add_u32 v9, 8, v4
    v_xor_b32 v9, v9, v7
    v_lshl_add_u32 v106, v9, 4, v8
    v_add_u32 v110, 0x10000, v106
    v_add_u32 v114, 0x20000, v106
    v_add_u32 v9, 12, v4
    v_xor_b32 v9, v9, v7
    v_lshl_add_u32 v107, v9, 4, v8
    v_add_u32 v111, 0x10000, v107
    v_add_u32 v115, 0x20000, v107
    v_add_u32 v9, s83, v4
    v_xor_b32 v9, v9, v7
    v_lshl_add_u32 v116, v9, 4, v8
    v_add_u32 v117, 0x10000, v116
    v_add_u32 v118, 0x20000, v116
    v_lshlrev_b32 v122, 4, v2
    s_lshl_b32 s82, s82, 10
    s_add_u32 s82, s82, s64
    s_lshr_b32 s83, s39, 2
    s_add_u32 s81, s82, 0
    s_cmp_eq_u32 s83, 0
    s_cselect_b32 s65, s81, 0x40000000
    s_add_u32 s81, s82, 4096
    s_cmp_eq_u32 s83, 1
    s_cselect_b32 s66, s81, 0x40000000
    s_add_u32 s81, s82, 8192
    s_cmp_eq_u32 s83, 0
    s_cselect_b32 s67, s81, 0x40000000
    s_add_u32 s81, s82, 12288
    s_cmp_eq_u32 s83, 1
    s_cselect_b32 s68, s81, 0x40000000
    s_lshl_b32 s80, s38, 3
    s_add_u32 s80, s80, s39
    v_mov_b32 v65, s80
    v_mov_b32 v201, 0x1000
    v_cndmask_b32 v201, v201, v65, vcc
    v_mov_b32 v200, 1
    s_waitcnt vmcnt(29)
    ds_read_b128 a[144:147], v104 offset:49152
    ds_read_b128 a[156:159], v105 offset:49152
    ds_read_b128 a[168:171], v106 offset:49152
    ds_read_b128 a[180:183], v107 offset:49152
    ds_read_b128 v[124:127], v116 offset:49152
    s_add_u32 s95, s65, 0
    s_waitcnt lgkmcnt(0)
    buffer_store_dwordx4 v[124:127], v122, s[8:11], s95 offen offset:0 sc1
    s_waitcnt vmcnt(26)
    ds_read_b128 a[148:151], v108 offset:49152
    ds_read_b128 a[160:163], v109 offset:49152
    ds_read_b128 a[172:175], v110 offset:49152
    ds_read_b128 a[184:187], v111 offset:49152
    ds_read_b128 v[128:131], v117 offset:49152
    s_add_u32 s95, s65, 16384
    s_waitcnt lgkmcnt(0)
    buffer_store_dwordx4 v[128:131], v122, s[8:11], s95 offen offset:0 sc1
    s_waitcnt vmcnt(23)
    ds_read_b128 a[152:155], v112 offset:16384
    ds_read_b128 a[164:167], v113 offset:16384
    ds_read_b128 a[176:179], v114 offset:16384
    ds_read_b128 a[188:191], v115 offset:16384
    ds_read_b128 v[132:135], v118 offset:16384
    s_add_u32 s95, s65, 32768
    s_waitcnt lgkmcnt(0)
    buffer_store_dwordx4 v[132:135], v122, s[8:11], s95 offen offset:0 sc1
    s_waitcnt vmcnt(16)
    ds_read_b128 a[0:3], v104 offset:32768
    ds_read_b128 a[12:15], v105 offset:32768
    ds_read_b128 a[24:27], v106 offset:32768
    ds_read_b128 a[36:39], v107 offset:32768
    ds_read_b128 v[136:139], v116 offset:32768
    s_add_u32 s95, s66, 0
    s_waitcnt lgkmcnt(0)
    buffer_store_dwordx4 v[136:139], v122, s[8:11], s95 offen offset:0 sc1
    s_waitcnt vmcnt(13)
    ds_read_b128 a[4:7], v108 offset:32768
    ds_read_b128 a[16:19], v109 offset:32768
    ds_read_b128 a[28:31], v110 offset:32768
    ds_read_b128 a[40:43], v111 offset:32768
    ds_read_b128 v[140:143], v117 offset:32768
    s_add_u32 s95, s66, 16384
    s_waitcnt lgkmcnt(0)
    buffer_store_dwordx4 v[140:143], v122, s[8:11], s95 offen offset:0 sc1
    s_add_u32 m0, s41, 147456
    s_add_u32 s80, s64, 33024
    buffer_load_dwordx4 v120, s[96:99], s80 offen offset:0 lds
    s_add_u32 s81, s64, 36096
    buffer_load_dwordx4 v121, s[96:99], s81 offen offset:1024 lds
    s_add_u32 s82, s64, 39168
    buffer_load_dwordx4 v120, s[96:99], s82 offen offset:2048 lds
    s_add_u32 s83, s64, 42240
    buffer_load_dwordx4 v121, s[96:99], s83 offen offset:3072 lds
    s_add_u32 m0, s41, 49152
    s_add_u32 s80, s64, 512
    buffer_load_dwordx4 v120, s[96:99], s80 offen offset:0 lds
    s_add_u32 s81, s64, 3584
    buffer_load_dwordx4 v121, s[96:99], s81 offen offset:1024 lds
    s_add_u32 s82, s64, 6656
    buffer_load_dwordx4 v120, s[96:99], s82 offen offset:2048 lds
    s_add_u32 s83, s64, 9728
    buffer_load_dwordx4 v121, s[96:99], s83 offen offset:3072 lds
    s_add_u32 m0, s41, 114688
    s_add_u32 s80, s64, 16896
    buffer_load_dwordx4 v120, s[96:99], s80 offen offset:0 lds
    s_add_u32 s81, s64, 19968
    buffer_load_dwordx4 v121, s[96:99], s81 offen offset:1024 lds
    s_add_u32 s82, s64, 23040
    buffer_load_dwordx4 v120, s[96:99], s82 offen offset:2048 lds
    s_add_u32 s83, s64, 26112
    buffer_load_dwordx4 v121, s[96:99], s83 offen offset:3072 lds
    s_barrier
    ds_read_b64_tr_b16 a[208:209], v236 offset:0
    ds_read_b64_tr_b16 a[210:211], v236 offset:4096
    ds_read_b64_tr_b16 a[212:213], v236 offset:8192
    ds_read_b64_tr_b16 a[214:215], v236 offset:12288
    v_xor_b32 v236, 0x10000, v236
    ds_read_b64_tr_b16 a[216:217], v236 offset:0
    ds_read_b64_tr_b16 a[218:219], v236 offset:4096
    ds_read_b64_tr_b16 a[220:221], v236 offset:8192
    ds_read_b64_tr_b16 a[222:223], v236 offset:12288
    ds_read_b128 v[212:215], v244 offset:0
    ds_read_b128 v[216:219], v244 offset:1024
    ds_read_b128 v[220:223], v244 offset:2048
    ds_read_b128 v[224:227], v244 offset:3072
    ds_read_b64_tr_b16 a[224:225], v237 offset:0
    ds_read_b64_tr_b16 a[226:227], v237 offset:4096
    ds_read_b64_tr_b16 a[228:229], v237 offset:8192
    ds_read_b64_tr_b16 a[230:231], v237 offset:12288
    v_xor_b32 v237, 0x10000, v237
    s_waitcnt lgkmcnt(14)
    v_mfma_f32_16x16x32_bf16 v[0:3], a[208:211], a[144:147], 0
    s_waitcnt lgkmcnt(12)
    ds_read_b64_tr_b16 a[232:233], v237 offset:0
    v_mfma_f32_16x16x32_bf16 v[0:3], a[212:215], a[156:159], v[0:3]
    s_waitcnt lgkmcnt(11)
    s_add_u32 m0, s41, 32768
    ds_read_b64_tr_b16 a[234:235], v237 offset:4096
    v_mfma_f32_16x16x32_bf16 v[0:3], a[216:219], a[168:171], v[0:3]
    s_waitcnt lgkmcnt(10)
    buffer_load_dwordx4 v249, s[32:35], s42 offen offset:0 lds
    v_mfma_f32_16x16x32_bf16 v[0:3], a[220:223], a[180:183], v[0:3]
    s_mov_b32 s89, 0
    ds_read_b64_tr_b16 a[236:237], v237 offset:8192
    v_mfma_f32_16x16x32_bf16 v[4:7], a[208:211], a[148:151], 0
    ds_read_b64_tr_b16 a[238:239], v237 offset:12288
    v_mfma_f32_16x16x32_bf16 v[4:7], a[212:215], a[160:163], v[4:7]
    s_add_u32 s47, s42, s45
    buffer_load_dwordx4 v250, s[32:35], s47 offen offset:1024 lds
    v_mfma_f32_16x16x32_bf16 v[4:7], a[216:219], a[172:175], v[4:7]
    v_mfma_f32_16x16x32_bf16 v[4:7], a[220:223], a[184:187], v[4:7]
    v_mfma_f32_16x16x32_bf16 v[8:11], a[208:211], a[152:155], 0
    v_mfma_f32_16x16x32_bf16 v[8:11], a[212:215], a[164:167], v[8:11]
    s_add_u32 s48, s47, s45
    buffer_load_dwordx4 v249, s[32:35], s48 offen offset:2048 lds
    v_mfma_f32_16x16x32_bf16 v[8:11], a[216:219], a[176:179], v[8:11]
    v_mfma_f32_16x16x32_bf16 v[8:11], a[220:223], a[188:191], v[8:11]
    s_waitcnt lgkmcnt(11)
    v_mfma_f32_16x16x32_bf16 v[96:99], a[208:211], v[212:215], 0
    s_waitcnt lgkmcnt(10)
    ds_read_b64_tr_b16 a[208:209], v238 offset:0
    v_mfma_f32_16x16x32_bf16 v[96:99], a[212:215], v[216:219], v[96:99]
    s_waitcnt lgkmcnt(10)
    s_add_u32 s49, s48, s45
    ds_read_b64_tr_b16 a[210:211], v238 offset:4096
    v_mfma_f32_16x16x32_bf16 v[96:99], a[216:219], v[220:223], v[96:99]
    s_waitcnt lgkmcnt(10)
    buffer_load_dwordx4 v250, s[32:35], s49 offen offset:3072 lds
    v_mfma_f32_16x16x32_bf16 v[96:99], a[220:223], v[224:227], v[96:99]
    s_waitcnt lgkmcnt(8)
    s_add_u32 s42, s42, s44
    ds_read_b64_tr_b16 a[212:213], v238 offset:8192
    v_mfma_f32_16x16x32_bf16 v[12:15], a[224:227], a[144:147], 0
    s_waitcnt lgkmcnt(7)
    ds_read_b64_tr_b16 a[214:215], v238 offset:12288
    v_xor_b32 v238, 0x10000, v238
    v_mfma_f32_16x16x32_bf16 v[12:15], a[228:231], a[156:159], v[12:15]
    s_waitcnt lgkmcnt(6)
    ds_read_b64_tr_b16 a[216:217], v238 offset:0
    v_mfma_f32_16x16x32_bf16 v[12:15], a[232:235], a[168:171], v[12:15]
    s_waitcnt lgkmcnt(5)
    ds_read_b64_tr_b16 a[218:219], v238 offset:4096
    v_mfma_f32_16x16x32_bf16 v[12:15], a[236:239], a[180:183], v[12:15]
    s_add_u32 m0, s41, 98304
    ds_read_b64_tr_b16 a[220:221], v238 offset:8192
    v_mfma_f32_16x16x32_bf16 v[16:19], a[224:227], a[148:151], 0
    buffer_load_dwordx4 v249, s[32:35], s43 offen offset:0 lds
    v_mfma_f32_16x16x32_bf16 v[16:19], a[228:231], a[160:163], v[16:19]
    ds_read_b64_tr_b16 a[222:223], v238 offset:12288
    v_mfma_f32_16x16x32_bf16 v[16:19], a[232:235], a[172:175], v[16:19]
    v_mfma_f32_16x16x32_bf16 v[16:19], a[236:239], a[184:187], v[16:19]
    s_add_u32 s47, s43, s45
    buffer_load_dwordx4 v250, s[32:35], s47 offen offset:1024 lds
    v_mfma_f32_16x16x32_bf16 v[20:23], a[224:227], a[152:155], 0
    v_mfma_f32_16x16x32_bf16 v[20:23], a[228:231], a[164:167], v[20:23]
    v_mfma_f32_16x16x32_bf16 v[20:23], a[232:235], a[176:179], v[20:23]
    v_mfma_f32_16x16x32_bf16 v[20:23], a[236:239], a[188:191], v[20:23]
    s_add_u32 s48, s47, s45
    buffer_load_dwordx4 v249, s[32:35], s48 offen offset:2048 lds
    v_mfma_f32_16x16x32_bf16 v[100:103], a[224:227], v[212:215], 0
    ds_read_b64_tr_b16 a[224:225], v239 offset:0
    v_mfma_f32_16x16x32_bf16 v[100:103], a[228:231], v[216:219], v[100:103]
    ds_read_b64_tr_b16 a[226:227], v239 offset:4096
    v_mfma_f32_16x16x32_bf16 v[100:103], a[232:235], v[220:223], v[100:103]
    ds_read_b64_tr_b16 a[228:229], v239 offset:8192
    v_mfma_f32_16x16x32_bf16 v[100:103], a[236:239], v[224:227], v[100:103]
    s_waitcnt lgkmcnt(9)
    s_add_u32 s49, s48, s45
    ds_read_b64_tr_b16 a[230:231], v239 offset:12288
    v_mfma_f32_16x16x32_bf16 v[24:27], a[208:211], a[144:147], 0
    s_waitcnt lgkmcnt(8)
    buffer_load_dwordx4 v250, s[32:35], s49 offen offset:3072 lds
    v_xor_b32 v239, 0x10000, v239
    v_mfma_f32_16x16x32_bf16 v[24:27], a[212:215], a[156:159], v[24:27]
    s_waitcnt lgkmcnt(6)
    ds_read_b64_tr_b16 a[232:233], v239 offset:0
    v_mfma_f32_16x16x32_bf16 v[24:27], a[216:219], a[168:171], v[24:27]
    s_waitcnt lgkmcnt(5)
    ds_read_b64_tr_b16 a[234:235], v239 offset:4096
    v_mfma_f32_16x16x32_bf16 v[24:27], a[220:223], a[180:183], v[24:27]
    s_add_u32 s43, s43, s44
    ds_read_b64_tr_b16 a[236:237], v239 offset:8192
    v_mfma_f32_16x16x32_bf16 v[28:31], a[208:211], a[148:151], 0
    ds_read_b64_tr_b16 a[238:239], v239 offset:12288
    v_mfma_f32_16x16x32_bf16 v[28:31], a[212:215], a[160:163], v[28:31]
    ds_read_b128 v[220:223], v244 offset:6144
    v_mfma_f32_16x16x32_bf16 v[28:31], a[216:219], a[172:175], v[28:31]
    ds_read_b128 v[224:227], v244 offset:7168
    v_mfma_f32_16x16x32_bf16 v[28:31], a[220:223], a[184:187], v[28:31]
    ds_read_b128 v[212:215], v244 offset:4096
    v_mfma_f32_16x16x32_bf16 v[32:35], a[208:211], a[152:155], 0
    ds_read_b64_tr_b16 a[208:209], v240 offset:0
    v_mfma_f32_16x16x32_bf16 v[32:35], a[212:215], a[164:167], v[32:35]
    ds_read_b64_tr_b16 a[210:211], v240 offset:4096
    v_mfma_f32_16x16x32_bf16 v[32:35], a[216:219], a[176:179], v[32:35]
    ds_read_b64_tr_b16 a[212:213], v240 offset:8192
    v_mfma_f32_16x16x32_bf16 v[32:35], a[220:223], a[188:191], v[32:35]
    s_waitcnt lgkmcnt(12)
    ds_read_b64_tr_b16 a[214:215], v240 offset:12288
    v_xor_b32 v240, 0x10000, v240
    v_mfma_f32_16x16x32_bf16 v[36:39], a[224:227], a[144:147], 0
    s_waitcnt lgkmcnt(11)
    ds_read_b64_tr_b16 a[216:217], v240 offset:0
    v_mfma_f32_16x16x32_bf16 v[36:39], a[228:231], a[156:159], v[36:39]
    s_waitcnt lgkmcnt(10)
    ds_read_b64_tr_b16 a[218:219], v240 offset:4096
    v_mfma_f32_16x16x32_bf16 v[36:39], a[232:235], a[168:171], v[36:39]
    s_waitcnt lgkmcnt(9)
    ds_read_b64_tr_b16 a[220:221], v240 offset:8192
    v_mfma_f32_16x16x32_bf16 v[36:39], a[236:239], a[180:183], v[36:39]
    ds_read_b64_tr_b16 a[222:223], v240 offset:12288
    v_mfma_f32_16x16x32_bf16 v[40:43], a[224:227], a[148:151], 0
    ds_read_b128 v[216:219], v244 offset:5120
    v_mfma_f32_16x16x32_bf16 v[40:43], a[228:231], a[160:163], v[40:43]
    v_mfma_f32_16x16x32_bf16 v[40:43], a[232:235], a[172:175], v[40:43]
    v_mfma_f32_16x16x32_bf16 v[40:43], a[236:239], a[184:187], v[40:43]
    s_add_u32 s95, s66, 32768
    s_waitcnt vmcnt(16)
    ds_read_b128 v[144:147], v118 offset:16384
    v_mfma_f32_16x16x32_bf16 v[44:47], a[224:227], a[152:155], 0
    ds_read_b128 a[8:11], v112 offset:16384
    v_mfma_f32_16x16x32_bf16 v[44:47], a[228:231], a[164:167], v[44:47]
    v_mfma_f32_16x16x32_bf16 v[44:47], a[232:235], a[176:179], v[44:47]
    v_mfma_f32_16x16x32_bf16 v[44:47], a[236:239], a[188:191], v[44:47]
    s_waitcnt lgkmcnt(9)
    ds_read_b128 a[20:23], v113 offset:16384
    v_mfma_f32_16x16x32_bf16 v[48:51], a[208:211], a[144:147], 0
    s_waitcnt lgkmcnt(8)
    ds_read_b128 a[32:35], v114 offset:16384
    v_mfma_f32_16x16x32_bf16 v[48:51], a[212:215], a[156:159], v[48:51]
    s_waitcnt lgkmcnt(7)
    s_waitcnt vmcnt(12)
    ds_read_b128 v[124:127], v116 offset:49152
    v_mfma_f32_16x16x32_bf16 v[48:51], a[216:219], a[168:171], v[48:51]
    s_waitcnt lgkmcnt(6)
    ds_read_b128 a[44:47], v115 offset:16384
    v_mfma_f32_16x16x32_bf16 v[48:51], a[220:223], a[180:183], v[48:51]
    ds_read_b64_tr_b16 a[224:225], v241 offset:0
    v_mfma_f32_16x16x32_bf16 v[52:55], a[208:211], a[148:151], 0
    ds_read_b64_tr_b16 a[226:227], v241 offset:4096
    v_mfma_f32_16x16x32_bf16 v[52:55], a[212:215], a[160:163], v[52:55]
    ds_read_b64_tr_b16 a[228:229], v241 offset:8192
    v_mfma_f32_16x16x32_bf16 v[52:55], a[216:219], a[172:175], v[52:55]
    ds_read_b64_tr_b16 a[230:231], v241 offset:12288
    v_xor_b32 v241, 0x10000, v241
    v_mfma_f32_16x16x32_bf16 v[52:55], a[220:223], a[184:187], v[52:55]
    s_waitcnt vmcnt(8)
    ds_read_b128 v[128:131], v117 offset:49152
    v_mfma_f32_16x16x32_bf16 v[56:59], a[208:211], a[152:155], 0
    ds_read_b64_tr_b16 a[232:233], v241 offset:0
    v_mfma_f32_16x16x32_bf16 v[56:59], a[212:215], a[164:167], v[56:59]
    ds_read_b64_tr_b16 a[234:235], v241 offset:4096
    v_mfma_f32_16x16x32_bf16 v[56:59], a[216:219], a[176:179], v[56:59]
    s_waitcnt lgkmcnt(12)
    buffer_store_dwordx4 v[144:147], v122, s[8:11], s95 offen offset:0 sc1
    v_mfma_f32_16x16x32_bf16 v[56:59], a[220:223], a[188:191], v[56:59]
    s_waitcnt lgkmcnt(5)
    s_add_u32 s95, s67, 0
    ds_read_b64_tr_b16 a[236:237], v241 offset:8192
    v_mfma_f32_16x16x32_bf16 v[60:63], a[224:227], a[144:147], 0
    s_waitcnt lgkmcnt(4)
    ds_read_b64_tr_b16 a[238:239], v241 offset:12288
    v_mfma_f32_16x16x32_bf16 v[60:63], a[228:231], a[156:159], v[60:63]
    s_waitcnt lgkmcnt(2)
    buffer_store_dwordx4 v[124:127], v122, s[8:11], s95 offen offset:0 sc1
    v_mfma_f32_16x16x32_bf16 v[60:63], a[232:235], a[168:171], v[60:63]
    s_waitcnt lgkmcnt(0)
    s_add_u32 s95, s67, 16384
    ds_read_b128 a[48:51], v104 offset:49152
    s_add_u32 m0, s41, 147456
    buffer_store_dwordx4 v[128:131], v122, s[8:11], s95 offen offset:0 sc1
    v_mfma_f32_16x16x32_bf16 v[60:63], a[236:239], a[180:183], v[60:63]
    s_add_u32 s80, s64, 33280
    buffer_load_dwordx4 v120, s[96:99], s80 offen offset:0 lds
    ds_read_b128 a[60:63], v105 offset:49152
    v_mfma_f32_16x16x32_bf16 v[64:67], a[224:227], a[148:151], 0
    s_add_u32 s81, s64, 36352
    buffer_load_dwordx4 v121, s[96:99], s81 offen offset:1024 lds
    ds_read_b128 a[72:75], v106 offset:49152
    v_mfma_f32_16x16x32_bf16 v[64:67], a[228:231], a[160:163], v[64:67]
    s_add_u32 s82, s64, 39424
    buffer_load_dwordx4 v120, s[96:99], s82 offen offset:2048 lds
    ds_read_b128 a[84:87], v107 offset:49152
    v_mfma_f32_16x16x32_bf16 v[64:67], a[232:235], a[172:175], v[64:67]
    s_add_u32 s83, s64, 42496
    ds_read_b64_tr_b16 a[208:209], v242 offset:0
    ds_read_b64_tr_b16 a[210:211], v242 offset:4096
    v_mfma_f32_16x16x32_bf16 v[64:67], a[236:239], a[184:187], v[64:67]
    ds_read_b64_tr_b16 a[212:213], v242 offset:8192
    v_mfma_f32_16x16x32_bf16 v[68:71], a[224:227], a[152:155], 0
    ds_read_b64_tr_b16 a[214:215], v242 offset:12288
    v_xor_b32 v242, 0x10000, v242
    v_mfma_f32_16x16x32_bf16 v[68:71], a[228:231], a[164:167], v[68:71]
    buffer_load_dwordx4 v121, s[96:99], s83 offen offset:3072 lds
    v_mfma_f32_16x16x32_bf16 v[68:71], a[232:235], a[176:179], v[68:71]
    s_add_u32 m0, s41, 49152
    ds_read_b64_tr_b16 a[216:217], v242 offset:0
    ds_read_b64_tr_b16 a[218:219], v242 offset:4096
    v_mfma_f32_16x16x32_bf16 v[68:71], a[236:239], a[188:191], v[68:71]
    s_waitcnt lgkmcnt(4)
    ds_read_b64_tr_b16 a[220:221], v242 offset:8192
    ds_read_b64_tr_b16 a[222:223], v242 offset:12288
    v_mfma_f32_16x16x32_bf16 v[72:75], a[208:211], a[144:147], 0
    s_waitcnt lgkmcnt(4)
    s_add_u32 s80, s64, 768
    ds_read_b64_tr_b16 a[224:225], v243 offset:0
    v_mfma_f32_16x16x32_bf16 v[72:75], a[212:215], a[156:159], v[72:75]
    s_waitcnt lgkmcnt(3)
    buffer_load_dwordx4 v120, s[96:99], s80 offen offset:0 lds
    ds_read_b64_tr_b16 a[226:227], v243 offset:4096
    s_add_u32 s81, s64, 3840
    buffer_load_dwordx4 v121, s[96:99], s81 offen offset:1024 lds
    s_add_u32 s82, s64, 6912
    buffer_load_dwordx4 v120, s[96:99], s82 offen offset:2048 lds
    v_mfma_f32_16x16x32_bf16 v[72:75], a[216:219], a[168:171], v[72:75]
    s_waitcnt lgkmcnt(2)
    ds_read_b64_tr_b16 a[228:229], v243 offset:8192
    ds_read_b64_tr_b16 a[230:231], v243 offset:12288
    v_mfma_f32_16x16x32_bf16 v[72:75], a[220:223], a[180:183], v[72:75]
    s_add_u32 s83, s64, 9984
    v_xor_b32 v243, 0x10000, v243
    v_mfma_f32_16x16x32_bf16 v[76:79], a[208:211], a[148:151], 0
    ds_read_b128 a[52:55], v108 offset:49152
    v_mfma_f32_16x16x32_bf16 v[76:79], a[212:215], a[160:163], v[76:79]
    ds_read_b128 a[64:67], v109 offset:49152
    v_mfma_f32_16x16x32_bf16 v[76:79], a[216:219], a[172:175], v[76:79]
    ds_read_b128 a[76:79], v110 offset:49152
    v_mfma_f32_16x16x32_bf16 v[76:79], a[220:223], a[184:187], v[76:79]
    ds_read_b128 a[88:91], v111 offset:49152
    v_mfma_f32_16x16x32_bf16 v[80:83], a[208:211], a[152:155], 0
    ds_read_b64_tr_b16 a[232:233], v243 offset:0
    v_mfma_f32_16x16x32_bf16 v[80:83], a[212:215], a[164:167], v[80:83]
    ds_read_b64_tr_b16 a[234:235], v243 offset:4096
    v_mfma_f32_16x16x32_bf16 v[80:83], a[216:219], a[176:179], v[80:83]
    ds_read_b64_tr_b16 a[236:237], v243 offset:8192
    v_mfma_f32_16x16x32_bf16 v[80:83], a[220:223], a[188:191], v[80:83]
    ds_read_b64_tr_b16 a[238:239], v243 offset:12288
    buffer_load_dwordx4 v121, s[96:99], s83 offen offset:3072 lds
    s_add_u32 m0, s41, 114688
    s_add_u32 s80, s64, 17152
    s_waitcnt lgkmcnt(4)
    buffer_load_dwordx4 v120, s[96:99], s80 offen offset:0 lds
    s_add_u32 s81, s64, 20224
    buffer_load_dwordx4 v121, s[96:99], s81 offen offset:1024 lds
    s_add_u32 s82, s64, 23296
    buffer_load_dwordx4 v120, s[96:99], s82 offen offset:2048 lds
    s_waitcnt lgkmcnt(0)
    s_barrier
    v_mfma_f32_16x16x32_bf16 v[84:87], a[224:227], a[144:147], 0
    ds_read_b64_tr_b16 a[216:217], v236 offset:16384
    v_mfma_f32_16x16x32_bf16 v[84:87], a[228:231], a[156:159], v[84:87]
    s_add_u32 s83, s64, 26368
    ds_read_b64_tr_b16 a[218:219], v236 offset:20480
    buffer_load_dwordx4 v121, s[96:99], s83 offen offset:3072 lds
    v_mfma_f32_16x16x32_bf16 v[84:87], a[232:235], a[168:171], v[84:87]
    ds_read_b64_tr_b16 a[220:221], v236 offset:24576
    v_mfma_f32_16x16x32_bf16 v[84:87], a[236:239], a[180:183], v[84:87]
    ds_read_b64_tr_b16 a[222:223], v236 offset:28672
    v_xor_b32 v236, 0x10000, v236
    v_mfma_f32_16x16x32_bf16 v[88:91], a[224:227], a[148:151], 0
    ds_read_b64_tr_b16 a[208:209], v236 offset:16384
    v_mfma_f32_16x16x32_bf16 v[88:91], a[228:231], a[160:163], v[88:91]
    ds_read_b64_tr_b16 a[210:211], v236 offset:20480
    v_mfma_f32_16x16x32_bf16 v[88:91], a[232:235], a[172:175], v[88:91]
    ds_read_b64_tr_b16 a[212:213], v236 offset:24576
    v_mfma_f32_16x16x32_bf16 v[88:91], a[236:239], a[184:187], v[88:91]
    ds_read_b64_tr_b16 a[214:215], v236 offset:28672
    v_mfma_f32_16x16x32_bf16 v[92:95], a[224:227], a[152:155], 0
    v_mfma_f32_16x16x32_bf16 v[92:95], a[228:231], a[164:167], v[92:95]
    v_mfma_f32_16x16x32_bf16 v[92:95], a[232:235], a[176:179], v[92:95]
    ds_read_b64_tr_b16 a[232:233], v237 offset:16384
    v_mfma_f32_16x16x32_bf16 v[92:95], a[236:239], a[188:191], v[92:95]
    s_waitcnt lgkmcnt(7)
    ds_read_b64_tr_b16 a[234:235], v237 offset:20480
    v_mfma_f32_16x16x32_bf16 v[0:3], a[216:219], a[24:27], v[0:3]
    s_waitcnt lgkmcnt(6)
    ds_read_b64_tr_b16 a[236:237], v237 offset:24576
    ds_read_b64_tr_b16 a[238:239], v237 offset:28672
    v_mfma_f32_16x16x32_bf16 v[0:3], a[220:223], a[36:39], v[0:3]
    s_waitcnt lgkmcnt(6)
    v_xor_b32 v237, 0x10000, v237
    v_mfma_f32_16x16x32_bf16 v[0:3], a[208:211], a[0:3], v[0:3]
    s_waitcnt lgkmcnt(4)
    ds_read_b64_tr_b16 a[224:225], v237 offset:16384
    ds_read_b64_tr_b16 a[226:227], v237 offset:20480
    v_mfma_f32_16x16x32_bf16 v[0:3], a[212:215], a[12:15], v[0:3]
    ds_read_b64_tr_b16 a[228:229], v237 offset:24576
    v_mfma_f32_16x16x32_bf16 v[4:7], a[216:219], a[28:31], v[4:7]
    ds_read_b64_tr_b16 a[230:231], v237 offset:28672
    v_mfma_f32_16x16x32_bf16 v[4:7], a[220:223], a[40:43], v[4:7]
    v_mfma_f32_16x16x32_bf16 v[4:7], a[208:211], a[4:7], v[4:7]
    v_mfma_f32_16x16x32_bf16 v[4:7], a[212:215], a[16:19], v[4:7]
    v_mfma_f32_16x16x32_bf16 v[8:11], a[216:219], a[32:35], v[8:11]
    v_mfma_f32_16x16x32_bf16 v[8:11], a[220:223], a[44:47], v[8:11]
    v_mfma_f32_16x16x32_bf16 v[8:11], a[208:211], a[8:11], v[8:11]
    v_mfma_f32_16x16x32_bf16 v[8:11], a[212:215], a[20:23], v[8:11]
    v_mfma_f32_16x16x32_bf16 v[96:99], a[216:219], v[220:223], v[96:99]
    ds_read_b64_tr_b16 a[216:217], v238 offset:16384
    v_mfma_f32_16x16x32_bf16 v[96:99], a[220:223], v[224:227], v[96:99]
    ds_read_b64_tr_b16 a[218:219], v238 offset:20480
    v_mfma_f32_16x16x32_bf16 v[96:99], a[208:211], v[212:215], v[96:99]
    ds_read_b64_tr_b16 a[220:221], v238 offset:24576
    v_mfma_f32_16x16x32_bf16 v[96:99], a[212:215], v[216:219], v[96:99]
    s_waitcnt lgkmcnt(9)
    ds_read_b64_tr_b16 a[222:223], v238 offset:28672
    v_xor_b32 v238, 0x10000, v238
    v_mfma_f32_16x16x32_bf16 v[12:15], a[232:235], a[24:27], v[12:15]
    s_waitcnt lgkmcnt(8)
    ds_read_b64_tr_b16 a[208:209], v238 offset:16384
    v_mfma_f32_16x16x32_bf16 v[12:15], a[236:239], a[36:39], v[12:15]
    s_waitcnt lgkmcnt(7)
    s_add_u32 s46, s40, 0
    ds_read_b64_tr_b16 a[210:211], v238 offset:20480
    v_mfma_f32_16x16x32_bf16 v[12:15], a[224:227], a[0:3], v[12:15]
    s_waitcnt lgkmcnt(6)
    s_add_u32 m0, s41, 0
    ds_read_b64_tr_b16 a[212:213], v238 offset:24576
    v_mfma_f32_16x16x32_bf16 v[12:15], a[228:231], a[12:15], v[12:15]
    buffer_load_dwordx4 v247, s[20:23], s46 offen offset:0 nt lds
    v_mfma_f32_16x16x32_bf16 v[16:19], a[232:235], a[28:31], v[16:19]
    ds_read_b64_tr_b16 a[214:215], v238 offset:28672
    v_mfma_f32_16x16x32_bf16 v[16:19], a[236:239], a[40:43], v[16:19]
    buffer_load_dwordx4 v248, s[20:23], s46 offen offset:1024 nt lds
    v_mfma_f32_16x16x32_bf16 v[16:19], a[224:227], a[4:7], v[16:19]
    v_mfma_f32_16x16x32_bf16 v[16:19], a[228:231], a[16:19], v[16:19]
    v_mfma_f32_16x16x32_bf16 v[20:23], a[232:235], a[32:35], v[20:23]
    v_mfma_f32_16x16x32_bf16 v[20:23], a[236:239], a[44:47], v[20:23]
    buffer_load_dwordx4 v247, s[20:23], s46 offen offset:2048 nt lds
    v_mfma_f32_16x16x32_bf16 v[20:23], a[224:227], a[8:11], v[20:23]
    v_mfma_f32_16x16x32_bf16 v[20:23], a[228:231], a[20:23], v[20:23]
    v_mfma_f32_16x16x32_bf16 v[100:103], a[232:235], v[220:223], v[100:103]
    ds_read_b64_tr_b16 a[232:233], v239 offset:16384
    v_mfma_f32_16x16x32_bf16 v[100:103], a[236:239], v[224:227], v[100:103]
    buffer_load_dwordx4 v248, s[20:23], s46 offen offset:3072 nt lds
    v_mfma_f32_16x16x32_bf16 v[100:103], a[224:227], v[212:215], v[100:103]
    ds_read_b64_tr_b16 a[234:235], v239 offset:20480
    v_mfma_f32_16x16x32_bf16 v[100:103], a[228:231], v[216:219], v[100:103]
    s_waitcnt lgkmcnt(8)
    ds_read_b64_tr_b16 a[236:237], v239 offset:24576
    ds_read_b64_tr_b16 a[238:239], v239 offset:28672
    v_mfma_f32_16x16x32_bf16 v[24:27], a[216:219], a[24:27], v[24:27]
    s_waitcnt lgkmcnt(8)
    v_xor_b32 v239, 0x10000, v239
    v_mfma_f32_16x16x32_bf16 v[24:27], a[220:223], a[36:39], v[24:27]
    s_waitcnt lgkmcnt(6)
    ds_read_b64_tr_b16 a[224:225], v239 offset:16384
    ds_read_b64_tr_b16 a[226:227], v239 offset:20480
    v_mfma_f32_16x16x32_bf16 v[24:27], a[208:211], a[0:3], v[24:27]
    s_waitcnt lgkmcnt(6)
    ds_read_b64_tr_b16 a[228:229], v239 offset:24576
    ds_read_b64_tr_b16 a[230:231], v239 offset:28672
    v_mfma_f32_16x16x32_bf16 v[24:27], a[212:215], a[12:15], v[24:27]
    s_add_u32 s46, s40, 0
    s_add_u32 m0, s41, 65536
    ds_read_b128 v[212:215], v244 offset:8192
    v_mfma_f32_16x16x32_bf16 v[28:31], a[216:219], a[28:31], v[28:31]
    buffer_load_dwordx4 v247, s[24:27], s46 offen offset:0 nt lds
    v_mfma_f32_16x16x32_bf16 v[28:31], a[220:223], a[40:43], v[28:31]
    ds_read_b128 v[216:219], v244 offset:9216
    v_mfma_f32_16x16x32_bf16 v[28:31], a[208:211], a[4:7], v[28:31]
    ds_read_b128 v[220:223], v244 offset:10240
    v_mfma_f32_16x16x32_bf16 v[28:31], a[212:215], a[16:19], v[28:31]
    buffer_load_dwordx4 v248, s[24:27], s46 offen offset:1024 nt lds
    v_mfma_f32_16x16x32_bf16 v[32:35], a[216:219], a[32:35], v[32:35]
    ds_read_b64_tr_b16 a[216:217], v240 offset:16384
    v_mfma_f32_16x16x32_bf16 v[32:35], a[220:223], a[44:47], v[32:35]
    ds_read_b64_tr_b16 a[218:219], v240 offset:20480
    v_mfma_f32_16x16x32_bf16 v[32:35], a[208:211], a[8:11], v[32:35]
    ds_read_b64_tr_b16 a[220:221], v240 offset:24576
    v_mfma_f32_16x16x32_bf16 v[32:35], a[212:215], a[20:23], v[32:35]
    s_waitcnt lgkmcnt(12)
    buffer_load_dwordx4 v247, s[24:27], s46 offen offset:2048 nt lds
    ds_read_b64_tr_b16 a[222:223], v240 offset:28672
    v_mfma_f32_16x16x32_bf16 v[36:39], a[232:235], a[24:27], v[36:39]
    s_waitcnt lgkmcnt(11)
    v_xor_b32 v240, 0x10000, v240
    v_mfma_f32_16x16x32_bf16 v[36:39], a[236:239], a[36:39], v[36:39]
    s_waitcnt lgkmcnt(9)
    ds_read_b64_tr_b16 a[208:209], v240 offset:16384
    ds_read_b64_tr_b16 a[210:211], v240 offset:20480
    v_mfma_f32_16x16x32_bf16 v[36:39], a[224:227], a[0:3], v[36:39]
    s_waitcnt lgkmcnt(9)
    ds_read_b64_tr_b16 a[212:213], v240 offset:24576
    ds_read_b64_tr_b16 a[214:215], v240 offset:28672
    v_mfma_f32_16x16x32_bf16 v[36:39], a[228:231], a[12:15], v[36:39]
    buffer_load_dwordx4 v248, s[24:27], s46 offen offset:3072 nt lds
    v_mfma_f32_16x16x32_bf16 v[40:43], a[232:235], a[28:31], v[40:43]
    ds_read_b128 v[224:227], v244 offset:11264
    v_mfma_f32_16x16x32_bf16 v[40:43], a[236:239], a[40:43], v[40:43]
    v_mfma_f32_16x16x32_bf16 v[40:43], a[224:227], a[4:7], v[40:43]
    v_mfma_f32_16x16x32_bf16 v[40:43], a[228:231], a[16:19], v[40:43]
    v_mfma_f32_16x16x32_bf16 v[44:47], a[232:235], a[32:35], v[44:47]
    ds_read_b64_tr_b16 a[232:233], v241 offset:16384
    v_mfma_f32_16x16x32_bf16 v[44:47], a[236:239], a[44:47], v[44:47]
    ds_read_b64_tr_b16 a[234:235], v241 offset:20480
    v_mfma_f32_16x16x32_bf16 v[44:47], a[224:227], a[8:11], v[44:47]
    v_mfma_f32_16x16x32_bf16 v[44:47], a[228:231], a[20:23], v[44:47]
    s_waitcnt lgkmcnt(9)
    ds_read_b64_tr_b16 a[236:237], v241 offset:24576
    ds_read_b64_tr_b16 a[238:239], v241 offset:28672
    v_mfma_f32_16x16x32_bf16 v[48:51], a[216:219], a[24:27], v[48:51]
    s_waitcnt lgkmcnt(9)
    s_waitcnt vmcnt(16)
    ds_read_b128 v[132:135], v118 offset:16384
    v_mfma_f32_16x16x32_bf16 v[48:51], a[220:223], a[36:39], v[48:51]
    s_waitcnt lgkmcnt(8)
    v_xor_b32 v241, 0x10000, v241
    v_mfma_f32_16x16x32_bf16 v[48:51], a[208:211], a[0:3], v[48:51]
    s_waitcnt lgkmcnt(6)
    ds_read_b128 a[56:59], v112 offset:16384
    ds_read_b128 a[68:71], v113 offset:16384
    v_mfma_f32_16x16x32_bf16 v[48:51], a[212:215], a[12:15], v[48:51]
    s_add_u32 s95, s67, 32768
    ds_read_b128 a[80:83], v114 offset:16384
    ds_read_b128 a[92:95], v115 offset:16384
    v_mfma_f32_16x16x32_bf16 v[52:55], a[216:219], a[28:31], v[52:55]
    ds_read_b64_tr_b16 a[224:225], v241 offset:16384
    v_mfma_f32_16x16x32_bf16 v[52:55], a[220:223], a[40:43], v[52:55]
    ds_read_b64_tr_b16 a[226:227], v241 offset:20480
    v_mfma_f32_16x16x32_bf16 v[52:55], a[208:211], a[4:7], v[52:55]
    ds_read_b64_tr_b16 a[228:229], v241 offset:24576
    v_mfma_f32_16x16x32_bf16 v[52:55], a[212:215], a[16:19], v[52:55]
    s_add_u32 m0, s41, 147456
    ds_read_b64_tr_b16 a[230:231], v241 offset:28672
    v_mfma_f32_16x16x32_bf16 v[56:59], a[216:219], a[32:35], v[56:59]
    s_add_u32 s80, s64, 33536
    s_waitcnt lgkmcnt(8)
    buffer_store_dwordx4 v[132:135], v122, s[8:11], s95 offen offset:0 sc1
    v_mfma_f32_16x16x32_bf16 v[56:59], a[220:223], a[44:47], v[56:59]
    s_waitcnt lgkmcnt(4)
    buffer_load_dwordx4 v120, s[96:99], s80 offen offset:0 lds
    ds_read_b64_tr_b16 a[216:217], v242 offset:16384
    v_mfma_f32_16x16x32_bf16 v[56:59], a[208:211], a[8:11], v[56:59]
    s_add_u32 s81, s64, 36608
    buffer_load_dwordx4 v121, s[96:99], s81 offen offset:1024 lds
    ds_read_b64_tr_b16 a[218:219], v242 offset:20480
    v_mfma_f32_16x16x32_bf16 v[56:59], a[212:215], a[20:23], v[56:59]
    ds_read_b64_tr_b16 a[220:221], v242 offset:24576
    v_mfma_f32_16x16x32_bf16 v[60:63], a[232:235], a[24:27], v[60:63]
    ds_read_b64_tr_b16 a[222:223], v242 offset:28672
    v_xor_b32 v242, 0x10000, v242
    v_mfma_f32_16x16x32_bf16 v[60:63], a[236:239], a[36:39], v[60:63]
    s_waitcnt lgkmcnt(6)
    s_add_u32 s82, s64, 39680
    ds_read_b64_tr_b16 a[208:209], v242 offset:16384
    v_mfma_f32_16x16x32_bf16 v[60:63], a[224:227], a[0:3], v[60:63]
    s_waitcnt lgkmcnt(5)
    buffer_load_dwordx4 v120, s[96:99], s82 offen offset:2048 lds
    ds_read_b64_tr_b16 a[210:211], v242 offset:20480
    v_mfma_f32_16x16x32_bf16 v[60:63], a[228:231], a[12:15], v[60:63]
    ds_read_b64_tr_b16 a[212:213], v242 offset:24576
    v_mfma_f32_16x16x32_bf16 v[64:67], a[232:235], a[28:31], v[64:67]
    s_add_u32 s83, s64, 42752
    ds_read_b64_tr_b16 a[214:215], v242 offset:28672
    buffer_load_dwordx4 v121, s[96:99], s83 offen offset:3072 lds
    v_mfma_f32_16x16x32_bf16 v[64:67], a[236:239], a[40:43], v[64:67]
    v_mfma_f32_16x16x32_bf16 v[64:67], a[224:227], a[4:7], v[64:67]
    v_mfma_f32_16x16x32_bf16 v[64:67], a[228:231], a[16:19], v[64:67]
    v_mfma_f32_16x16x32_bf16 v[68:71], a[232:235], a[32:35], v[68:71]
    ds_read_b64_tr_b16 a[232:233], v243 offset:16384
    v_mfma_f32_16x16x32_bf16 v[68:71], a[236:239], a[44:47], v[68:71]
    s_add_u32 s95, s68, 0
    ds_read_b64_tr_b16 a[234:235], v243 offset:20480
    ds_read_b64_tr_b16 a[236:237], v243 offset:24576
    v_mfma_f32_16x16x32_bf16 v[68:71], a[224:227], a[8:11], v[68:71]
    ds_read_b64_tr_b16 a[238:239], v243 offset:28672
    v_xor_b32 v243, 0x10000, v243
    v_mfma_f32_16x16x32_bf16 v[68:71], a[228:231], a[20:23], v[68:71]
    s_waitcnt lgkmcnt(10)
    s_waitcnt vmcnt(17)
    ds_read_b128 a[96:99], v104 offset:49152
    v_mfma_f32_16x16x32_bf16 v[72:75], a[216:219], a[24:27], v[72:75]
    s_waitcnt lgkmcnt(9)
    ds_read_b128 a[108:111], v105 offset:49152
    ds_read_b128 a[120:123], v106 offset:49152
    v_mfma_f32_16x16x32_bf16 v[72:75], a[220:223], a[36:39], v[72:75]
    s_waitcnt lgkmcnt(9)
    ds_read_b128 a[132:135], v107 offset:49152
    ds_read_b128 v[136:139], v116 offset:49152
    v_mfma_f32_16x16x32_bf16 v[72:75], a[208:211], a[0:3], v[72:75]
    s_waitcnt lgkmcnt(9)
    ds_read_b64_tr_b16 a[224:225], v243 offset:16384
    ds_read_b64_tr_b16 a[226:227], v243 offset:20480
    v_mfma_f32_16x16x32_bf16 v[72:75], a[212:215], a[12:15], v[72:75]
    ds_read_b64_tr_b16 a[228:229], v243 offset:24576
    v_mfma_f32_16x16x32_bf16 v[76:79], a[216:219], a[28:31], v[76:79]
    ds_read_b64_tr_b16 a[230:231], v243 offset:28672
    v_mfma_f32_16x16x32_bf16 v[76:79], a[220:223], a[40:43], v[76:79]
    s_waitcnt vmcnt(13)
    ds_read_b128 a[100:103], v108 offset:49152
    v_mfma_f32_16x16x32_bf16 v[76:79], a[208:211], a[4:7], v[76:79]
    s_waitcnt lgkmcnt(5)
    buffer_store_dwordx4 v[136:139], v122, s[8:11], s95 offen offset:0 sc1
    v_mfma_f32_16x16x32_bf16 v[76:79], a[212:215], a[16:19], v[76:79]
    s_add_u32 s95, s68, 16384
    ds_read_b128 a[112:115], v109 offset:49152
    ds_read_b128 a[124:127], v110 offset:49152
    v_mfma_f32_16x16x32_bf16 v[80:83], a[216:219], a[32:35], v[80:83]
    ds_read_b128 a[136:139], v111 offset:49152
    v_mfma_f32_16x16x32_bf16 v[80:83], a[220:223], a[44:47], v[80:83]
    ds_read_b128 v[140:143], v117 offset:49152
    v_mfma_f32_16x16x32_bf16 v[80:83], a[208:211], a[8:11], v[80:83]
    v_mfma_f32_16x16x32_bf16 v[80:83], a[212:215], a[20:23], v[80:83]
    s_waitcnt lgkmcnt(0)
    s_barrier
    v_mfma_f32_16x16x32_bf16 v[84:87], a[232:235], a[24:27], v[84:87]
    ds_read_b64_tr_b16 a[208:209], v236 offset:32768
    v_mfma_f32_16x16x32_bf16 v[84:87], a[236:239], a[36:39], v[84:87]
    ds_read_b64_tr_b16 a[210:211], v236 offset:36864
    v_mfma_f32_16x16x32_bf16 v[84:87], a[224:227], a[0:3], v[84:87]
    ds_read_b64_tr_b16 a[212:213], v236 offset:40960
    v_mfma_f32_16x16x32_bf16 v[84:87], a[228:231], a[12:15], v[84:87]
    ds_read_b64_tr_b16 a[214:215], v236 offset:45056
    v_xor_b32 v236, 0x10000, v236
    v_mfma_f32_16x16x32_bf16 v[88:91], a[232:235], a[28:31], v[88:91]
    ds_read_b64_tr_b16 a[216:217], v236 offset:32768
    v_mfma_f32_16x16x32_bf16 v[88:91], a[236:239], a[40:43], v[88:91]
    ds_read_b64_tr_b16 a[218:219], v236 offset:36864
    v_mfma_f32_16x16x32_bf16 v[88:91], a[224:227], a[4:7], v[88:91]
    ds_read_b64_tr_b16 a[220:221], v236 offset:40960
    v_mfma_f32_16x16x32_bf16 v[88:91], a[228:231], a[16:19], v[88:91]
    ds_read_b64_tr_b16 a[222:223], v236 offset:45056
    v_mfma_f32_16x16x32_bf16 v[92:95], a[232:235], a[32:35], v[92:95]
    buffer_store_dwordx4 v[140:143], v122, s[8:11], s95 offen offset:0 sc1
    v_mfma_f32_16x16x32_bf16 v[92:95], a[236:239], a[44:47], v[92:95]
    v_mfma_f32_16x16x32_bf16 v[92:95], a[224:227], a[8:11], v[92:95]
    ds_read_b64_tr_b16 a[224:225], v237 offset:32768
    v_mfma_f32_16x16x32_bf16 v[92:95], a[228:231], a[20:23], v[92:95]
    s_waitcnt lgkmcnt(7)
    ds_read_b64_tr_b16 a[226:227], v237 offset:36864
    ds_read_b64_tr_b16 a[228:229], v237 offset:40960
    v_mfma_f32_16x16x32_bf16 v[0:3], a[208:211], a[48:51], v[0:3]
    s_waitcnt lgkmcnt(7)
    ds_read_b64_tr_b16 a[230:231], v237 offset:45056
    v_xor_b32 v237, 0x10000, v237
    v_mfma_f32_16x16x32_bf16 v[0:3], a[212:215], a[60:63], v[0:3]
    s_waitcnt lgkmcnt(6)
    s_add_u32 m0, s41, 49152
    ds_read_b64_tr_b16 a[232:233], v237 offset:32768
    v_mfma_f32_16x16x32_bf16 v[0:3], a[216:219], a[72:75], v[0:3]
    s_waitcnt lgkmcnt(5)
    buffer_load_dwordx4 v249, s[32:35], s42 offen offset:0 lds
    ds_read_b64_tr_b16 a[234:235], v237 offset:36864
    v_mfma_f32_16x16x32_bf16 v[0:3], a[220:223], a[84:87], v[0:3]
    ds_read_b64_tr_b16 a[236:237], v237 offset:40960
    v_mfma_f32_16x16x32_bf16 v[4:7], a[208:211], a[52:55], v[4:7]
    s_add_u32 s47, s42, s45
    buffer_load_dwordx4 v250, s[32:35], s47 offen offset:1024 lds
    ds_read_b64_tr_b16 a[238:239], v237 offset:45056
    v_mfma_f32_16x16x32_bf16 v[4:7], a[212:215], a[64:67], v[4:7]
    v_mfma_f32_16x16x32_bf16 v[4:7], a[216:219], a[76:79], v[4:7]
    v_mfma_f32_16x16x32_bf16 v[4:7], a[220:223], a[88:91], v[4:7]
    s_add_u32 s48, s47, s45
    buffer_load_dwordx4 v249, s[32:35], s48 offen offset:2048 lds
    v_mfma_f32_16x16x32_bf16 v[8:11], a[208:211], a[56:59], v[8:11]
    v_mfma_f32_16x16x32_bf16 v[8:11], a[212:215], a[68:71], v[8:11]
    v_mfma_f32_16x16x32_bf16 v[8:11], a[216:219], a[80:83], v[8:11]
    s_add_u32 s49, s48, s45
    buffer_load_dwordx4 v250, s[32:35], s49 offen offset:3072 lds
    v_mfma_f32_16x16x32_bf16 v[8:11], a[220:223], a[92:95], v[8:11]
    s_add_u32 s42, s42, s63
    v_mfma_f32_16x16x32_bf16 v[96:99], a[208:211], v[212:215], v[96:99]
    ds_read_b64_tr_b16 a[208:209], v238 offset:32768
    v_mfma_f32_16x16x32_bf16 v[96:99], a[212:215], v[216:219], v[96:99]
    ds_read_b64_tr_b16 a[210:211], v238 offset:36864
    v_mfma_f32_16x16x32_bf16 v[96:99], a[216:219], v[220:223], v[96:99]
    ds_read_b64_tr_b16 a[212:213], v238 offset:40960
    v_mfma_f32_16x16x32_bf16 v[96:99], a[220:223], v[224:227], v[96:99]
    s_waitcnt lgkmcnt(9)
    s_add_u32 m0, s41, 114688
    ds_read_b64_tr_b16 a[214:215], v238 offset:45056
    v_mfma_f32_16x16x32_bf16 v[12:15], a[224:227], a[48:51], v[12:15]
    s_waitcnt lgkmcnt(8)
    buffer_load_dwordx4 v249, s[32:35], s43 offen offset:0 lds
    v_xor_b32 v238, 0x10000, v238
    v_mfma_f32_16x16x32_bf16 v[12:15], a[228:231], a[60:63], v[12:15]
    s_waitcnt lgkmcnt(6)
    ds_read_b64_tr_b16 a[216:217], v238 offset:32768
    ds_read_b64_tr_b16 a[218:219], v238 offset:36864
    v_mfma_f32_16x16x32_bf16 v[12:15], a[232:235], a[72:75], v[12:15]
    s_waitcnt lgkmcnt(6)
    s_add_u32 s47, s43, s45
    ds_read_b64_tr_b16 a[220:221], v238 offset:40960
    v_mfma_f32_16x16x32_bf16 v[12:15], a[236:239], a[84:87], v[12:15]
    buffer_load_dwordx4 v250, s[32:35], s47 offen offset:1024 lds
    v_mfma_f32_16x16x32_bf16 v[16:19], a[224:227], a[52:55], v[16:19]
    ds_read_b64_tr_b16 a[222:223], v238 offset:45056
    v_mfma_f32_16x16x32_bf16 v[16:19], a[228:231], a[64:67], v[16:19]
    s_add_u32 s48, s47, s45
    buffer_load_dwordx4 v249, s[32:35], s48 offen offset:2048 lds
    v_mfma_f32_16x16x32_bf16 v[16:19], a[232:235], a[76:79], v[16:19]
    v_mfma_f32_16x16x32_bf16 v[16:19], a[236:239], a[88:91], v[16:19]
    v_mfma_f32_16x16x32_bf16 v[20:23], a[224:227], a[56:59], v[20:23]
    s_add_u32 s49, s48, s45
    buffer_load_dwordx4 v250, s[32:35], s49 offen offset:3072 lds
    v_mfma_f32_16x16x32_bf16 v[20:23], a[228:231], a[68:71], v[20:23]
    s_add_u32 s43, s43, s63
    v_mfma_f32_16x16x32_bf16 v[20:23], a[232:235], a[80:83], v[20:23]
    v_mfma_f32_16x16x32_bf16 v[20:23], a[236:239], a[92:95], v[20:23]
    v_mfma_f32_16x16x32_bf16 v[100:103], a[224:227], v[212:215], v[100:103]
    ds_read_b64_tr_b16 a[224:225], v239 offset:32768
    v_mfma_f32_16x16x32_bf16 v[100:103], a[228:231], v[216:219], v[100:103]
    ds_read_b64_tr_b16 a[226:227], v239 offset:36864
    v_mfma_f32_16x16x32_bf16 v[100:103], a[232:235], v[220:223], v[100:103]
    ds_read_b64_tr_b16 a[228:229], v239 offset:40960
    v_mfma_f32_16x16x32_bf16 v[100:103], a[236:239], v[224:227], v[100:103]
    s_waitcnt lgkmcnt(9)
    ds_read_b64_tr_b16 a[230:231], v239 offset:45056
    v_xor_b32 v239, 0x10000, v239
    v_mfma_f32_16x16x32_bf16 v[24:27], a[208:211], a[48:51], v[24:27]
    s_waitcnt lgkmcnt(8)
    ds_read_b64_tr_b16 a[232:233], v239 offset:32768
    ds_read_b64_tr_b16 a[234:235], v239 offset:36864
    v_mfma_f32_16x16x32_bf16 v[24:27], a[212:215], a[60:63], v[24:27]
    s_waitcnt lgkmcnt(8)
    s_add_u32 s46, s40, 16384
    ds_read_b64_tr_b16 a[236:237], v239 offset:40960
    v_mfma_f32_16x16x32_bf16 v[24:27], a[216:219], a[72:75], v[24:27]
    s_waitcnt lgkmcnt(7)
    s_add_u32 m0, s41, 16384
    ds_read_b64_tr_b16 a[238:239], v239 offset:45056
    v_mfma_f32_16x16x32_bf16 v[24:27], a[220:223], a[84:87], v[24:27]
    buffer_load_dwordx4 v247, s[20:23], s46 offen offset:0 nt lds
    v_mfma_f32_16x16x32_bf16 v[28:31], a[208:211], a[52:55], v[28:31]
    ds_read_b128 v[220:223], v244 offset:14336
    v_mfma_f32_16x16x32_bf16 v[28:31], a[212:215], a[64:67], v[28:31]
    ds_read_b128 v[224:227], v244 offset:15360
    v_mfma_f32_16x16x32_bf16 v[28:31], a[216:219], a[76:79], v[28:31]
    buffer_load_dwordx4 v248, s[20:23], s46 offen offset:1024 nt lds
    v_mfma_f32_16x16x32_bf16 v[28:31], a[220:223], a[88:91], v[28:31]
    ds_read_b128 v[212:215], v244 offset:12288
    v_mfma_f32_16x16x32_bf16 v[32:35], a[208:211], a[56:59], v[32:35]
    ds_read_b64_tr_b16 a[208:209], v240 offset:32768
    v_mfma_f32_16x16x32_bf16 v[32:35], a[212:215], a[68:71], v[32:35]
    ds_read_b64_tr_b16 a[210:211], v240 offset:36864
    v_mfma_f32_16x16x32_bf16 v[32:35], a[216:219], a[80:83], v[32:35]
    ds_read_b64_tr_b16 a[212:213], v240 offset:40960
    v_mfma_f32_16x16x32_bf16 v[32:35], a[220:223], a[92:95], v[32:35]
    s_waitcnt lgkmcnt(12)
    buffer_load_dwordx4 v247, s[20:23], s46 offen offset:2048 nt lds
    ds_read_b64_tr_b16 a[214:215], v240 offset:45056
    v_mfma_f32_16x16x32_bf16 v[36:39], a[224:227], a[48:51], v[36:39]
    s_waitcnt lgkmcnt(11)
    v_xor_b32 v240, 0x10000, v240
    v_mfma_f32_16x16x32_bf16 v[36:39], a[228:231], a[60:63], v[36:39]
    s_waitcnt lgkmcnt(9)
    ds_read_b64_tr_b16 a[216:217], v240 offset:32768
    ds_read_b64_tr_b16 a[218:219], v240 offset:36864
    v_mfma_f32_16x16x32_bf16 v[36:39], a[232:235], a[72:75], v[36:39]
    s_waitcnt lgkmcnt(9)
    ds_read_b64_tr_b16 a[220:221], v240 offset:40960
    ds_read_b64_tr_b16 a[222:223], v240 offset:45056
    v_mfma_f32_16x16x32_bf16 v[36:39], a[236:239], a[84:87], v[36:39]
    ds_read_b128 v[216:219], v244 offset:13312
    v_mfma_f32_16x16x32_bf16 v[40:43], a[224:227], a[52:55], v[40:43]
    buffer_load_dwordx4 v248, s[20:23], s46 offen offset:3072 nt lds
    v_mfma_f32_16x16x32_bf16 v[40:43], a[228:231], a[64:67], v[40:43]
    v_mfma_f32_16x16x32_bf16 v[40:43], a[232:235], a[76:79], v[40:43]
    v_mfma_f32_16x16x32_bf16 v[40:43], a[236:239], a[88:91], v[40:43]
    v_mfma_f32_16x16x32_bf16 v[44:47], a[224:227], a[56:59], v[44:47]
    ds_read_b64_tr_b16 a[224:225], v241 offset:32768
    v_mfma_f32_16x16x32_bf16 v[44:47], a[228:231], a[68:71], v[44:47]
    ds_read_b64_tr_b16 a[226:227], v241 offset:36864
    v_mfma_f32_16x16x32_bf16 v[44:47], a[232:235], a[80:83], v[44:47]
    v_mfma_f32_16x16x32_bf16 v[44:47], a[236:239], a[92:95], v[44:47]
    s_waitcnt lgkmcnt(9)
    s_add_u32 s46, s40, 16384
    ds_read_b64_tr_b16 a[228:229], v241 offset:40960
    v_mfma_f32_16x16x32_bf16 v[48:51], a[208:211], a[48:51], v[48:51]
    s_waitcnt lgkmcnt(8)
    s_add_u32 m0, s41, 81920
    ds_read_b64_tr_b16 a[230:231], v241 offset:45056
    v_mfma_f32_16x16x32_bf16 v[48:51], a[212:215], a[60:63], v[48:51]
    s_waitcnt lgkmcnt(7)
    buffer_load_dwordx4 v247, s[24:27], s46 offen offset:0 nt lds
    v_xor_b32 v241, 0x10000, v241
    v_mfma_f32_16x16x32_bf16 v[48:51], a[216:219], a[72:75], v[48:51]
    s_waitcnt lgkmcnt(5)
    ds_read_b64_tr_b16 a[232:233], v241 offset:32768
    ds_read_b64_tr_b16 a[234:235], v241 offset:36864
    v_mfma_f32_16x16x32_bf16 v[48:51], a[220:223], a[84:87], v[48:51]
    ds_read_b64_tr_b16 a[236:237], v241 offset:40960
    v_mfma_f32_16x16x32_bf16 v[52:55], a[208:211], a[52:55], v[52:55]
    ds_read_b64_tr_b16 a[238:239], v241 offset:45056
    v_mfma_f32_16x16x32_bf16 v[52:55], a[212:215], a[64:67], v[52:55]
    buffer_load_dwordx4 v248, s[24:27], s46 offen offset:1024 nt lds
    v_mfma_f32_16x16x32_bf16 v[52:55], a[216:219], a[76:79], v[52:55]
    v_mfma_f32_16x16x32_bf16 v[52:55], a[220:223], a[88:91], v[52:55]
    v_mfma_f32_16x16x32_bf16 v[56:59], a[208:211], a[56:59], v[56:59]
    ds_read_b64_tr_b16 a[208:209], v242 offset:32768
    v_mfma_f32_16x16x32_bf16 v[56:59], a[212:215], a[68:71], v[56:59]
    buffer_load_dwordx4 v247, s[24:27], s46 offen offset:2048 nt lds
    v_mfma_f32_16x16x32_bf16 v[56:59], a[216:219], a[80:83], v[56:59]
    ds_read_b64_tr_b16 a[210:211], v242 offset:36864
    v_mfma_f32_16x16x32_bf16 v[56:59], a[220:223], a[92:95], v[56:59]
    s_waitcnt lgkmcnt(8)
    ds_read_b64_tr_b16 a[212:213], v242 offset:40960
    ds_read_b64_tr_b16 a[214:215], v242 offset:45056
    v_mfma_f32_16x16x32_bf16 v[60:63], a[224:227], a[48:51], v[60:63]
    s_waitcnt lgkmcnt(8)
    v_xor_b32 v242, 0x10000, v242
    v_mfma_f32_16x16x32_bf16 v[60:63], a[228:231], a[60:63], v[60:63]
    s_waitcnt lgkmcnt(6)
    ds_read_b64_tr_b16 a[216:217], v242 offset:32768
    ds_read_b64_tr_b16 a[218:219], v242 offset:36864
    v_mfma_f32_16x16x32_bf16 v[60:63], a[232:235], a[72:75], v[60:63]
    s_waitcnt lgkmcnt(6)
    ds_read_b64_tr_b16 a[220:221], v242 offset:40960
    ds_read_b64_tr_b16 a[222:223], v242 offset:45056
    v_mfma_f32_16x16x32_bf16 v[60:63], a[236:239], a[84:87], v[60:63]
    s_add_u32 s95, s68, 32768
    buffer_load_dwordx4 v248, s[24:27], s46 offen offset:3072 nt lds
    v_mfma_f32_16x16x32_bf16 v[64:67], a[224:227], a[52:55], v[64:67]
    s_waitcnt vmcnt(18)
    ds_read_b128 a[104:107], v112 offset:16384
    ds_read_b128 a[116:119], v113 offset:16384
    v_mfma_f32_16x16x32_bf16 v[64:67], a[228:231], a[64:67], v[64:67]
    ds_read_b128 a[128:131], v114 offset:16384
    v_mfma_f32_16x16x32_bf16 v[64:67], a[232:235], a[76:79], v[64:67]
    ds_read_b128 a[140:143], v115 offset:16384
    v_mfma_f32_16x16x32_bf16 v[64:67], a[236:239], a[88:91], v[64:67]
    ds_read_b128 v[144:147], v118 offset:16384
    v_mfma_f32_16x16x32_bf16 v[68:71], a[224:227], a[56:59], v[68:71]
    ds_read_b64_tr_b16 a[224:225], v243 offset:32768
    v_mfma_f32_16x16x32_bf16 v[68:71], a[228:231], a[68:71], v[68:71]
    v_mfma_f32_16x16x32_bf16 v[68:71], a[232:235], a[80:83], v[68:71]
    v_mfma_f32_16x16x32_bf16 v[68:71], a[236:239], a[92:95], v[68:71]
    s_waitcnt lgkmcnt(12)
    ds_read_b64_tr_b16 a[226:227], v243 offset:36864
    ds_read_b64_tr_b16 a[228:229], v243 offset:40960
    v_mfma_f32_16x16x32_bf16 v[72:75], a[208:211], a[48:51], v[72:75]
    s_waitcnt lgkmcnt(12)
    ds_read_b64_tr_b16 a[230:231], v243 offset:45056
    v_xor_b32 v243, 0x10000, v243
    v_mfma_f32_16x16x32_bf16 v[72:75], a[212:215], a[60:63], v[72:75]
    s_waitcnt lgkmcnt(11)
    ds_read_b64_tr_b16 a[232:233], v243 offset:32768
    ds_read_b64_tr_b16 a[234:235], v243 offset:36864
    v_mfma_f32_16x16x32_bf16 v[72:75], a[216:219], a[72:75], v[72:75]
    s_waitcnt lgkmcnt(11)
    ds_read_b64_tr_b16 a[236:237], v243 offset:40960
    ds_read_b64_tr_b16 a[238:239], v243 offset:45056
    v_mfma_f32_16x16x32_bf16 v[72:75], a[220:223], a[84:87], v[72:75]
    s_waitcnt lgkmcnt(8)
    buffer_store_dwordx4 v[144:147], v122, s[8:11], s95 offen offset:0 sc1
    v_mfma_f32_16x16x32_bf16 v[76:79], a[208:211], a[52:55], v[76:79]
    v_mfma_f32_16x16x32_bf16 v[76:79], a[212:215], a[64:67], v[76:79]
    v_mfma_f32_16x16x32_bf16 v[76:79], a[216:219], a[76:79], v[76:79]
    v_mfma_f32_16x16x32_bf16 v[76:79], a[220:223], a[88:91], v[76:79]
    v_mfma_f32_16x16x32_bf16 v[80:83], a[208:211], a[56:59], v[80:83]
    v_mfma_f32_16x16x32_bf16 v[80:83], a[212:215], a[68:71], v[80:83]
    v_mfma_f32_16x16x32_bf16 v[80:83], a[216:219], a[80:83], v[80:83]
    v_mfma_f32_16x16x32_bf16 v[80:83], a[220:223], a[92:95], v[80:83]
    s_waitcnt vmcnt(9) lgkmcnt(0)
    s_barrier
    v_mfma_f32_16x16x32_bf16 v[84:87], a[224:227], a[48:51], v[84:87]
    ds_read_b64_tr_b16 a[216:217], v236 offset:49152
    v_mfma_f32_16x16x32_bf16 v[84:87], a[228:231], a[60:63], v[84:87]
    ds_read_b64_tr_b16 a[218:219], v236 offset:53248
    v_mfma_f32_16x16x32_bf16 v[84:87], a[232:235], a[72:75], v[84:87]
    ds_read_b64_tr_b16 a[220:221], v236 offset:57344
    v_mfma_f32_16x16x32_bf16 v[84:87], a[236:239], a[84:87], v[84:87]
    ds_read_b64_tr_b16 a[222:223], v236 offset:61440
    v_xor_b32 v236, 0x10000, v236
    v_mfma_f32_16x16x32_bf16 v[88:91], a[224:227], a[52:55], v[88:91]
    ds_read_b64_tr_b16 a[208:209], v236 offset:49152
    v_mfma_f32_16x16x32_bf16 v[88:91], a[228:231], a[64:67], v[88:91]
    ds_read_b64_tr_b16 a[210:211], v236 offset:53248
    v_mfma_f32_16x16x32_bf16 v[88:91], a[232:235], a[76:79], v[88:91]
    ds_read_b64_tr_b16 a[212:213], v236 offset:57344
    v_mfma_f32_16x16x32_bf16 v[88:91], a[236:239], a[88:91], v[88:91]
    ds_read_b64_tr_b16 a[214:215], v236 offset:61440
    v_mfma_f32_16x16x32_bf16 v[92:95], a[224:227], a[56:59], v[92:95]
    v_mfma_f32_16x16x32_bf16 v[92:95], a[228:231], a[68:71], v[92:95]
    v_mfma_f32_16x16x32_bf16 v[92:95], a[232:235], a[80:83], v[92:95]
    ds_read_b64_tr_b16 a[232:233], v237 offset:49152
    v_mfma_f32_16x16x32_bf16 v[92:95], a[236:239], a[92:95], v[92:95]
    s_waitcnt lgkmcnt(7)
    ds_read_b64_tr_b16 a[234:235], v237 offset:53248
    ds_read_b64_tr_b16 a[236:237], v237 offset:57344
    v_mfma_f32_16x16x32_bf16 v[0:3], a[216:219], a[120:123], v[0:3]
    s_waitcnt lgkmcnt(7)
    ds_read_b64_tr_b16 a[238:239], v237 offset:61440
    v_xor_b32 v237, 0x10000, v237
    v_mfma_f32_16x16x32_bf16 v[0:3], a[220:223], a[132:135], v[0:3]
    s_waitcnt lgkmcnt(6)
    ds_read_b64_tr_b16 a[224:225], v237 offset:49152
    ds_read_b64_tr_b16 a[226:227], v237 offset:53248
    v_mfma_f32_16x16x32_bf16 v[0:3], a[208:211], a[96:99], v[0:3]
    s_waitcnt lgkmcnt(6)
    ds_read_b64_tr_b16 a[228:229], v237 offset:57344
    ds_read_b64_tr_b16 a[230:231], v237 offset:61440
    v_mfma_f32_16x16x32_bf16 v[0:3], a[212:215], a[108:111], v[0:3]
    s_add_u32 s46, s40, 32768
    s_add_u32 m0, s41, 32768
    v_mfma_f32_16x16x32_bf16 v[4:7], a[216:219], a[124:127], v[4:7]
    buffer_load_dwordx4 v247, s[20:23], s46 offen offset:0 nt lds
    v_mfma_f32_16x16x32_bf16 v[4:7], a[220:223], a[136:139], v[4:7]
    v_mfma_f32_16x16x32_bf16 v[4:7], a[208:211], a[100:103], v[4:7]
    v_mfma_f32_16x16x32_bf16 v[4:7], a[212:215], a[112:115], v[4:7]
    v_mfma_f32_16x16x32_bf16 v[8:11], a[216:219], a[128:131], v[8:11]
    v_mul_f32 v0, s54, v0
    v_mul_f32 v1, s54, v1
    v_mfma_f32_16x16x32_bf16 v[8:11], a[220:223], a[140:143], v[8:11]
    buffer_load_dwordx4 v248, s[20:23], s46 offen offset:1024 nt lds
    v_mul_f32 v2, s54, v2
    v_mfma_f32_16x16x32_bf16 v[8:11], a[208:211], a[104:107], v[8:11]
    v_mul_f32 v3, s54, v3
    v_mul_f32 v4, s54, v4
    v_mfma_f32_16x16x32_bf16 v[8:11], a[212:215], a[116:119], v[8:11]
    v_mul_f32 v5, s54, v5
    v_cvt_pk_bf16_f32 v0, v0, v1
    v_mfma_f32_16x16x32_bf16 v[96:99], a[216:219], v[220:223], v[96:99]
    ds_read_b64_tr_b16 a[216:217], v238 offset:49152
    v_mul_f32 v6, s54, v6
    v_mfma_f32_16x16x32_bf16 v[96:99], a[220:223], v[224:227], v[96:99]
    ds_read_b64_tr_b16 a[218:219], v238 offset:53248
    v_mul_f32 v7, s54, v7
    v_mfma_f32_16x16x32_bf16 v[96:99], a[208:211], v[212:215], v[96:99]
    ds_read_b64_tr_b16 a[220:221], v238 offset:57344
    v_mul_f32 v8, s54, v8
    v_mfma_f32_16x16x32_bf16 v[96:99], a[212:215], v[216:219], v[96:99]
    s_waitcnt lgkmcnt(9)
    buffer_load_dwordx4 v247, s[20:23], s46 offen offset:2048 nt lds
    ds_read_b64_tr_b16 a[222:223], v238 offset:61440
    v_mfma_f32_16x16x32_bf16 v[12:15], a[232:235], a[120:123], v[12:15]
    s_waitcnt lgkmcnt(8)
    v_xor_b32 v238, 0x10000, v238
    v_mul_f32 v9, s54, v9
    v_mfma_f32_16x16x32_bf16 v[12:15], a[236:239], a[132:135], v[12:15]
    s_waitcnt lgkmcnt(6)
    ds_read_b64_tr_b16 a[208:209], v238 offset:49152
    ds_read_b64_tr_b16 a[210:211], v238 offset:53248
    v_mfma_f32_16x16x32_bf16 v[12:15], a[224:227], a[96:99], v[12:15]
    s_waitcnt lgkmcnt(6)
    ds_read_b64_tr_b16 a[212:213], v238 offset:57344
    ds_read_b64_tr_b16 a[214:215], v238 offset:61440
    v_mfma_f32_16x16x32_bf16 v[12:15], a[228:231], a[108:111], v[12:15]
    v_mul_f32 v96, s54, v96
    v_mul_f32 v97, s54, v97
    v_mfma_f32_16x16x32_bf16 v[16:19], a[232:235], a[124:127], v[16:19]
    v_mul_f32 v98, s54, v98
    v_mul_f32 v99, s54, v99
    v_mfma_f32_16x16x32_bf16 v[16:19], a[236:239], a[136:139], v[16:19]
    buffer_load_dwordx4 v248, s[20:23], s46 offen offset:3072 nt lds
    v_cvt_pk_bf16_f32 v96, v96, v97
    v_mfma_f32_16x16x32_bf16 v[16:19], a[224:227], a[100:103], v[16:19]
    v_mul_f32 v12, s54, v12
    v_mul_f32 v13, s54, v13
    v_mfma_f32_16x16x32_bf16 v[16:19], a[228:231], a[112:115], v[16:19]
    v_mul_f32 v14, s54, v14
    v_mul_f32 v15, s54, v15
    v_mfma_f32_16x16x32_bf16 v[20:23], a[232:235], a[128:131], v[20:23]
    v_cvt_pk_bf16_f32 v12, v12, v13
    v_cvt_pk_bf16_f32 v4, v4, v5
    v_mfma_f32_16x16x32_bf16 v[20:23], a[236:239], a[140:143], v[20:23]
    v_mul_f32 v10, s54, v10
    v_mul_f32 v11, s54, v11
    v_mfma_f32_16x16x32_bf16 v[20:23], a[224:227], a[104:107], v[20:23]
    v_mul_f32 v16, s54, v16
    v_mul_f32 v17, s54, v17
    v_mfma_f32_16x16x32_bf16 v[20:23], a[228:231], a[116:119], v[20:23]
    v_mul_f32 v18, s54, v18
    v_mul_f32 v19, s54, v19
    v_mfma_f32_16x16x32_bf16 v[100:103], a[232:235], v[220:223], v[100:103]
    ds_read_b64_tr_b16 a[232:233], v239 offset:49152
    v_cvt_pk_bf16_f32 v16, v16, v17
    v_mfma_f32_16x16x32_bf16 v[100:103], a[236:239], v[224:227], v[100:103]
    ds_read_b64_tr_b16 a[234:235], v239 offset:53248
    v_cvt_pk_bf16_f32 v8, v8, v9
    v_mfma_f32_16x16x32_bf16 v[100:103], a[224:227], v[212:215], v[100:103]
    ds_read_b64_tr_b16 a[236:237], v239 offset:57344
    v_mul_f32 v20, s54, v20
    v_mfma_f32_16x16x32_bf16 v[100:103], a[228:231], v[216:219], v[100:103]
    s_waitcnt lgkmcnt(9)
    ds_read_b64_tr_b16 a[238:239], v239 offset:61440
    v_xor_b32 v239, 0x10000, v239
    v_mfma_f32_16x16x32_bf16 v[24:27], a[216:219], a[120:123], v[24:27]
    s_waitcnt lgkmcnt(8)
    ds_read_b64_tr_b16 a[224:225], v239 offset:49152
    ds_read_b64_tr_b16 a[226:227], v239 offset:53248
    v_mfma_f32_16x16x32_bf16 v[24:27], a[220:223], a[132:135], v[24:27]
    s_waitcnt lgkmcnt(8)
    ds_read_b64_tr_b16 a[228:229], v239 offset:57344
    ds_read_b64_tr_b16 a[230:231], v239 offset:61440
    v_mfma_f32_16x16x32_bf16 v[24:27], a[208:211], a[96:99], v[24:27]
    s_waitcnt lgkmcnt(8)
    v_mul_f32 v21, s54, v21
    v_mul_f32 v22, s54, v22
    v_mfma_f32_16x16x32_bf16 v[24:27], a[212:215], a[108:111], v[24:27]
    v_mul_f32 v23, s54, v23
    v_cvt_pk_bf16_f32 v20, v20, v21
    v_mfma_f32_16x16x32_bf16 v[28:31], a[216:219], a[124:127], v[28:31]
    v_mul_f32 v100, s54, v100
    v_mul_f32 v101, s54, v101
    v_mfma_f32_16x16x32_bf16 v[28:31], a[220:223], a[136:139], v[28:31]
    v_mul_f32 v102, s54, v102
    v_mul_f32 v103, s54, v103
    v_mfma_f32_16x16x32_bf16 v[28:31], a[208:211], a[100:103], v[28:31]
    v_mul_f32 v24, s54, v24
    v_mul_f32 v25, s54, v25
    v_mfma_f32_16x16x32_bf16 v[28:31], a[212:215], a[112:115], v[28:31]
    s_add_u32 s46, s40, 32768
    s_add_u32 m0, s41, 98304
    v_cvt_pk_bf16_f32 v97, v98, v99
    v_mfma_f32_16x16x32_bf16 v[32:35], a[216:219], a[128:131], v[32:35]
    buffer_load_dwordx4 v247, s[24:27], s46 offen offset:0 nt lds
    v_mul_f32 v26, s54, v26
    v_mfma_f32_16x16x32_bf16 v[32:35], a[220:223], a[140:143], v[32:35]
    ds_read_b64_tr_b16 a[216:217], v240 offset:49152
    v_mul_f32 v28, s54, v28
    v_mfma_f32_16x16x32_bf16 v[32:35], a[208:211], a[104:107], v[32:35]
    ds_read_b64_tr_b16 a[218:219], v240 offset:53248
    v_mul_f32 v29, s54, v29
    v_mfma_f32_16x16x32_bf16 v[32:35], a[212:215], a[116:119], v[32:35]
    s_waitcnt lgkmcnt(8)
    ds_read_b64_tr_b16 a[220:221], v240 offset:57344
    ds_read_b64_tr_b16 a[222:223], v240 offset:61440
    v_mfma_f32_16x16x32_bf16 v[36:39], a[232:235], a[120:123], v[36:39]
    s_waitcnt lgkmcnt(8)
    v_xor_b32 v240, 0x10000, v240
    v_mul_f32 v27, s54, v27
    v_mfma_f32_16x16x32_bf16 v[36:39], a[236:239], a[132:135], v[36:39]
    s_waitcnt lgkmcnt(6)
    ds_read_b64_tr_b16 a[208:209], v240 offset:49152
    ds_read_b64_tr_b16 a[210:211], v240 offset:53248
    v_mfma_f32_16x16x32_bf16 v[36:39], a[224:227], a[96:99], v[36:39]
    s_waitcnt lgkmcnt(6)
    buffer_load_dwordx4 v248, s[24:27], s46 offen offset:1024 nt lds
    ds_read_b64_tr_b16 a[212:213], v240 offset:57344
    v_mfma_f32_16x16x32_bf16 v[36:39], a[228:231], a[108:111], v[36:39]
    ds_read_b64_tr_b16 a[214:215], v240 offset:61440
    v_mul_f32 v32, s54, v32
    v_mfma_f32_16x16x32_bf16 v[40:43], a[232:235], a[124:127], v[40:43]
    v_mul_f32 v33, s54, v33
    v_cvt_pk_bf16_f32 v24, v24, v25
    v_mfma_f32_16x16x32_bf16 v[40:43], a[236:239], a[136:139], v[40:43]
    v_mul_f32 v30, s54, v30
    v_mul_f32 v31, s54, v31
    v_mfma_f32_16x16x32_bf16 v[40:43], a[224:227], a[100:103], v[40:43]
    v_mul_f32 v36, s54, v36
    v_mul_f32 v37, s54, v37
    v_mfma_f32_16x16x32_bf16 v[40:43], a[228:231], a[112:115], v[40:43]
    buffer_load_dwordx4 v247, s[24:27], s46 offen offset:2048 nt lds
    v_mul_f32 v38, s54, v38
    v_mfma_f32_16x16x32_bf16 v[44:47], a[232:235], a[128:131], v[44:47]
    ds_read_b64_tr_b16 a[232:233], v241 offset:49152
    v_mul_f32 v39, s54, v39
    v_mfma_f32_16x16x32_bf16 v[44:47], a[236:239], a[140:143], v[44:47]
    ds_read_b64_tr_b16 a[234:235], v241 offset:53248
    v_cvt_pk_bf16_f32 v36, v36, v37
    v_mfma_f32_16x16x32_bf16 v[44:47], a[224:227], a[104:107], v[44:47]
    ds_read_b64_tr_b16 a[236:237], v241 offset:57344
    v_mul_f32 v40, s54, v40
    v_mfma_f32_16x16x32_bf16 v[44:47], a[228:231], a[116:119], v[44:47]
    s_waitcnt lgkmcnt(9)
    ds_read_b64_tr_b16 a[238:239], v241 offset:61440
    v_xor_b32 v241, 0x10000, v241
    v_mfma_f32_16x16x32_bf16 v[48:51], a[216:219], a[120:123], v[48:51]
    s_waitcnt lgkmcnt(8)
    ds_read_b64_tr_b16 a[224:225], v241 offset:49152
    ds_read_b64_tr_b16 a[226:227], v241 offset:53248
    v_mfma_f32_16x16x32_bf16 v[48:51], a[220:223], a[132:135], v[48:51]
    s_waitcnt lgkmcnt(8)
    buffer_load_dwordx4 v248, s[24:27], s46 offen offset:3072 nt lds
    ds_read_b64_tr_b16 a[228:229], v241 offset:57344
    v_mfma_f32_16x16x32_bf16 v[48:51], a[208:211], a[96:99], v[48:51]
    s_waitcnt lgkmcnt(7)
    ds_read_b64_tr_b16 a[230:231], v241 offset:61440
    v_mul_f32 v41, s54, v41
    v_mfma_f32_16x16x32_bf16 v[48:51], a[212:215], a[108:111], v[48:51]
    v_mul_f32 v44, s54, v44
    v_mul_f32 v45, s54, v45
    v_mfma_f32_16x16x32_bf16 v[52:55], a[216:219], a[124:127], v[52:55]
    v_mul_f32 v42, s54, v42
    v_mul_f32 v43, s54, v43
    v_mfma_f32_16x16x32_bf16 v[52:55], a[220:223], a[136:139], v[52:55]
    v_cvt_pk_bf16_f32 v28, v28, v29
    v_cvt_pk_bf16_f32 v40, v40, v41
    v_mfma_f32_16x16x32_bf16 v[52:55], a[208:211], a[100:103], v[52:55]
    v_mul_f32 v34, s54, v34
    v_mul_f32 v35, s54, v35
    v_mfma_f32_16x16x32_bf16 v[52:55], a[212:215], a[112:115], v[52:55]
    v_mul_f32 v46, s54, v46
    v_mul_f32 v47, s54, v47
    v_mfma_f32_16x16x32_bf16 v[56:59], a[216:219], a[128:131], v[56:59]
    ds_read_b64_tr_b16 a[216:217], v242 offset:49152
    v_cvt_pk_bf16_f32 v32, v32, v33
    v_mfma_f32_16x16x32_bf16 v[56:59], a[220:223], a[140:143], v[56:59]
    ds_read_b64_tr_b16 a[218:219], v242 offset:53248
    v_cvt_pk_bf16_f32 v44, v44, v45
    v_mfma_f32_16x16x32_bf16 v[56:59], a[208:211], a[104:107], v[56:59]
    ds_read_b64_tr_b16 a[220:221], v242 offset:57344
    v_cvt_pk_bf16_f32 v1, v2, v3
    v_mfma_f32_16x16x32_bf16 v[56:59], a[212:215], a[116:119], v[56:59]
    s_waitcnt lgkmcnt(9)
    ds_read_b64_tr_b16 a[222:223], v242 offset:61440
    v_xor_b32 v242, 0x10000, v242
    v_mfma_f32_16x16x32_bf16 v[60:63], a[232:235], a[120:123], v[60:63]
    s_waitcnt lgkmcnt(8)
    ds_read_b64_tr_b16 a[208:209], v242 offset:49152
    ds_read_b64_tr_b16 a[210:211], v242 offset:53248
    v_mfma_f32_16x16x32_bf16 v[60:63], a[236:239], a[132:135], v[60:63]
    s_waitcnt lgkmcnt(8)
    ds_read_b64_tr_b16 a[212:213], v242 offset:57344
    ds_read_b64_tr_b16 a[214:215], v242 offset:61440
    v_mfma_f32_16x16x32_bf16 v[60:63], a[224:227], a[96:99], v[60:63]
    s_waitcnt lgkmcnt(8)
    v_cvt_pk_bf16_f32 v13, v14, v15
    v_cvt_pk_bf16_f32 v5, v6, v7
    v_mfma_f32_16x16x32_bf16 v[60:63], a[228:231], a[108:111], v[60:63]
    v_cvt_pk_bf16_f32 v17, v18, v19
    v_cvt_pk_bf16_f32 v9, v10, v11
    v_mfma_f32_16x16x32_bf16 v[64:67], a[232:235], a[124:127], v[64:67]
    v_cvt_pk_bf16_f32 v21, v22, v23
    v_cvt_pk_bf16_f32 v98, v100, v101
    v_mfma_f32_16x16x32_bf16 v[64:67], a[236:239], a[136:139], v[64:67]
    v_cvt_pk_bf16_f32 v99, v102, v103
    v_cvt_pk_bf16_f32 v25, v26, v27
    v_mfma_f32_16x16x32_bf16 v[64:67], a[224:227], a[100:103], v[64:67]
    v_cvt_pk_bf16_f32 v37, v38, v39
    v_cvt_pk_bf16_f32 v29, v30, v31
    v_mfma_f32_16x16x32_bf16 v[64:67], a[228:231], a[112:115], v[64:67]
    v_cvt_pk_bf16_f32 v41, v42, v43
    v_cvt_pk_bf16_f32 v33, v34, v35
    v_mfma_f32_16x16x32_bf16 v[68:71], a[232:235], a[128:131], v[68:71]
    ds_read_b64_tr_b16 a[232:233], v243 offset:49152
    v_cvt_pk_bf16_f32 v45, v46, v47
    v_mfma_f32_16x16x32_bf16 v[68:71], a[236:239], a[140:143], v[68:71]
    ds_read_b64_tr_b16 a[234:235], v243 offset:53248
    v_cndmask_b32 v2, v0, v12, s[50:51]
    v_mfma_f32_16x16x32_bf16 v[68:71], a[224:227], a[104:107], v[68:71]
    ds_read_b64_tr_b16 a[236:237], v243 offset:57344
    v_cndmask_b32 v3, v1, v13, s[50:51]
    v_mfma_f32_16x16x32_bf16 v[68:71], a[228:231], a[116:119], v[68:71]
    s_waitcnt lgkmcnt(9)
    ds_read_b64_tr_b16 a[238:239], v243 offset:61440
    v_xor_b32 v243, 0x10000, v243
    v_mfma_f32_16x16x32_bf16 v[72:75], a[216:219], a[120:123], v[72:75]
    s_waitcnt lgkmcnt(8)
    ds_read_b64_tr_b16 a[224:225], v243 offset:49152
    ds_read_b64_tr_b16 a[226:227], v243 offset:53248
    v_mfma_f32_16x16x32_bf16 v[72:75], a[220:223], a[132:135], v[72:75]
    s_waitcnt lgkmcnt(8)
    ds_read_b64_tr_b16 a[228:229], v243 offset:57344
    ds_read_b64_tr_b16 a[230:231], v243 offset:61440
    v_mfma_f32_16x16x32_bf16 v[72:75], a[208:211], a[96:99], v[72:75]
    s_waitcnt lgkmcnt(8)
    v_cndmask_b32 v14, v12, v0, s[50:51]
    v_cndmask_b32 v15, v13, v1, s[50:51]
    v_mfma_f32_16x16x32_bf16 v[72:75], a[212:215], a[108:111], v[72:75]
    v_cndmask_b32 v6, v4, v16, s[50:51]
    v_cndmask_b32 v7, v5, v17, s[50:51]
    v_mfma_f32_16x16x32_bf16 v[76:79], a[216:219], a[124:127], v[76:79]
    v_cndmask_b32 v18, v16, v4, s[50:51]
    v_cndmask_b32 v19, v17, v5, s[50:51]
    v_mfma_f32_16x16x32_bf16 v[76:79], a[220:223], a[136:139], v[76:79]
    v_cndmask_b32 v10, v8, v20, s[50:51]
    v_cndmask_b32 v11, v9, v21, s[50:51]
    v_mfma_f32_16x16x32_bf16 v[76:79], a[208:211], a[100:103], v[76:79]
    v_cndmask_b32 v22, v20, v8, s[50:51]
    v_cndmask_b32 v23, v21, v9, s[50:51]
    v_mfma_f32_16x16x32_bf16 v[76:79], a[212:215], a[112:115], v[76:79]
    v_cndmask_b32 v100, v96, v98, s[50:51]
    v_cndmask_b32 v101, v97, v99, s[50:51]
    v_mfma_f32_16x16x32_bf16 v[80:83], a[216:219], a[128:131], v[80:83]
    v_cndmask_b32 v102, v98, v96, s[50:51]
    v_cndmask_b32 v103, v99, v97, s[50:51]
    v_mfma_f32_16x16x32_bf16 v[80:83], a[220:223], a[140:143], v[80:83]
    v_cndmask_b32 v26, v24, v36, s[50:51]
    v_cndmask_b32 v27, v25, v37, s[50:51]
    v_mfma_f32_16x16x32_bf16 v[80:83], a[208:211], a[104:107], v[80:83]
    v_cndmask_b32 v38, v36, v24, s[50:51]
    v_cndmask_b32 v39, v37, v25, s[50:51]
    v_mfma_f32_16x16x32_bf16 v[80:83], a[212:215], a[116:119], v[80:83]
    s_waitcnt lgkmcnt(6)
    v_cndmask_b32 v30, v28, v40, s[50:51]
    v_cndmask_b32 v31, v29, v41, s[50:51]
    v_mfma_f32_16x16x32_bf16 v[84:87], a[232:235], a[120:123], v[84:87]
    s_waitcnt lgkmcnt(4)
    v_cndmask_b32 v42, v40, v28, s[50:51]
    v_cndmask_b32 v43, v41, v29, s[50:51]
    v_mfma_f32_16x16x32_bf16 v[84:87], a[236:239], a[132:135], v[84:87]
    s_waitcnt lgkmcnt(2)
    v_cndmask_b32 v34, v32, v44, s[50:51]
    v_cndmask_b32 v35, v33, v45, s[50:51]
    v_mfma_f32_16x16x32_bf16 v[84:87], a[224:227], a[96:99], v[84:87]
    s_waitcnt lgkmcnt(0)
    v_cndmask_b32 v46, v44, v32, s[50:51]
    v_cndmask_b32 v47, v45, v33, s[50:51]
    v_mfma_f32_16x16x32_bf16 v[84:87], a[228:231], a[108:111], v[84:87]
    v_accvgpr_write_b32 a144, v2
    v_accvgpr_write_b32 a145, v3
    v_mfma_f32_16x16x32_bf16 v[88:91], a[232:235], a[124:127], v[88:91]
    v_accvgpr_write_b32 a146, v14
    v_accvgpr_write_b32 a147, v15
    v_mfma_f32_16x16x32_bf16 v[88:91], a[236:239], a[136:139], v[88:91]
    v_accvgpr_write_b32 a148, v6
    v_accvgpr_write_b32 a149, v7
    v_mfma_f32_16x16x32_bf16 v[88:91], a[224:227], a[100:103], v[88:91]
    v_accvgpr_write_b32 a150, v18
    v_accvgpr_write_b32 a151, v19
    v_mfma_f32_16x16x32_bf16 v[88:91], a[228:231], a[112:115], v[88:91]
    v_accvgpr_write_b32 a152, v10
    v_accvgpr_write_b32 a153, v11
    v_mfma_f32_16x16x32_bf16 v[92:95], a[232:235], a[128:131], v[92:95]
    v_accvgpr_write_b32 a154, v22
    v_accvgpr_write_b32 a155, v23
    v_mfma_f32_16x16x32_bf16 v[92:95], a[236:239], a[140:143], v[92:95]
    ds_write_b128 v245, v[100:103] offset:20480
    v_mfma_f32_16x16x32_bf16 v[92:95], a[224:227], a[104:107], v[92:95]
    v_accvgpr_write_b32 a156, v26
    v_accvgpr_write_b32 a157, v27
    v_mfma_f32_16x16x32_bf16 v[92:95], a[228:231], a[116:119], v[92:95]
    s_waitcnt vmcnt(8)
    v_accvgpr_write_b32 a158, v38
    v_accvgpr_write_b32 a159, v39
    s_barrier
    v_accvgpr_write_b32 a160, v30
    v_accvgpr_write_b32 a161, v31
    v_accvgpr_write_b32 a162, v42
    v_accvgpr_write_b32 a163, v43
    v_accvgpr_write_b32 a164, v34
    v_accvgpr_write_b32 a165, v35
    v_accvgpr_write_b32 a166, v46
    v_accvgpr_write_b32 a167, v47
    buffer_store_byte v200, v201, s[4:7], 0 offen sc1
    s_branch L_qdone
L_head:
    s_waitcnt vmcnt(24)
    s_barrier
    ds_read_b64_tr_b16 a[208:209], v236 offset:0
    ds_read_b64_tr_b16 a[210:211], v236 offset:4096
    ds_read_b64_tr_b16 a[212:213], v236 offset:8192
    ds_read_b64_tr_b16 a[214:215], v236 offset:12288
    v_xor_b32 v236, 0x10000, v236
    ds_read_b64_tr_b16 a[216:217], v236 offset:0
    ds_read_b64_tr_b16 a[218:219], v236 offset:4096
    ds_read_b64_tr_b16 a[220:221], v236 offset:8192
    ds_read_b64_tr_b16 a[222:223], v236 offset:12288
    buffer_load_dwordx4 v[152:155], v251, s[8:11], s92 offen offset:0 sc1
    ds_read_b128 v[212:215], v244 offset:0
    ds_read_b128 v[216:219], v244 offset:1024
    ds_read_b128 v[220:223], v244 offset:2048
    ds_read_b128 v[224:227], v244 offset:3072
    ds_read_b64_tr_b16 a[224:225], v237 offset:0
    ds_read_b64_tr_b16 a[226:227], v237 offset:4096
    ds_read_b64_tr_b16 a[228:229], v237 offset:8192
    s_waitcnt vmcnt(12) lgkmcnt(13)
    v_mfma_f32_16x16x32_bf16 v[0:3], a[208:211], v[104:107], 0
    s_waitcnt vmcnt(9) lgkmcnt(11)
    ds_read_b64_tr_b16 a[230:231], v237 offset:12288
    v_xor_b32 v237, 0x10000, v237
    v_mfma_f32_16x16x32_bf16 v[0:3], a[212:215], v[116:119], v[0:3]
    s_waitcnt vmcnt(6) lgkmcnt(10)
    ds_read_b64_tr_b16 a[232:233], v237 offset:0
    v_mul_f32 v48, v204, v48
    v_mfma_f32_16x16x32_bf16 v[0:3], a[216:219], v[128:131], v[0:3]
    s_waitcnt vmcnt(3) lgkmcnt(9)
    ds_read_b64_tr_b16 a[234:235], v237 offset:4096
    v_mul_f32 v49, v204, v49
    v_mfma_f32_16x16x32_bf16 v[0:3], a[220:223], v[140:143], v[0:3]
    buffer_load_dwordx4 v[156:159], v252, s[8:11], s92 offen offset:0 sc1
    v_mul_f32 v50, v204, v50
    v_mfma_f32_16x16x32_bf16 v[4:7], a[208:211], v[108:111], 0
    ds_read_b64_tr_b16 a[236:237], v237 offset:8192
    v_mul_f32 v51, v204, v51
    v_mfma_f32_16x16x32_bf16 v[4:7], a[212:215], v[120:123], v[4:7]
    ds_read_b64_tr_b16 a[238:239], v237 offset:12288
    v_cvt_pk_bf16_f32 v48, v48, v49
    v_mfma_f32_16x16x32_bf16 v[4:7], a[216:219], v[132:135], v[4:7]
    v_cvt_pk_bf16_f32 v50, v50, v51
    v_accvgpr_write_b32 a168, v48
    s_waitcnt vmcnt(3)
    v_mfma_f32_16x16x32_bf16 v[4:7], a[220:223], v[144:147], v[4:7]
    buffer_load_dwordx4 v[160:163], v253, s[8:11], s92 offen offset:0 sc1
    v_accvgpr_write_b32 a169, v50
    v_mfma_f32_16x16x32_bf16 v[8:11], a[208:211], v[112:115], 0
    v_mul_f32 v52, v205, v52
    v_mul_f32 v53, v205, v53
    v_mfma_f32_16x16x32_bf16 v[8:11], a[212:215], v[124:127], v[8:11]
    v_mul_f32 v54, v205, v54
    v_mul_f32 v55, v205, v55
    v_mfma_f32_16x16x32_bf16 v[8:11], a[216:219], v[136:139], v[8:11]
    v_cvt_pk_bf16_f32 v52, v52, v53
    v_cvt_pk_bf16_f32 v54, v54, v55
    s_waitcnt vmcnt(3)
    v_mfma_f32_16x16x32_bf16 v[8:11], a[220:223], v[148:151], v[8:11]
    s_waitcnt lgkmcnt(11)
    buffer_load_dwordx4 v[164:167], v251, s[8:11], s92 offen offset:1024 sc1
    v_accvgpr_write_b32 a172, v52
    v_mfma_f32_16x16x32_bf16 v[96:99], a[208:211], v[212:215], 0
    s_waitcnt lgkmcnt(10)
    ds_read_b64_tr_b16 a[208:209], v238 offset:0
    v_accvgpr_write_b32 a173, v54
    v_mfma_f32_16x16x32_bf16 v[96:99], a[212:215], v[216:219], v[96:99]
    s_waitcnt lgkmcnt(10)
    ds_read_b64_tr_b16 a[210:211], v238 offset:4096
    v_mul_f32 v56, v206, v56
    v_mfma_f32_16x16x32_bf16 v[96:99], a[216:219], v[220:223], v[96:99]
    s_waitcnt lgkmcnt(10)
    ds_read_b64_tr_b16 a[212:213], v238 offset:8192
    v_mul_f32 v57, v206, v57
    v_mfma_f32_16x16x32_bf16 v[96:99], a[220:223], v[224:227], v[96:99]
    s_waitcnt lgkmcnt(9)
    buffer_load_dwordx4 v[168:171], v252, s[8:11], s92 offen offset:1024 sc1
    v_mul_f32 v58, v206, v58
    v_mfma_f32_16x16x32_bf16 v[12:15], a[224:227], v[104:107], 0
    s_waitcnt lgkmcnt(7)
    ds_read_b64_tr_b16 a[214:215], v238 offset:12288
    v_xor_b32 v238, 0x10000, v238
    v_mfma_f32_16x16x32_bf16 v[12:15], a[228:231], v[116:119], v[12:15]
    s_waitcnt lgkmcnt(6)
    ds_read_b64_tr_b16 a[216:217], v238 offset:0
    v_mul_f32 v59, v206, v59
    v_mfma_f32_16x16x32_bf16 v[12:15], a[232:235], v[128:131], v[12:15]
    s_waitcnt lgkmcnt(5)
    ds_read_b64_tr_b16 a[218:219], v238 offset:4096
    v_cvt_pk_bf16_f32 v56, v56, v57
    v_mfma_f32_16x16x32_bf16 v[12:15], a[236:239], v[140:143], v[12:15]
    buffer_load_dwordx4 v[172:175], v253, s[8:11], s92 offen offset:1024 sc1
    v_cvt_pk_bf16_f32 v58, v58, v59
    v_mfma_f32_16x16x32_bf16 v[16:19], a[224:227], v[108:111], 0
    ds_read_b64_tr_b16 a[220:221], v238 offset:8192
    v_accvgpr_write_b32 a176, v56
    v_mfma_f32_16x16x32_bf16 v[16:19], a[228:231], v[120:123], v[16:19]
    ds_read_b64_tr_b16 a[222:223], v238 offset:12288
    v_accvgpr_write_b32 a177, v58
    v_mfma_f32_16x16x32_bf16 v[16:19], a[232:235], v[132:135], v[16:19]
    v_mul_f32 v60, v204, v60
    v_mul_f32 v61, v204, v61
    v_mfma_f32_16x16x32_bf16 v[16:19], a[236:239], v[144:147], v[16:19]
    buffer_load_dwordx4 v[176:179], v251, s[8:11], s92 offen offset:2048 sc1
    v_mul_f32 v62, v204, v62
    v_mfma_f32_16x16x32_bf16 v[20:23], a[224:227], v[112:115], 0
    v_mul_f32 v63, v204, v63
    v_cvt_pk_bf16_f32 v60, v60, v61
    v_mfma_f32_16x16x32_bf16 v[20:23], a[228:231], v[124:127], v[20:23]
    v_cvt_pk_bf16_f32 v62, v62, v63
    v_accvgpr_write_b32 a170, v60
    v_mfma_f32_16x16x32_bf16 v[20:23], a[232:235], v[136:139], v[20:23]
    v_accvgpr_write_b32 a171, v62
    v_mul_f32 v64, v205, v64
    v_mfma_f32_16x16x32_bf16 v[20:23], a[236:239], v[148:151], v[20:23]
    buffer_load_dwordx4 v[180:183], v252, s[8:11], s92 offen offset:2048 sc1
    v_mul_f32 v65, v205, v65
    v_mfma_f32_16x16x32_bf16 v[100:103], a[224:227], v[212:215], 0
    ds_read_b64_tr_b16 a[224:225], v239 offset:0
    v_mul_f32 v66, v205, v66
    v_mfma_f32_16x16x32_bf16 v[100:103], a[228:231], v[216:219], v[100:103]
    ds_read_b64_tr_b16 a[226:227], v239 offset:4096
    v_mul_f32 v67, v205, v67
    v_mfma_f32_16x16x32_bf16 v[100:103], a[232:235], v[220:223], v[100:103]
    ds_read_b64_tr_b16 a[228:229], v239 offset:8192
    v_cvt_pk_bf16_f32 v64, v64, v65
    v_mfma_f32_16x16x32_bf16 v[100:103], a[236:239], v[224:227], v[100:103]
    s_waitcnt lgkmcnt(9)
    buffer_load_dwordx4 v[184:187], v253, s[8:11], s92 offen offset:2048 sc1
    v_cvt_pk_bf16_f32 v66, v66, v67
    v_mfma_f32_16x16x32_bf16 v[24:27], a[208:211], v[104:107], 0
    s_waitcnt lgkmcnt(7)
    ds_read_b64_tr_b16 a[230:231], v239 offset:12288
    v_xor_b32 v239, 0x10000, v239
    v_mfma_f32_16x16x32_bf16 v[24:27], a[212:215], v[116:119], v[24:27]
    s_waitcnt lgkmcnt(6)
    ds_read_b64_tr_b16 a[232:233], v239 offset:0
    v_accvgpr_write_b32 a174, v64
    v_mfma_f32_16x16x32_bf16 v[24:27], a[216:219], v[128:131], v[24:27]
    s_waitcnt lgkmcnt(5)
    ds_read_b64_tr_b16 a[234:235], v239 offset:4096
    v_accvgpr_write_b32 a175, v66
    v_mfma_f32_16x16x32_bf16 v[24:27], a[220:223], v[140:143], v[24:27]
    ds_read_b64_tr_b16 a[236:237], v239 offset:8192
    v_mul_f32 v68, v206, v68
    v_mfma_f32_16x16x32_bf16 v[28:31], a[208:211], v[108:111], 0
    ds_read_b64_tr_b16 a[238:239], v239 offset:12288
    v_mul_f32 v69, v206, v69
    v_mfma_f32_16x16x32_bf16 v[28:31], a[212:215], v[120:123], v[28:31]
    buffer_load_dwordx4 v[188:191], v251, s[8:11], s92 offen offset:3072 sc1
    v_mul_f32 v70, v206, v70
    v_mfma_f32_16x16x32_bf16 v[28:31], a[216:219], v[132:135], v[28:31]
    v_mul_f32 v71, v206, v71
    v_cvt_pk_bf16_f32 v68, v68, v69
    v_mfma_f32_16x16x32_bf16 v[28:31], a[220:223], v[144:147], v[28:31]
    buffer_load_dwordx4 v[192:195], v252, s[8:11], s92 offen offset:3072 sc1
    v_cvt_pk_bf16_f32 v70, v70, v71
    v_mfma_f32_16x16x32_bf16 v[32:35], a[208:211], v[112:115], 0
    ds_read_b64_tr_b16 a[208:209], v240 offset:0
    v_accvgpr_write_b32 a178, v68
    v_mfma_f32_16x16x32_bf16 v[32:35], a[212:215], v[124:127], v[32:35]
    ds_read_b64_tr_b16 a[210:211], v240 offset:4096
    v_accvgpr_write_b32 a179, v70
    v_mfma_f32_16x16x32_bf16 v[32:35], a[216:219], v[136:139], v[32:35]
    ds_read_b64_tr_b16 a[212:213], v240 offset:8192
    v_mul_f32 v72, v204, v72
    v_mfma_f32_16x16x32_bf16 v[32:35], a[220:223], v[148:151], v[32:35]
    s_waitcnt lgkmcnt(9)
    buffer_load_dwordx4 v[196:199], v253, s[8:11], s92 offen offset:3072 sc1
    v_mul_f32 v73, v204, v73
    v_mfma_f32_16x16x32_bf16 v[36:39], a[224:227], v[104:107], 0
    s_waitcnt lgkmcnt(7)
    ds_read_b64_tr_b16 a[214:215], v240 offset:12288
    v_xor_b32 v240, 0x10000, v240
    v_mfma_f32_16x16x32_bf16 v[36:39], a[228:231], v[116:119], v[36:39]
    s_waitcnt lgkmcnt(6)
    ds_read_b64_tr_b16 a[216:217], v240 offset:0
    v_mul_f32 v74, v204, v74
    v_mfma_f32_16x16x32_bf16 v[36:39], a[232:235], v[128:131], v[36:39]
    s_waitcnt lgkmcnt(5)
    ds_read_b64_tr_b16 a[218:219], v240 offset:4096
    v_mul_f32 v75, v204, v75
    v_mfma_f32_16x16x32_bf16 v[36:39], a[236:239], v[140:143], v[36:39]
    ds_read_b64_tr_b16 a[220:221], v240 offset:8192
    v_cvt_pk_bf16_f32 v72, v72, v73
    v_mfma_f32_16x16x32_bf16 v[40:43], a[224:227], v[108:111], 0
    ds_read_b64_tr_b16 a[222:223], v240 offset:12288
    v_cvt_pk_bf16_f32 v74, v74, v75
    v_mfma_f32_16x16x32_bf16 v[40:43], a[228:231], v[120:123], v[40:43]
    s_add_u32 m0, s41, 49152
    v_accvgpr_write_b32 a180, v72
    v_accvgpr_write_b32 a181, v74
    v_mfma_f32_16x16x32_bf16 v[40:43], a[232:235], v[132:135], v[40:43]
    buffer_load_dwordx4 v249, s[32:35], s42 offen offset:0 lds
    v_mul_f32 v76, v205, v76
    v_mfma_f32_16x16x32_bf16 v[40:43], a[236:239], v[144:147], v[40:43]
    v_mul_f32 v77, v205, v77
    v_mul_f32 v78, v205, v78
    v_mfma_f32_16x16x32_bf16 v[44:47], a[224:227], v[112:115], 0
    ds_read_b64_tr_b16 a[224:225], v241 offset:0
    v_mul_f32 v79, v205, v79
    v_mfma_f32_16x16x32_bf16 v[44:47], a[228:231], v[124:127], v[44:47]
    ds_read_b64_tr_b16 a[226:227], v241 offset:4096
    v_cvt_pk_bf16_f32 v76, v76, v77
    v_mfma_f32_16x16x32_bf16 v[44:47], a[232:235], v[136:139], v[44:47]
    ds_read_b64_tr_b16 a[228:229], v241 offset:8192
    v_cvt_pk_bf16_f32 v78, v78, v79
    v_mfma_f32_16x16x32_bf16 v[44:47], a[236:239], v[148:151], v[44:47]
    s_waitcnt lgkmcnt(9)
    s_add_u32 s47, s42, s45
    ds_read_b64_tr_b16 a[230:231], v241 offset:12288
    v_mfma_f32_16x16x32_bf16 v[48:51], a[208:211], v[104:107], 0
    s_waitcnt lgkmcnt(8)
    buffer_load_dwordx4 v250, s[32:35], s47 offen offset:1024 lds
    v_xor_b32 v241, 0x10000, v241
    v_mfma_f32_16x16x32_bf16 v[48:51], a[212:215], v[116:119], v[48:51]
    s_waitcnt lgkmcnt(6)
    ds_read_b64_tr_b16 a[232:233], v241 offset:0
    v_accvgpr_write_b32 a184, v76
    v_mfma_f32_16x16x32_bf16 v[48:51], a[216:219], v[128:131], v[48:51]
    s_waitcnt lgkmcnt(5)
    ds_read_b64_tr_b16 a[234:235], v241 offset:4096
    v_accvgpr_write_b32 a185, v78
    v_mfma_f32_16x16x32_bf16 v[48:51], a[220:223], v[140:143], v[48:51]
    ds_read_b64_tr_b16 a[236:237], v241 offset:8192
    v_mul_f32 v80, v206, v80
    v_mfma_f32_16x16x32_bf16 v[52:55], a[208:211], v[108:111], 0
    ds_read_b64_tr_b16 a[238:239], v241 offset:12288
    v_mul_f32 v81, v206, v81
    v_mfma_f32_16x16x32_bf16 v[52:55], a[212:215], v[120:123], v[52:55]
    s_add_u32 s48, s47, s45
    buffer_load_dwordx4 v249, s[32:35], s48 offen offset:2048 lds
    v_mul_f32 v82, v206, v82
    v_mfma_f32_16x16x32_bf16 v[52:55], a[216:219], v[132:135], v[52:55]
    v_mul_f32 v83, v206, v83
    v_cvt_pk_bf16_f32 v80, v80, v81
    v_mfma_f32_16x16x32_bf16 v[52:55], a[220:223], v[144:147], v[52:55]
    v_cvt_pk_bf16_f32 v82, v82, v83
    v_accvgpr_write_b32 a188, v80
    v_mfma_f32_16x16x32_bf16 v[56:59], a[208:211], v[112:115], 0
    ds_read_b64_tr_b16 a[208:209], v242 offset:0
    v_accvgpr_write_b32 a189, v82
    v_mfma_f32_16x16x32_bf16 v[56:59], a[212:215], v[124:127], v[56:59]
    ds_read_b64_tr_b16 a[210:211], v242 offset:4096
    v_mul_f32 v84, v204, v84
    v_mfma_f32_16x16x32_bf16 v[56:59], a[216:219], v[136:139], v[56:59]
    ds_read_b64_tr_b16 a[212:213], v242 offset:8192
    v_mul_f32 v85, v204, v85
    v_mfma_f32_16x16x32_bf16 v[56:59], a[220:223], v[148:151], v[56:59]
    s_waitcnt lgkmcnt(9)
    s_add_u32 s49, s48, s45
    ds_read_b64_tr_b16 a[214:215], v242 offset:12288
    v_mfma_f32_16x16x32_bf16 v[60:63], a[224:227], v[104:107], 0
    s_waitcnt lgkmcnt(8)
    buffer_load_dwordx4 v250, s[32:35], s49 offen offset:3072 lds
    v_xor_b32 v242, 0x10000, v242
    v_mfma_f32_16x16x32_bf16 v[60:63], a[228:231], v[116:119], v[60:63]
    s_waitcnt lgkmcnt(6)
    ds_read_b64_tr_b16 a[216:217], v242 offset:0
    v_mul_f32 v86, v204, v86
    v_mfma_f32_16x16x32_bf16 v[60:63], a[232:235], v[128:131], v[60:63]
    s_waitcnt lgkmcnt(5)
    ds_read_b64_tr_b16 a[218:219], v242 offset:4096
    v_mul_f32 v87, v204, v87
    v_mfma_f32_16x16x32_bf16 v[60:63], a[236:239], v[140:143], v[60:63]
    s_add_u32 s42, s42, s63
    ds_read_b64_tr_b16 a[220:221], v242 offset:8192
    v_cvt_pk_bf16_f32 v84, v84, v85
    v_mfma_f32_16x16x32_bf16 v[64:67], a[224:227], v[108:111], 0
    ds_read_b64_tr_b16 a[222:223], v242 offset:12288
    v_cvt_pk_bf16_f32 v86, v86, v87
    v_mfma_f32_16x16x32_bf16 v[64:67], a[228:231], v[120:123], v[64:67]
    s_add_u32 m0, s41, 114688
    v_accvgpr_write_b32 a182, v84
    v_accvgpr_write_b32 a183, v86
    v_mfma_f32_16x16x32_bf16 v[64:67], a[232:235], v[132:135], v[64:67]
    buffer_load_dwordx4 v249, s[32:35], s43 offen offset:0 lds
    v_mul_f32 v88, v205, v88
    v_mfma_f32_16x16x32_bf16 v[64:67], a[236:239], v[144:147], v[64:67]
    v_mul_f32 v89, v205, v89
    v_mul_f32 v90, v205, v90
    v_mfma_f32_16x16x32_bf16 v[68:71], a[224:227], v[112:115], 0
    ds_read_b64_tr_b16 a[224:225], v243 offset:0
    v_mul_f32 v91, v205, v91
    v_mfma_f32_16x16x32_bf16 v[68:71], a[228:231], v[124:127], v[68:71]
    ds_read_b64_tr_b16 a[226:227], v243 offset:4096
    v_cvt_pk_bf16_f32 v88, v88, v89
    v_mfma_f32_16x16x32_bf16 v[68:71], a[232:235], v[136:139], v[68:71]
    ds_read_b64_tr_b16 a[228:229], v243 offset:8192
    v_cvt_pk_bf16_f32 v90, v90, v91
    v_mfma_f32_16x16x32_bf16 v[68:71], a[236:239], v[148:151], v[68:71]
    s_waitcnt lgkmcnt(9)
    ds_read_b64_tr_b16 a[230:231], v243 offset:12288
    v_xor_b32 v243, 0x10000, v243
    v_mfma_f32_16x16x32_bf16 v[72:75], a[208:211], v[104:107], 0
    s_waitcnt lgkmcnt(8)
    s_add_u32 s47, s43, s45
    ds_read_b64_tr_b16 a[232:233], v243 offset:0
    v_mfma_f32_16x16x32_bf16 v[72:75], a[212:215], v[116:119], v[72:75]
    s_waitcnt lgkmcnt(7)
    buffer_load_dwordx4 v250, s[32:35], s47 offen offset:1024 lds
    v_accvgpr_write_b32 a186, v88
    v_mfma_f32_16x16x32_bf16 v[72:75], a[216:219], v[128:131], v[72:75]
    s_waitcnt lgkmcnt(5)
    ds_read_b64_tr_b16 a[234:235], v243 offset:4096
    v_accvgpr_write_b32 a187, v90
    v_mfma_f32_16x16x32_bf16 v[72:75], a[220:223], v[140:143], v[72:75]
    ds_read_b64_tr_b16 a[236:237], v243 offset:8192
    v_mul_f32 v92, v206, v92
    v_mfma_f32_16x16x32_bf16 v[76:79], a[208:211], v[108:111], 0
    ds_read_b64_tr_b16 a[238:239], v243 offset:12288
    v_mul_f32 v93, v206, v93
    v_mfma_f32_16x16x32_bf16 v[76:79], a[212:215], v[120:123], v[76:79]
    s_add_u32 s48, s47, s45
    buffer_load_dwordx4 v249, s[32:35], s48 offen offset:2048 lds
    v_mul_f32 v94, v206, v94
    v_mfma_f32_16x16x32_bf16 v[76:79], a[216:219], v[132:135], v[76:79]
    v_mul_f32 v95, v206, v95
    v_cvt_pk_bf16_f32 v92, v92, v93
    v_mfma_f32_16x16x32_bf16 v[76:79], a[220:223], v[144:147], v[76:79]
    v_cvt_pk_bf16_f32 v94, v94, v95
    v_accvgpr_write_b32 a190, v92
    v_mfma_f32_16x16x32_bf16 v[80:83], a[208:211], v[112:115], 0
    v_accvgpr_write_b32 a191, v94
    v_add_u32 v204, s55, v245
    v_mfma_f32_16x16x32_bf16 v[80:83], a[212:215], v[124:127], v[80:83]
    ds_read_b128 v[220:223], v244 offset:6144
    v_accvgpr_mov_b32 a0, a48
    v_mfma_f32_16x16x32_bf16 v[80:83], a[216:219], v[136:139], v[80:83]
    ds_read_b128 v[224:227], v244 offset:7168
    v_accvgpr_mov_b32 a1, a49
    v_mfma_f32_16x16x32_bf16 v[80:83], a[220:223], v[148:151], v[80:83]
    s_waitcnt lgkmcnt(2)
    s_add_u32 s49, s48, s45
    ds_read_b128 v[212:215], v244 offset:4096
    s_barrier
    v_mfma_f32_16x16x32_bf16 v[84:87], a[224:227], v[104:107], 0
    s_add_u32 s43, s43, s63
    buffer_load_dwordx4 v250, s[32:35], s49 offen offset:3072 lds
    v_accvgpr_mov_b32 a2, a50
    v_mfma_f32_16x16x32_bf16 v[84:87], a[228:231], v[116:119], v[84:87]
    ds_read_b64_tr_b16 a[216:217], v236 offset:16384
    v_accvgpr_mov_b32 a3, a51
    v_mfma_f32_16x16x32_bf16 v[84:87], a[232:235], v[128:131], v[84:87]
    ds_read_b64_tr_b16 a[218:219], v236 offset:20480
    v_accvgpr_mov_b32 a4, a52
    v_mfma_f32_16x16x32_bf16 v[84:87], a[236:239], v[140:143], v[84:87]
    ds_read_b64_tr_b16 a[220:221], v236 offset:24576
    v_accvgpr_mov_b32 a5, a53
    v_mfma_f32_16x16x32_bf16 v[88:91], a[224:227], v[108:111], 0
    ds_read_b64_tr_b16 a[222:223], v236 offset:28672
    v_xor_b32 v236, 0x10000, v236
    v_mfma_f32_16x16x32_bf16 v[88:91], a[228:231], v[120:123], v[88:91]
    ds_read_b64_tr_b16 a[208:209], v236 offset:16384
    v_accvgpr_mov_b32 a6, a54
    v_mfma_f32_16x16x32_bf16 v[88:91], a[232:235], v[132:135], v[88:91]
    ds_read_b64_tr_b16 a[210:211], v236 offset:20480
    v_accvgpr_mov_b32 a7, a55
    v_mfma_f32_16x16x32_bf16 v[88:91], a[236:239], v[144:147], v[88:91]
    ds_read_b64_tr_b16 a[212:213], v236 offset:24576
    v_accvgpr_mov_b32 a8, a56
    v_mfma_f32_16x16x32_bf16 v[92:95], a[224:227], v[112:115], 0
    ds_read_b64_tr_b16 a[214:215], v236 offset:28672
    v_accvgpr_mov_b32 a9, a57
    v_mfma_f32_16x16x32_bf16 v[92:95], a[228:231], v[124:127], v[92:95]
    ds_read_b128 v[216:219], v244 offset:5120
    v_accvgpr_mov_b32 a10, a58
    v_mfma_f32_16x16x32_bf16 v[92:95], a[232:235], v[136:139], v[92:95]
    ds_read_b64_tr_b16 a[232:233], v237 offset:16384
    v_accvgpr_mov_b32 a11, a59
    v_mfma_f32_16x16x32_bf16 v[92:95], a[236:239], v[148:151], v[92:95]
    s_waitcnt vmcnt(13) lgkmcnt(8)
    ds_read_b64_tr_b16 a[234:235], v237 offset:20480
    v_accvgpr_mov_b32 a12, a60
    v_mfma_f32_16x16x32_bf16 v[0:3], a[216:219], v[176:179], v[0:3]
    s_waitcnt vmcnt(10) lgkmcnt(7)
    ds_read_b64_tr_b16 a[236:237], v237 offset:24576
    v_accvgpr_mov_b32 a13, a61
    v_mfma_f32_16x16x32_bf16 v[0:3], a[220:223], v[188:191], v[0:3]
    s_waitcnt lgkmcnt(6)
    ds_read_b64_tr_b16 a[238:239], v237 offset:28672
    v_xor_b32 v237, 0x10000, v237
    v_mfma_f32_16x16x32_bf16 v[0:3], a[208:211], v[152:155], v[0:3]
    s_waitcnt lgkmcnt(5)
    ds_read_b64_tr_b16 a[224:225], v237 offset:16384
    v_accvgpr_mov_b32 a14, a62
    v_mfma_f32_16x16x32_bf16 v[0:3], a[212:215], v[164:167], v[0:3]
    buffer_load_dwordx4 v[104:107], v251, s[8:11], s93 offen offset:0 sc1
    v_accvgpr_mov_b32 a15, a63
    v_mfma_f32_16x16x32_bf16 v[4:7], a[216:219], v[180:183], v[4:7]
    s_waitcnt vmcnt(10)
    ds_read_b64_tr_b16 a[226:227], v237 offset:20480
    v_accvgpr_mov_b32 a16, a64
    v_mfma_f32_16x16x32_bf16 v[4:7], a[220:223], v[192:195], v[4:7]
    ds_read_b64_tr_b16 a[228:229], v237 offset:24576
    v_accvgpr_mov_b32 a17, a65
    v_mfma_f32_16x16x32_bf16 v[4:7], a[208:211], v[156:159], v[4:7]
    ds_read_b64_tr_b16 a[230:231], v237 offset:28672
    v_accvgpr_mov_b32 a18, a66
    v_mfma_f32_16x16x32_bf16 v[4:7], a[212:215], v[168:171], v[4:7]
    buffer_load_dwordx4 v[108:111], v252, s[8:11], s93 offen offset:0 sc1
    v_accvgpr_mov_b32 a19, a67
    v_mfma_f32_16x16x32_bf16 v[8:11], a[216:219], v[184:187], v[8:11]
    s_waitcnt vmcnt(10)
    ds_write_b128 v204, v[208:211] offset:0
    v_mfma_f32_16x16x32_bf16 v[8:11], a[220:223], v[196:199], v[8:11]
    v_accvgpr_mov_b32 a20, a68
    v_accvgpr_mov_b32 a21, a69
    v_mfma_f32_16x16x32_bf16 v[8:11], a[208:211], v[160:163], v[8:11]
    v_accvgpr_mov_b32 a22, a70
    v_accvgpr_mov_b32 a23, a71
    v_mfma_f32_16x16x32_bf16 v[8:11], a[212:215], v[172:175], v[8:11]
    buffer_load_dwordx4 v[112:115], v253, s[8:11], s93 offen offset:0 sc1
    v_accvgpr_mov_b32 a24, a72
    v_mfma_f32_16x16x32_bf16 v[96:99], a[216:219], v[220:223], v[96:99]
    ds_read_b64_tr_b16 a[216:217], v238 offset:16384
    v_accvgpr_mov_b32 a25, a73
    v_mfma_f32_16x16x32_bf16 v[96:99], a[220:223], v[224:227], v[96:99]
    ds_read_b64_tr_b16 a[218:219], v238 offset:20480
    v_accvgpr_mov_b32 a26, a74
    v_mfma_f32_16x16x32_bf16 v[96:99], a[208:211], v[212:215], v[96:99]
    s_waitcnt lgkmcnt(11)
    ds_read_b64_tr_b16 a[220:221], v238 offset:24576
    v_accvgpr_mov_b32 a27, a75
    v_mfma_f32_16x16x32_bf16 v[96:99], a[212:215], v[216:219], v[96:99]
    s_waitcnt lgkmcnt(10)
    buffer_load_dwordx4 v[116:119], v251, s[8:11], s93 offen offset:1024 sc1
    v_accvgpr_mov_b32 a28, a76
    v_mfma_f32_16x16x32_bf16 v[12:15], a[232:235], v[176:179], v[12:15]
    s_waitcnt lgkmcnt(8)
    ds_read_b64_tr_b16 a[222:223], v238 offset:28672
    v_xor_b32 v238, 0x10000, v238
    v_mfma_f32_16x16x32_bf16 v[12:15], a[236:239], v[188:191], v[12:15]
    s_waitcnt lgkmcnt(7)
    ds_read_b64_tr_b16 a[208:209], v238 offset:16384
    v_accvgpr_mov_b32 a29, a77
    v_mfma_f32_16x16x32_bf16 v[12:15], a[224:227], v[152:155], v[12:15]
    s_waitcnt lgkmcnt(6)
    ds_read_b64_tr_b16 a[210:211], v238 offset:20480
    v_accvgpr_mov_b32 a30, a78
    v_mfma_f32_16x16x32_bf16 v[12:15], a[228:231], v[164:167], v[12:15]
    buffer_load_dwordx4 v[120:123], v252, s[8:11], s93 offen offset:1024 sc1
    v_accvgpr_mov_b32 a31, a79
    v_mfma_f32_16x16x32_bf16 v[16:19], a[232:235], v[180:183], v[16:19]
    ds_read_b64_tr_b16 a[212:213], v238 offset:24576
    v_accvgpr_mov_b32 a32, a80
    v_mfma_f32_16x16x32_bf16 v[16:19], a[236:239], v[192:195], v[16:19]
    ds_read_b64_tr_b16 a[214:215], v238 offset:28672
    v_accvgpr_mov_b32 a33, a81
    v_mfma_f32_16x16x32_bf16 v[16:19], a[224:227], v[156:159], v[16:19]
    v_accvgpr_mov_b32 a34, a82
    v_accvgpr_mov_b32 a35, a83
    v_mfma_f32_16x16x32_bf16 v[16:19], a[228:231], v[168:171], v[16:19]
    buffer_load_dwordx4 v[124:127], v253, s[8:11], s93 offen offset:1024 sc1
    v_accvgpr_mov_b32 a36, a84
    v_mfma_f32_16x16x32_bf16 v[20:23], a[232:235], v[184:187], v[20:23]
    v_accvgpr_mov_b32 a37, a85
    v_accvgpr_mov_b32 a38, a86
    v_mfma_f32_16x16x32_bf16 v[20:23], a[236:239], v[196:199], v[20:23]
    v_accvgpr_mov_b32 a39, a87
    v_accvgpr_mov_b32 a40, a88
    v_mfma_f32_16x16x32_bf16 v[20:23], a[224:227], v[160:163], v[20:23]
    v_accvgpr_mov_b32 a41, a89
    v_accvgpr_mov_b32 a42, a90
    v_mfma_f32_16x16x32_bf16 v[20:23], a[228:231], v[172:175], v[20:23]
    buffer_load_dwordx4 v[128:131], v251, s[8:11], s93 offen offset:2048 sc1
    v_accvgpr_mov_b32 a43, a91
    v_mfma_f32_16x16x32_bf16 v[100:103], a[232:235], v[220:223], v[100:103]
    ds_read_b64_tr_b16 a[232:233], v239 offset:16384
    v_accvgpr_mov_b32 a44, a92
    v_mfma_f32_16x16x32_bf16 v[100:103], a[236:239], v[224:227], v[100:103]
    ds_read_b64_tr_b16 a[234:235], v239 offset:20480
    v_accvgpr_mov_b32 a45, a93
    v_mfma_f32_16x16x32_bf16 v[100:103], a[224:227], v[212:215], v[100:103]
    ds_read_b64_tr_b16 a[236:237], v239 offset:24576
    v_accvgpr_mov_b32 a46, a94
    v_mfma_f32_16x16x32_bf16 v[100:103], a[228:231], v[216:219], v[100:103]
    s_waitcnt lgkmcnt(9)
    buffer_load_dwordx4 v[132:135], v252, s[8:11], s93 offen offset:2048 sc1
    v_accvgpr_mov_b32 a47, a95
    v_mfma_f32_16x16x32_bf16 v[24:27], a[216:219], v[176:179], v[24:27]
    s_waitcnt lgkmcnt(7)
    ds_read_b64_tr_b16 a[238:239], v239 offset:28672
    v_xor_b32 v239, 0x10000, v239
    v_mfma_f32_16x16x32_bf16 v[24:27], a[220:223], v[188:191], v[24:27]
    s_waitcnt lgkmcnt(6)
    ds_read_b64_tr_b16 a[224:225], v239 offset:16384
    v_accvgpr_mov_b32 a48, a96
    v_mfma_f32_16x16x32_bf16 v[24:27], a[208:211], v[152:155], v[24:27]
    s_waitcnt lgkmcnt(5)
    ds_read_b64_tr_b16 a[226:227], v239 offset:20480
    v_accvgpr_mov_b32 a49, a97
    v_mfma_f32_16x16x32_bf16 v[24:27], a[212:215], v[164:167], v[24:27]
    ds_read_b64_tr_b16 a[228:229], v239 offset:24576
    v_accvgpr_mov_b32 a50, a98
    v_mfma_f32_16x16x32_bf16 v[28:31], a[216:219], v[180:183], v[28:31]
    ds_read_b64_tr_b16 a[230:231], v239 offset:28672
    v_accvgpr_mov_b32 a51, a99
    v_mfma_f32_16x16x32_bf16 v[28:31], a[220:223], v[192:195], v[28:31]
    buffer_load_dwordx4 v[136:139], v253, s[8:11], s93 offen offset:2048 sc1
    v_accvgpr_mov_b32 a52, a100
    v_mfma_f32_16x16x32_bf16 v[28:31], a[208:211], v[156:159], v[28:31]
    ds_read_b128 v[212:215], v244 offset:8192
    v_accvgpr_mov_b32 a53, a101
    v_mfma_f32_16x16x32_bf16 v[28:31], a[212:215], v[168:171], v[28:31]
    buffer_load_dwordx4 v[140:143], v251, s[8:11], s93 offen offset:3072 sc1
    v_accvgpr_mov_b32 a54, a102
    v_mfma_f32_16x16x32_bf16 v[32:35], a[216:219], v[184:187], v[32:35]
    ds_read_b64_tr_b16 a[216:217], v240 offset:16384
    v_accvgpr_mov_b32 a55, a103
    v_mfma_f32_16x16x32_bf16 v[32:35], a[220:223], v[196:199], v[32:35]
    ds_read_b64_tr_b16 a[218:219], v240 offset:20480
    v_accvgpr_mov_b32 a56, a104
    v_mfma_f32_16x16x32_bf16 v[32:35], a[208:211], v[160:163], v[32:35]
    ds_read_b64_tr_b16 a[220:221], v240 offset:24576
    v_accvgpr_mov_b32 a57, a105
    v_mfma_f32_16x16x32_bf16 v[32:35], a[212:215], v[172:175], v[32:35]
    s_waitcnt lgkmcnt(10)
    buffer_load_dwordx4 v[144:147], v252, s[8:11], s93 offen offset:3072 sc1
    v_accvgpr_mov_b32 a58, a106
    v_mfma_f32_16x16x32_bf16 v[36:39], a[232:235], v[176:179], v[36:39]
    s_waitcnt lgkmcnt(8)
    ds_read_b64_tr_b16 a[222:223], v240 offset:28672
    v_xor_b32 v240, 0x10000, v240
    v_mfma_f32_16x16x32_bf16 v[36:39], a[236:239], v[188:191], v[36:39]
    s_waitcnt lgkmcnt(7)
    ds_read_b64_tr_b16 a[208:209], v240 offset:16384
    v_accvgpr_mov_b32 a59, a107
    v_mfma_f32_16x16x32_bf16 v[36:39], a[224:227], v[152:155], v[36:39]
    s_waitcnt lgkmcnt(6)
    ds_read_b64_tr_b16 a[210:211], v240 offset:20480
    v_accvgpr_mov_b32 a60, a108
    v_mfma_f32_16x16x32_bf16 v[36:39], a[228:231], v[164:167], v[36:39]
    ds_read_b64_tr_b16 a[212:213], v240 offset:24576
    v_accvgpr_mov_b32 a61, a109
    v_mfma_f32_16x16x32_bf16 v[40:43], a[232:235], v[180:183], v[40:43]
    ds_read_b64_tr_b16 a[214:215], v240 offset:28672
    v_accvgpr_mov_b32 a62, a110
    v_mfma_f32_16x16x32_bf16 v[40:43], a[236:239], v[192:195], v[40:43]
    buffer_load_dwordx4 v[148:151], v253, s[8:11], s93 offen offset:3072 sc1
    v_accvgpr_mov_b32 a63, a111
    v_mfma_f32_16x16x32_bf16 v[40:43], a[224:227], v[156:159], v[40:43]
    ds_read_b128 v[216:219], v244 offset:9216
    v_accvgpr_mov_b32 a64, a112
    v_mfma_f32_16x16x32_bf16 v[40:43], a[228:231], v[168:171], v[40:43]
    ds_read_b128 v[220:223], v244 offset:10240
    v_accvgpr_mov_b32 a65, a113
    v_mfma_f32_16x16x32_bf16 v[44:47], a[232:235], v[184:187], v[44:47]
    ds_read_b64_tr_b16 a[232:233], v241 offset:16384
    v_accvgpr_mov_b32 a66, a114
    v_mfma_f32_16x16x32_bf16 v[44:47], a[236:239], v[196:199], v[44:47]
    s_add_u32 s46, s40, 0
    s_add_u32 m0, s41, 0
    ds_read_b64_tr_b16 a[234:235], v241 offset:20480
    v_mfma_f32_16x16x32_bf16 v[44:47], a[224:227], v[160:163], v[44:47]
    buffer_load_dwordx4 v247, s[20:23], s46 offen offset:0 nt lds
    v_accvgpr_mov_b32 a67, a115
    v_mfma_f32_16x16x32_bf16 v[44:47], a[228:231], v[172:175], v[44:47]
    s_waitcnt lgkmcnt(10)
    ds_read_b64_tr_b16 a[236:237], v241 offset:24576
    v_accvgpr_mov_b32 a68, a116
    v_mfma_f32_16x16x32_bf16 v[48:51], a[216:219], v[176:179], v[48:51]
    s_waitcnt lgkmcnt(9)
    ds_read_b64_tr_b16 a[238:239], v241 offset:28672
    v_xor_b32 v241, 0x10000, v241
    v_mfma_f32_16x16x32_bf16 v[48:51], a[220:223], v[188:191], v[48:51]
    s_waitcnt lgkmcnt(8)
    ds_read_b64_tr_b16 a[224:225], v241 offset:16384
    v_accvgpr_mov_b32 a69, a117
    v_mfma_f32_16x16x32_bf16 v[48:51], a[208:211], v[152:155], v[48:51]
    s_waitcnt lgkmcnt(7)
    ds_read_b64_tr_b16 a[226:227], v241 offset:20480
    v_accvgpr_mov_b32 a70, a118
    v_mfma_f32_16x16x32_bf16 v[48:51], a[212:215], v[164:167], v[48:51]
    ds_read_b64_tr_b16 a[228:229], v241 offset:24576
    v_accvgpr_mov_b32 a71, a119
    v_mfma_f32_16x16x32_bf16 v[52:55], a[216:219], v[180:183], v[52:55]
    ds_read_b64_tr_b16 a[230:231], v241 offset:28672
    v_accvgpr_mov_b32 a72, a120
    v_mfma_f32_16x16x32_bf16 v[52:55], a[220:223], v[192:195], v[52:55]
    buffer_load_dwordx4 v248, s[20:23], s46 offen offset:1024 nt lds
    v_accvgpr_mov_b32 a73, a121
    v_mfma_f32_16x16x32_bf16 v[52:55], a[208:211], v[156:159], v[52:55]
    ds_read_b128 v[224:227], v244 offset:11264
    v_accvgpr_mov_b32 a74, a122
    v_mfma_f32_16x16x32_bf16 v[52:55], a[212:215], v[168:171], v[52:55]
    v_accvgpr_mov_b32 a75, a123
    v_accvgpr_mov_b32 a76, a124
    v_mfma_f32_16x16x32_bf16 v[56:59], a[216:219], v[184:187], v[56:59]
    ds_read_b64_tr_b16 a[216:217], v242 offset:16384
    v_accvgpr_mov_b32 a77, a125
    v_mfma_f32_16x16x32_bf16 v[56:59], a[220:223], v[196:199], v[56:59]
    buffer_load_dwordx4 v247, s[20:23], s46 offen offset:2048 nt lds
    v_accvgpr_mov_b32 a78, a126
    v_mfma_f32_16x16x32_bf16 v[56:59], a[208:211], v[160:163], v[56:59]
    ds_read_b64_tr_b16 a[218:219], v242 offset:20480
    v_accvgpr_mov_b32 a79, a127
    v_mfma_f32_16x16x32_bf16 v[56:59], a[212:215], v[172:175], v[56:59]
    s_waitcnt lgkmcnt(9)
    ds_read_b64_tr_b16 a[220:221], v242 offset:24576
    v_accvgpr_mov_b32 a80, a128
    v_mfma_f32_16x16x32_bf16 v[60:63], a[232:235], v[176:179], v[60:63]
    s_waitcnt lgkmcnt(8)
    ds_read_b64_tr_b16 a[222:223], v242 offset:28672
    v_xor_b32 v242, 0x10000, v242
    v_mfma_f32_16x16x32_bf16 v[60:63], a[236:239], v[188:191], v[60:63]
    s_waitcnt lgkmcnt(7)
    ds_read_b64_tr_b16 a[208:209], v242 offset:16384
    v_accvgpr_mov_b32 a81, a129
    v_mfma_f32_16x16x32_bf16 v[60:63], a[224:227], v[152:155], v[60:63]
    s_waitcnt lgkmcnt(6)
    ds_read_b64_tr_b16 a[210:211], v242 offset:20480
    v_accvgpr_mov_b32 a82, a130
    v_mfma_f32_16x16x32_bf16 v[60:63], a[228:231], v[164:167], v[60:63]
    ds_read_b64_tr_b16 a[212:213], v242 offset:24576
    v_accvgpr_mov_b32 a83, a131
    v_mfma_f32_16x16x32_bf16 v[64:67], a[232:235], v[180:183], v[64:67]
    ds_read_b64_tr_b16 a[214:215], v242 offset:28672
    v_accvgpr_mov_b32 a84, a132
    v_mfma_f32_16x16x32_bf16 v[64:67], a[236:239], v[192:195], v[64:67]
    buffer_load_dwordx4 v248, s[20:23], s46 offen offset:3072 nt lds
    v_accvgpr_mov_b32 a85, a133
    v_mfma_f32_16x16x32_bf16 v[64:67], a[224:227], v[156:159], v[64:67]
    v_accvgpr_mov_b32 a86, a134
    v_accvgpr_mov_b32 a87, a135
    v_mfma_f32_16x16x32_bf16 v[64:67], a[228:231], v[168:171], v[64:67]
    v_accvgpr_mov_b32 a88, a136
    v_accvgpr_mov_b32 a89, a137
    v_mfma_f32_16x16x32_bf16 v[68:71], a[232:235], v[184:187], v[68:71]
    ds_read_b64_tr_b16 a[232:233], v243 offset:16384
    v_accvgpr_mov_b32 a90, a138
    v_mfma_f32_16x16x32_bf16 v[68:71], a[236:239], v[196:199], v[68:71]
    s_add_u32 s46, s40, 0
    s_add_u32 m0, s41, 65536
    ds_read_b64_tr_b16 a[234:235], v243 offset:20480
    v_mfma_f32_16x16x32_bf16 v[68:71], a[224:227], v[160:163], v[68:71]
    buffer_load_dwordx4 v247, s[24:27], s46 offen offset:0 nt lds
    v_accvgpr_mov_b32 a91, a139
    v_mfma_f32_16x16x32_bf16 v[68:71], a[228:231], v[172:175], v[68:71]
    s_waitcnt lgkmcnt(8)
    ds_read_b64_tr_b16 a[236:237], v243 offset:24576
    v_accvgpr_mov_b32 a92, a140
    v_mfma_f32_16x16x32_bf16 v[72:75], a[216:219], v[176:179], v[72:75]
    s_waitcnt lgkmcnt(7)
    ds_read_b64_tr_b16 a[238:239], v243 offset:28672
    v_xor_b32 v243, 0x10000, v243
    v_mfma_f32_16x16x32_bf16 v[72:75], a[220:223], v[188:191], v[72:75]
    s_waitcnt lgkmcnt(6)
    ds_read_b64_tr_b16 a[224:225], v243 offset:16384
    v_accvgpr_mov_b32 a93, a141
    v_mfma_f32_16x16x32_bf16 v[72:75], a[208:211], v[152:155], v[72:75]
    s_waitcnt lgkmcnt(5)
    ds_read_b64_tr_b16 a[226:227], v243 offset:20480
    v_accvgpr_mov_b32 a94, a142
    v_mfma_f32_16x16x32_bf16 v[72:75], a[212:215], v[164:167], v[72:75]
    ds_read_b64_tr_b16 a[228:229], v243 offset:24576
    v_accvgpr_mov_b32 a95, a143
    v_mfma_f32_16x16x32_bf16 v[76:79], a[216:219], v[180:183], v[76:79]
    ds_read_b64_tr_b16 a[230:231], v243 offset:28672
    v_accvgpr_mov_b32 a96, a144
    v_mfma_f32_16x16x32_bf16 v[76:79], a[220:223], v[192:195], v[76:79]
    buffer_load_dwordx4 v248, s[24:27], s46 offen offset:1024 nt lds
    v_accvgpr_mov_b32 a97, a145
    v_mfma_f32_16x16x32_bf16 v[76:79], a[208:211], v[156:159], v[76:79]
    v_accvgpr_mov_b32 a98, a146
    v_accvgpr_mov_b32 a99, a147
    v_mfma_f32_16x16x32_bf16 v[76:79], a[212:215], v[168:171], v[76:79]
    v_accvgpr_mov_b32 a100, a148
    v_accvgpr_mov_b32 a101, a149
    v_mfma_f32_16x16x32_bf16 v[80:83], a[216:219], v[184:187], v[80:83]
    v_accvgpr_mov_b32 a102, a150
    v_accvgpr_mov_b32 a103, a151
    v_mfma_f32_16x16x32_bf16 v[80:83], a[220:223], v[196:199], v[80:83]
    buffer_load_dwordx4 v247, s[24:27], s46 offen offset:2048 nt lds
    v_accvgpr_mov_b32 a104, a152
    v_mfma_f32_16x16x32_bf16 v[80:83], a[208:211], v[160:163], v[80:83]
    v_accvgpr_mov_b32 a105, a153
    v_accvgpr_mov_b32 a106, a154
    v_mfma_f32_16x16x32_bf16 v[80:83], a[212:215], v[172:175], v[80:83]
    s_waitcnt lgkmcnt(0)
    v_accvgpr_mov_b32 a107, a155
    v_accvgpr_mov_b32 a108, a156
    s_barrier
    v_mfma_f32_16x16x32_bf16 v[84:87], a[232:235], v[176:179], v[84:87]
    ds_read_b64_tr_b16 a[208:209], v236 offset:32768
    v_accvgpr_mov_b32 a109, a157
    v_mfma_f32_16x16x32_bf16 v[84:87], a[236:239], v[188:191], v[84:87]
    ds_read_b64_tr_b16 a[210:211], v236 offset:36864
    v_accvgpr_mov_b32 a110, a158
    v_mfma_f32_16x16x32_bf16 v[84:87], a[224:227], v[152:155], v[84:87]
    ds_read_b64_tr_b16 a[212:213], v236 offset:40960
    v_accvgpr_mov_b32 a111, a159
    v_mfma_f32_16x16x32_bf16 v[84:87], a[228:231], v[164:167], v[84:87]
    ds_read_b64_tr_b16 a[214:215], v236 offset:45056
    v_xor_b32 v236, 0x10000, v236
    v_mfma_f32_16x16x32_bf16 v[88:91], a[232:235], v[180:183], v[88:91]
    ds_read_b64_tr_b16 a[216:217], v236 offset:32768
    v_accvgpr_mov_b32 a112, a160
    v_mfma_f32_16x16x32_bf16 v[88:91], a[236:239], v[192:195], v[88:91]
    ds_read_b64_tr_b16 a[218:219], v236 offset:36864
    v_accvgpr_mov_b32 a113, a161
    v_mfma_f32_16x16x32_bf16 v[88:91], a[224:227], v[156:159], v[88:91]
    buffer_load_dwordx4 v248, s[24:27], s46 offen offset:3072 nt lds
    v_accvgpr_mov_b32 a114, a162
    v_mfma_f32_16x16x32_bf16 v[88:91], a[228:231], v[168:171], v[88:91]
    ds_read_b64_tr_b16 a[220:221], v236 offset:40960
    v_accvgpr_mov_b32 a115, a163
    v_mfma_f32_16x16x32_bf16 v[92:95], a[232:235], v[184:187], v[92:95]
    ds_read_b64_tr_b16 a[222:223], v236 offset:45056
    v_accvgpr_mov_b32 a116, a164
    v_mfma_f32_16x16x32_bf16 v[92:95], a[236:239], v[196:199], v[92:95]
    v_accvgpr_mov_b32 a117, a165
    v_accvgpr_mov_b32 a118, a166
    v_mfma_f32_16x16x32_bf16 v[92:95], a[224:227], v[160:163], v[92:95]
    ds_read_b64_tr_b16 a[224:225], v237 offset:32768
    v_accvgpr_mov_b32 a119, a167
    v_mfma_f32_16x16x32_bf16 v[92:95], a[228:231], v[172:175], v[92:95]
    s_waitcnt vmcnt(19) lgkmcnt(7)
    ds_read_b64_tr_b16 a[226:227], v237 offset:36864
    v_accvgpr_mov_b32 a120, a168
    v_mfma_f32_16x16x32_bf16 v[0:3], a[208:211], v[104:107], v[0:3]
    s_waitcnt vmcnt(16) lgkmcnt(6)
    ds_read_b64_tr_b16 a[228:229], v237 offset:40960
    v_accvgpr_mov_b32 a121, a169
    v_mfma_f32_16x16x32_bf16 v[0:3], a[212:215], v[116:119], v[0:3]
    s_waitcnt vmcnt(13) lgkmcnt(5)
    ds_read_b64_tr_b16 a[230:231], v237 offset:45056
    v_xor_b32 v237, 0x10000, v237
    v_mfma_f32_16x16x32_bf16 v[0:3], a[216:219], v[128:131], v[0:3]
    s_waitcnt vmcnt(10) lgkmcnt(4)
    ds_read_b64_tr_b16 a[232:233], v237 offset:32768
    v_accvgpr_mov_b32 a122, a170
    v_mfma_f32_16x16x32_bf16 v[0:3], a[220:223], v[140:143], v[0:3]
    buffer_load_dwordx4 v[152:155], v251, s[8:11], s94 offen offset:0 sc1
    v_accvgpr_mov_b32 a123, a171
    v_mfma_f32_16x16x32_bf16 v[4:7], a[208:211], v[108:111], v[4:7]
    ds_read_b64_tr_b16 a[234:235], v237 offset:36864
    v_accvgpr_mov_b32 a124, a172
    v_mfma_f32_16x16x32_bf16 v[4:7], a[212:215], v[120:123], v[4:7]
    ds_read_b64_tr_b16 a[236:237], v237 offset:40960
    v_accvgpr_mov_b32 a125, a173
    v_mfma_f32_16x16x32_bf16 v[4:7], a[216:219], v[132:135], v[4:7]
    s_waitcnt vmcnt(10)
    ds_read_b64_tr_b16 a[238:239], v237 offset:45056
    v_accvgpr_mov_b32 a126, a174
    v_mfma_f32_16x16x32_bf16 v[4:7], a[220:223], v[144:147], v[4:7]
    buffer_load_dwordx4 v[156:159], v252, s[8:11], s94 offen offset:0 sc1
    v_accvgpr_mov_b32 a127, a175
    v_mfma_f32_16x16x32_bf16 v[8:11], a[208:211], v[112:115], v[8:11]
    v_accvgpr_mov_b32 a128, a176
    v_accvgpr_mov_b32 a129, a177
    v_mfma_f32_16x16x32_bf16 v[8:11], a[212:215], v[124:127], v[8:11]
    v_accvgpr_mov_b32 a130, a178
    v_accvgpr_mov_b32 a131, a179
    v_mfma_f32_16x16x32_bf16 v[8:11], a[216:219], v[136:139], v[8:11]
    s_waitcnt vmcnt(10)
    v_accvgpr_mov_b32 a132, a180
    v_accvgpr_mov_b32 a133, a181
    v_mfma_f32_16x16x32_bf16 v[8:11], a[220:223], v[148:151], v[8:11]
    buffer_load_dwordx4 v[160:163], v253, s[8:11], s94 offen offset:0 sc1
    v_accvgpr_mov_b32 a134, a182
    v_mfma_f32_16x16x32_bf16 v[96:99], a[208:211], v[212:215], v[96:99]
    ds_read_b64_tr_b16 a[208:209], v238 offset:32768
    v_accvgpr_mov_b32 a135, a183
    v_mfma_f32_16x16x32_bf16 v[96:99], a[212:215], v[216:219], v[96:99]
    ds_read_b64_tr_b16 a[210:211], v238 offset:36864
    v_accvgpr_mov_b32 a136, a184
    v_mfma_f32_16x16x32_bf16 v[96:99], a[216:219], v[220:223], v[96:99]
    ds_read_b64_tr_b16 a[212:213], v238 offset:40960
    v_accvgpr_mov_b32 a137, a185
    v_mfma_f32_16x16x32_bf16 v[96:99], a[220:223], v[224:227], v[96:99]
    s_waitcnt lgkmcnt(9)
    buffer_load_dwordx4 v[164:167], v251, s[8:11], s94 offen offset:1024 sc1
    v_accvgpr_mov_b32 a138, a186
    v_mfma_f32_16x16x32_bf16 v[12:15], a[224:227], v[104:107], v[12:15]
    s_waitcnt lgkmcnt(7)
    ds_read_b64_tr_b16 a[214:215], v238 offset:45056
    v_xor_b32 v238, 0x10000, v238
    v_mfma_f32_16x16x32_bf16 v[12:15], a[228:231], v[116:119], v[12:15]
    s_waitcnt lgkmcnt(6)
    ds_read_b64_tr_b16 a[216:217], v238 offset:32768
    v_accvgpr_mov_b32 a139, a187
    v_mfma_f32_16x16x32_bf16 v[12:15], a[232:235], v[128:131], v[12:15]
    s_waitcnt lgkmcnt(5)
    ds_read_b64_tr_b16 a[218:219], v238 offset:36864
    v_accvgpr_mov_b32 a140, a188
    v_mfma_f32_16x16x32_bf16 v[12:15], a[236:239], v[140:143], v[12:15]
    buffer_load_dwordx4 v[168:171], v252, s[8:11], s94 offen offset:1024 sc1
    v_accvgpr_mov_b32 a141, a189
    v_mfma_f32_16x16x32_bf16 v[16:19], a[224:227], v[108:111], v[16:19]
    ds_read_b64_tr_b16 a[220:221], v238 offset:40960
    v_accvgpr_mov_b32 a142, a190
    v_mfma_f32_16x16x32_bf16 v[16:19], a[228:231], v[120:123], v[16:19]
    ds_read_b64_tr_b16 a[222:223], v238 offset:45056
    v_accvgpr_mov_b32 a143, a191
    v_mfma_f32_16x16x32_bf16 v[16:19], a[232:235], v[132:135], v[16:19]
    v_mfma_f32_16x16x32_bf16 v[16:19], a[236:239], v[144:147], v[16:19]
    buffer_load_dwordx4 v[172:175], v253, s[8:11], s94 offen offset:1024 sc1
    v_mfma_f32_16x16x32_bf16 v[20:23], a[224:227], v[112:115], v[20:23]
    v_mfma_f32_16x16x32_bf16 v[20:23], a[228:231], v[124:127], v[20:23]
    v_mfma_f32_16x16x32_bf16 v[20:23], a[232:235], v[136:139], v[20:23]
    v_mfma_f32_16x16x32_bf16 v[20:23], a[236:239], v[148:151], v[20:23]
    buffer_load_dwordx4 v[176:179], v251, s[8:11], s94 offen offset:2048 sc1
    v_mfma_f32_16x16x32_bf16 v[100:103], a[224:227], v[212:215], v[100:103]
    ds_read_b64_tr_b16 a[224:225], v239 offset:32768
    v_mfma_f32_16x16x32_bf16 v[100:103], a[228:231], v[216:219], v[100:103]
    ds_read_b64_tr_b16 a[226:227], v239 offset:36864
    v_mfma_f32_16x16x32_bf16 v[100:103], a[232:235], v[220:223], v[100:103]
    ds_read_b64_tr_b16 a[228:229], v239 offset:40960
    v_mfma_f32_16x16x32_bf16 v[100:103], a[236:239], v[224:227], v[100:103]
    s_waitcnt lgkmcnt(9)
    buffer_load_dwordx4 v[180:183], v252, s[8:11], s94 offen offset:2048 sc1
    v_mfma_f32_16x16x32_bf16 v[24:27], a[208:211], v[104:107], v[24:27]
    s_waitcnt lgkmcnt(7)
    ds_read_b64_tr_b16 a[230:231], v239 offset:45056
    v_xor_b32 v239, 0x10000, v239
    v_mfma_f32_16x16x32_bf16 v[24:27], a[212:215], v[116:119], v[24:27]
    s_waitcnt lgkmcnt(6)
    ds_read_b64_tr_b16 a[232:233], v239 offset:32768
    v_mfma_f32_16x16x32_bf16 v[24:27], a[216:219], v[128:131], v[24:27]
    s_waitcnt lgkmcnt(5)
    ds_read_b64_tr_b16 a[234:235], v239 offset:36864
    v_mfma_f32_16x16x32_bf16 v[24:27], a[220:223], v[140:143], v[24:27]
    ds_read_b64_tr_b16 a[236:237], v239 offset:40960
    v_mfma_f32_16x16x32_bf16 v[28:31], a[208:211], v[108:111], v[28:31]
    ds_read_b64_tr_b16 a[238:239], v239 offset:45056
    v_mfma_f32_16x16x32_bf16 v[28:31], a[212:215], v[120:123], v[28:31]
    buffer_load_dwordx4 v[184:187], v253, s[8:11], s94 offen offset:2048 sc1
    v_mfma_f32_16x16x32_bf16 v[28:31], a[216:219], v[132:135], v[28:31]
    ds_read_b128 v[220:223], v244 offset:14336
    v_mfma_f32_16x16x32_bf16 v[28:31], a[220:223], v[144:147], v[28:31]
    buffer_load_dwordx4 v[188:191], v251, s[8:11], s94 offen offset:3072 sc1
    v_mfma_f32_16x16x32_bf16 v[32:35], a[208:211], v[112:115], v[32:35]
    ds_read_b64_tr_b16 a[208:209], v240 offset:32768
    v_mfma_f32_16x16x32_bf16 v[32:35], a[212:215], v[124:127], v[32:35]
    ds_read_b64_tr_b16 a[210:211], v240 offset:36864
    v_mfma_f32_16x16x32_bf16 v[32:35], a[216:219], v[136:139], v[32:35]
    ds_read_b64_tr_b16 a[212:213], v240 offset:40960
    v_mfma_f32_16x16x32_bf16 v[32:35], a[220:223], v[148:151], v[32:35]
    s_waitcnt lgkmcnt(10)
    buffer_load_dwordx4 v[192:195], v252, s[8:11], s94 offen offset:3072 sc1
    v_mfma_f32_16x16x32_bf16 v[36:39], a[224:227], v[104:107], v[36:39]
    s_waitcnt lgkmcnt(8)
    ds_read_b64_tr_b16 a[214:215], v240 offset:45056
    v_xor_b32 v240, 0x10000, v240
    v_mfma_f32_16x16x32_bf16 v[36:39], a[228:231], v[116:119], v[36:39]
    s_waitcnt lgkmcnt(7)
    ds_read_b64_tr_b16 a[216:217], v240 offset:32768
    v_mfma_f32_16x16x32_bf16 v[36:39], a[232:235], v[128:131], v[36:39]
    s_waitcnt lgkmcnt(6)
    ds_read_b64_tr_b16 a[218:219], v240 offset:36864
    v_mfma_f32_16x16x32_bf16 v[36:39], a[236:239], v[140:143], v[36:39]
    ds_read_b64_tr_b16 a[220:221], v240 offset:40960
    v_mfma_f32_16x16x32_bf16 v[40:43], a[224:227], v[108:111], v[40:43]
    ds_read_b64_tr_b16 a[222:223], v240 offset:45056
    v_mfma_f32_16x16x32_bf16 v[40:43], a[228:231], v[120:123], v[40:43]
    buffer_load_dwordx4 v[196:199], v253, s[8:11], s94 offen offset:3072 sc1
    v_mfma_f32_16x16x32_bf16 v[40:43], a[232:235], v[132:135], v[40:43]
    ds_read_b128 v[224:227], v244 offset:15360
    v_mfma_f32_16x16x32_bf16 v[40:43], a[236:239], v[144:147], v[40:43]
    ds_read_b128 v[212:215], v244 offset:12288
    v_mfma_f32_16x16x32_bf16 v[44:47], a[224:227], v[112:115], v[44:47]
    ds_read_b64_tr_b16 a[224:225], v241 offset:32768
    v_mfma_f32_16x16x32_bf16 v[44:47], a[228:231], v[124:127], v[44:47]
    s_add_u32 s46, s40, 16384
    s_add_u32 m0, s41, 16384
    ds_read_b64_tr_b16 a[226:227], v241 offset:36864
    v_mfma_f32_16x16x32_bf16 v[44:47], a[232:235], v[136:139], v[44:47]
    buffer_load_dwordx4 v247, s[20:23], s46 offen offset:0 nt lds
    v_mfma_f32_16x16x32_bf16 v[44:47], a[236:239], v[148:151], v[44:47]
    s_waitcnt lgkmcnt(10)
    ds_read_b64_tr_b16 a[228:229], v241 offset:40960
    v_mfma_f32_16x16x32_bf16 v[48:51], a[208:211], v[104:107], v[48:51]
    s_waitcnt lgkmcnt(9)
    ds_read_b64_tr_b16 a[230:231], v241 offset:45056
    v_xor_b32 v241, 0x10000, v241
    v_mfma_f32_16x16x32_bf16 v[48:51], a[212:215], v[116:119], v[48:51]
    s_waitcnt lgkmcnt(8)
    ds_read_b64_tr_b16 a[232:233], v241 offset:32768
    v_mfma_f32_16x16x32_bf16 v[48:51], a[216:219], v[128:131], v[48:51]
    s_waitcnt lgkmcnt(7)
    ds_read_b64_tr_b16 a[234:235], v241 offset:36864
    v_mfma_f32_16x16x32_bf16 v[48:51], a[220:223], v[140:143], v[48:51]
    ds_read_b64_tr_b16 a[236:237], v241 offset:40960
    v_mfma_f32_16x16x32_bf16 v[52:55], a[208:211], v[108:111], v[52:55]
    ds_read_b64_tr_b16 a[238:239], v241 offset:45056
    v_mfma_f32_16x16x32_bf16 v[52:55], a[212:215], v[120:123], v[52:55]
    buffer_load_dwordx4 v248, s[20:23], s46 offen offset:1024 nt lds
    v_mfma_f32_16x16x32_bf16 v[52:55], a[216:219], v[132:135], v[52:55]
    ds_read_b128 v[216:219], v244 offset:13312
    v_mfma_f32_16x16x32_bf16 v[52:55], a[220:223], v[144:147], v[52:55]
    v_mfma_f32_16x16x32_bf16 v[56:59], a[208:211], v[112:115], v[56:59]
    ds_read_b64_tr_b16 a[208:209], v242 offset:32768
    v_mfma_f32_16x16x32_bf16 v[56:59], a[212:215], v[124:127], v[56:59]
    buffer_load_dwordx4 v247, s[20:23], s46 offen offset:2048 nt lds
    v_mfma_f32_16x16x32_bf16 v[56:59], a[216:219], v[136:139], v[56:59]
    ds_read_b64_tr_b16 a[210:211], v242 offset:36864
    v_mfma_f32_16x16x32_bf16 v[56:59], a[220:223], v[148:151], v[56:59]
    s_waitcnt lgkmcnt(9)
    ds_read_b64_tr_b16 a[212:213], v242 offset:40960
    v_mfma_f32_16x16x32_bf16 v[60:63], a[224:227], v[104:107], v[60:63]
    s_waitcnt lgkmcnt(8)
    ds_read_b64_tr_b16 a[214:215], v242 offset:45056
    v_xor_b32 v242, 0x10000, v242
    v_mfma_f32_16x16x32_bf16 v[60:63], a[228:231], v[116:119], v[60:63]
    s_waitcnt lgkmcnt(7)
    ds_read_b64_tr_b16 a[216:217], v242 offset:32768
    v_mfma_f32_16x16x32_bf16 v[60:63], a[232:235], v[128:131], v[60:63]
    s_waitcnt lgkmcnt(6)
    ds_read_b64_tr_b16 a[218:219], v242 offset:36864
    v_mfma_f32_16x16x32_bf16 v[60:63], a[236:239], v[140:143], v[60:63]
    ds_read_b64_tr_b16 a[220:221], v242 offset:40960
    v_mfma_f32_16x16x32_bf16 v[64:67], a[224:227], v[108:111], v[64:67]
    ds_read_b64_tr_b16 a[222:223], v242 offset:45056
    v_mfma_f32_16x16x32_bf16 v[64:67], a[228:231], v[120:123], v[64:67]
    buffer_load_dwordx4 v248, s[20:23], s46 offen offset:3072 nt lds
    v_mfma_f32_16x16x32_bf16 v[64:67], a[232:235], v[132:135], v[64:67]
    v_mfma_f32_16x16x32_bf16 v[64:67], a[236:239], v[144:147], v[64:67]
    v_mfma_f32_16x16x32_bf16 v[68:71], a[224:227], v[112:115], v[68:71]
    ds_read_b64_tr_b16 a[224:225], v243 offset:32768
    v_mfma_f32_16x16x32_bf16 v[68:71], a[228:231], v[124:127], v[68:71]
    s_add_u32 s46, s40, 16384
    s_add_u32 m0, s41, 81920
    ds_read_b64_tr_b16 a[226:227], v243 offset:36864
    v_mfma_f32_16x16x32_bf16 v[68:71], a[232:235], v[136:139], v[68:71]
    buffer_load_dwordx4 v247, s[24:27], s46 offen offset:0 nt lds
    v_mfma_f32_16x16x32_bf16 v[68:71], a[236:239], v[148:151], v[68:71]
    s_waitcnt lgkmcnt(8)
    ds_read_b64_tr_b16 a[228:229], v243 offset:40960
    v_mfma_f32_16x16x32_bf16 v[72:75], a[208:211], v[104:107], v[72:75]
    s_waitcnt lgkmcnt(7)
    ds_read_b64_tr_b16 a[230:231], v243 offset:45056
    v_xor_b32 v243, 0x10000, v243
    v_mfma_f32_16x16x32_bf16 v[72:75], a[212:215], v[116:119], v[72:75]
    s_waitcnt lgkmcnt(6)
    ds_read_b64_tr_b16 a[232:233], v243 offset:32768
    v_mfma_f32_16x16x32_bf16 v[72:75], a[216:219], v[128:131], v[72:75]
    s_waitcnt lgkmcnt(5)
    ds_read_b64_tr_b16 a[234:235], v243 offset:36864
    ds_read_b64_tr_b16 a[236:237], v243 offset:40960
    v_mfma_f32_16x16x32_bf16 v[72:75], a[220:223], v[140:143], v[72:75]
    ds_read_b64_tr_b16 a[238:239], v243 offset:45056
    v_mfma_f32_16x16x32_bf16 v[76:79], a[208:211], v[108:111], v[76:79]
    buffer_load_dwordx4 v248, s[24:27], s46 offen offset:1024 nt lds
    v_mfma_f32_16x16x32_bf16 v[76:79], a[212:215], v[120:123], v[76:79]
    v_mfma_f32_16x16x32_bf16 v[76:79], a[216:219], v[132:135], v[76:79]
    v_mfma_f32_16x16x32_bf16 v[76:79], a[220:223], v[144:147], v[76:79]
    v_mfma_f32_16x16x32_bf16 v[80:83], a[208:211], v[112:115], v[80:83]
    v_mfma_f32_16x16x32_bf16 v[80:83], a[212:215], v[124:127], v[80:83]
    buffer_load_dwordx4 v247, s[24:27], s46 offen offset:2048 nt lds
    v_mfma_f32_16x16x32_bf16 v[80:83], a[216:219], v[136:139], v[80:83]
    v_mfma_f32_16x16x32_bf16 v[80:83], a[220:223], v[148:151], v[80:83]
    s_waitcnt lgkmcnt(0)
    s_barrier
    v_mfma_f32_16x16x32_bf16 v[84:87], a[224:227], v[104:107], v[84:87]
    ds_read_b64_tr_b16 a[216:217], v236 offset:49152
    v_mfma_f32_16x16x32_bf16 v[84:87], a[228:231], v[116:119], v[84:87]
    ds_read_b64_tr_b16 a[218:219], v236 offset:53248
    v_mfma_f32_16x16x32_bf16 v[84:87], a[232:235], v[128:131], v[84:87]
    ds_read_b64_tr_b16 a[220:221], v236 offset:57344
    v_mfma_f32_16x16x32_bf16 v[84:87], a[236:239], v[140:143], v[84:87]
    ds_read_b64_tr_b16 a[222:223], v236 offset:61440
    v_xor_b32 v236, 0x10000, v236
    v_mfma_f32_16x16x32_bf16 v[88:91], a[224:227], v[108:111], v[88:91]
    ds_read_b64_tr_b16 a[208:209], v236 offset:49152
    v_mfma_f32_16x16x32_bf16 v[88:91], a[228:231], v[120:123], v[88:91]
    ds_read_b64_tr_b16 a[210:211], v236 offset:53248
    v_mfma_f32_16x16x32_bf16 v[88:91], a[232:235], v[132:135], v[88:91]
    buffer_load_dwordx4 v248, s[24:27], s46 offen offset:3072 nt lds
    v_mfma_f32_16x16x32_bf16 v[88:91], a[236:239], v[144:147], v[88:91]
    ds_read_b64_tr_b16 a[212:213], v236 offset:57344
    v_mfma_f32_16x16x32_bf16 v[92:95], a[224:227], v[112:115], v[92:95]
    ds_read_b64_tr_b16 a[214:215], v236 offset:61440
    v_mfma_f32_16x16x32_bf16 v[92:95], a[228:231], v[124:127], v[92:95]
    v_mfma_f32_16x16x32_bf16 v[92:95], a[232:235], v[136:139], v[92:95]
    ds_read_b64_tr_b16 a[232:233], v237 offset:49152
    v_mfma_f32_16x16x32_bf16 v[92:95], a[236:239], v[148:151], v[92:95]
    s_waitcnt vmcnt(13) lgkmcnt(7)
    ds_read_b64_tr_b16 a[234:235], v237 offset:53248
    v_mfma_f32_16x16x32_bf16 v[0:3], a[216:219], v[176:179], v[0:3]
    s_waitcnt vmcnt(10) lgkmcnt(6)
    ds_read_b64_tr_b16 a[236:237], v237 offset:57344
    v_mfma_f32_16x16x32_bf16 v[0:3], a[220:223], v[188:191], v[0:3]
    s_waitcnt lgkmcnt(5)
    ds_read_b64_tr_b16 a[238:239], v237 offset:61440
    v_xor_b32 v237, 0x10000, v237
    v_mfma_f32_16x16x32_bf16 v[0:3], a[208:211], v[152:155], v[0:3]
    s_waitcnt lgkmcnt(4)
    ds_read_b64_tr_b16 a[224:225], v237 offset:49152
    v_mfma_f32_16x16x32_bf16 v[0:3], a[212:215], v[164:167], v[0:3]
    ds_read_b64_tr_b16 a[226:227], v237 offset:53248
    v_mfma_f32_16x16x32_bf16 v[4:7], a[216:219], v[180:183], v[4:7]
    s_waitcnt vmcnt(9)
    ds_read_b64_tr_b16 a[228:229], v237 offset:57344
    v_mfma_f32_16x16x32_bf16 v[4:7], a[220:223], v[192:195], v[4:7]
    ds_read_b64_tr_b16 a[230:231], v237 offset:61440
    v_mfma_f32_16x16x32_bf16 v[4:7], a[208:211], v[156:159], v[4:7]
    v_mfma_f32_16x16x32_bf16 v[4:7], a[212:215], v[168:171], v[4:7]
    s_add_u32 s46, s40, 32768
    s_add_u32 m0, s41, 32768
    v_mul_f32 v0, s54, v0
    v_mfma_f32_16x16x32_bf16 v[8:11], a[216:219], v[184:187], v[8:11]
    s_waitcnt vmcnt(8)
    buffer_load_dwordx4 v247, s[20:23], s46 offen offset:0 nt lds
    v_mul_f32 v1, s54, v1
    v_mfma_f32_16x16x32_bf16 v[8:11], a[220:223], v[196:199], v[8:11]
    v_mul_f32 v4, s54, v4
    v_mul_f32 v5, s54, v5
    v_mfma_f32_16x16x32_bf16 v[8:11], a[208:211], v[160:163], v[8:11]
    v_mul_f32 v2, s54, v2
    v_mul_f32 v3, s54, v3
    v_mfma_f32_16x16x32_bf16 v[8:11], a[212:215], v[172:175], v[8:11]
    v_cvt_pk_bf16_f32 v0, v0, v1
    v_mul_f32 v6, s54, v6
    v_mfma_f32_16x16x32_bf16 v[96:99], a[216:219], v[220:223], v[96:99]
    ds_read_b64_tr_b16 a[216:217], v238 offset:49152
    v_mul_f32 v7, s54, v7
    v_mfma_f32_16x16x32_bf16 v[96:99], a[220:223], v[224:227], v[96:99]
    buffer_load_dwordx4 v248, s[20:23], s46 offen offset:1024 nt lds
    v_cvt_pk_bf16_f32 v4, v4, v5
    v_mfma_f32_16x16x32_bf16 v[96:99], a[208:211], v[212:215], v[96:99]
    ds_read_b64_tr_b16 a[218:219], v238 offset:53248
    v_mul_f32 v8, s54, v8
    v_mfma_f32_16x16x32_bf16 v[96:99], a[212:215], v[216:219], v[96:99]
    s_waitcnt lgkmcnt(8)
    ds_read_b64_tr_b16 a[220:221], v238 offset:57344
    v_mul_f32 v9, s54, v9
    v_mfma_f32_16x16x32_bf16 v[12:15], a[232:235], v[176:179], v[12:15]
    s_waitcnt lgkmcnt(7)
    ds_read_b64_tr_b16 a[222:223], v238 offset:61440
    v_xor_b32 v238, 0x10000, v238
    v_mfma_f32_16x16x32_bf16 v[12:15], a[236:239], v[188:191], v[12:15]
    s_waitcnt lgkmcnt(6)
    ds_read_b64_tr_b16 a[208:209], v238 offset:49152
    v_mul_f32 v96, s54, v96
    v_mfma_f32_16x16x32_bf16 v[12:15], a[224:227], v[152:155], v[12:15]
    s_waitcnt lgkmcnt(5)
    ds_read_b64_tr_b16 a[210:211], v238 offset:53248
    v_mul_f32 v97, s54, v97
    v_mfma_f32_16x16x32_bf16 v[12:15], a[228:231], v[164:167], v[12:15]
    buffer_load_dwordx4 v247, s[20:23], s46 offen offset:2048 nt lds
    v_mul_f32 v98, s54, v98
    v_mfma_f32_16x16x32_bf16 v[16:19], a[232:235], v[180:183], v[16:19]
    ds_read_b64_tr_b16 a[212:213], v238 offset:57344
    v_mul_f32 v99, s54, v99
    v_mfma_f32_16x16x32_bf16 v[16:19], a[236:239], v[192:195], v[16:19]
    ds_read_b64_tr_b16 a[214:215], v238 offset:61440
    v_cvt_pk_bf16_f32 v96, v96, v97
    v_mfma_f32_16x16x32_bf16 v[16:19], a[224:227], v[156:159], v[16:19]
    v_mul_f32 v12, s54, v12
    v_mul_f32 v13, s54, v13
    v_mfma_f32_16x16x32_bf16 v[16:19], a[228:231], v[168:171], v[16:19]
    v_mul_f32 v14, s54, v14
    v_mul_f32 v15, s54, v15
    v_mfma_f32_16x16x32_bf16 v[20:23], a[232:235], v[184:187], v[20:23]
    v_cvt_pk_bf16_f32 v12, v12, v13
    v_mul_f32 v10, s54, v10
    v_mfma_f32_16x16x32_bf16 v[20:23], a[236:239], v[196:199], v[20:23]
    buffer_load_dwordx4 v248, s[20:23], s46 offen offset:3072 nt lds
    v_mul_f32 v11, s54, v11
    v_mfma_f32_16x16x32_bf16 v[20:23], a[224:227], v[160:163], v[20:23]
    v_mul_f32 v16, s54, v16
    v_mul_f32 v17, s54, v17
    v_mfma_f32_16x16x32_bf16 v[20:23], a[228:231], v[172:175], v[20:23]
    v_mul_f32 v18, s54, v18
    v_mul_f32 v19, s54, v19
    v_mfma_f32_16x16x32_bf16 v[100:103], a[232:235], v[220:223], v[100:103]
    ds_read_b64_tr_b16 a[232:233], v239 offset:49152
    v_cvt_pk_bf16_f32 v16, v16, v17
    v_mfma_f32_16x16x32_bf16 v[100:103], a[236:239], v[224:227], v[100:103]
    ds_read_b64_tr_b16 a[234:235], v239 offset:53248
    v_cvt_pk_bf16_f32 v8, v8, v9
    v_mfma_f32_16x16x32_bf16 v[100:103], a[224:227], v[212:215], v[100:103]
    ds_read_b64_tr_b16 a[236:237], v239 offset:57344
    v_mul_f32 v20, s54, v20
    v_mfma_f32_16x16x32_bf16 v[100:103], a[228:231], v[216:219], v[100:103]
    s_waitcnt lgkmcnt(9)
    ds_read_b64_tr_b16 a[238:239], v239 offset:61440
    v_xor_b32 v239, 0x10000, v239
    v_mfma_f32_16x16x32_bf16 v[24:27], a[216:219], v[176:179], v[24:27]
    s_waitcnt lgkmcnt(8)
    ds_read_b64_tr_b16 a[224:225], v239 offset:49152
    v_mul_f32 v21, s54, v21
    v_mfma_f32_16x16x32_bf16 v[24:27], a[220:223], v[188:191], v[24:27]
    s_waitcnt lgkmcnt(7)
    ds_read_b64_tr_b16 a[226:227], v239 offset:53248
    v_mul_f32 v22, s54, v22
    v_mfma_f32_16x16x32_bf16 v[24:27], a[208:211], v[152:155], v[24:27]
    s_waitcnt lgkmcnt(6)
    ds_read_b64_tr_b16 a[228:229], v239 offset:57344
    v_mul_f32 v23, s54, v23
    v_mfma_f32_16x16x32_bf16 v[24:27], a[212:215], v[164:167], v[24:27]
    ds_read_b64_tr_b16 a[230:231], v239 offset:61440
    v_cvt_pk_bf16_f32 v20, v20, v21
    v_mfma_f32_16x16x32_bf16 v[28:31], a[216:219], v[180:183], v[28:31]
    v_mul_f32 v100, s54, v100
    v_mul_f32 v101, s54, v101
    v_mfma_f32_16x16x32_bf16 v[28:31], a[220:223], v[192:195], v[28:31]
    v_mul_f32 v102, s54, v102
    v_mul_f32 v103, s54, v103
    v_mfma_f32_16x16x32_bf16 v[28:31], a[208:211], v[156:159], v[28:31]
    v_mul_f32 v24, s54, v24
    v_mul_f32 v25, s54, v25
    v_mfma_f32_16x16x32_bf16 v[28:31], a[212:215], v[168:171], v[28:31]
    v_cvt_pk_bf16_f32 v97, v98, v99
    v_mul_f32 v26, s54, v26
    v_mfma_f32_16x16x32_bf16 v[32:35], a[216:219], v[184:187], v[32:35]
    ds_read_b64_tr_b16 a[216:217], v240 offset:49152
    v_mul_f32 v27, s54, v27
    v_mfma_f32_16x16x32_bf16 v[32:35], a[220:223], v[196:199], v[32:35]
    ds_read_b64_tr_b16 a[218:219], v240 offset:53248
    v_cvt_pk_bf16_f32 v24, v24, v25
    v_mfma_f32_16x16x32_bf16 v[32:35], a[208:211], v[160:163], v[32:35]
    ds_read_b64_tr_b16 a[220:221], v240 offset:57344
    v_mul_f32 v28, s54, v28
    v_mfma_f32_16x16x32_bf16 v[32:35], a[212:215], v[172:175], v[32:35]
    s_waitcnt lgkmcnt(9)
    s_add_u32 s46, s40, 32768
    ds_read_b64_tr_b16 a[222:223], v240 offset:61440
    v_mfma_f32_16x16x32_bf16 v[36:39], a[232:235], v[176:179], v[36:39]
    s_waitcnt lgkmcnt(8)
    s_add_u32 m0, s41, 98304
    v_xor_b32 v240, 0x10000, v240
    v_mfma_f32_16x16x32_bf16 v[36:39], a[236:239], v[188:191], v[36:39]
    s_waitcnt lgkmcnt(6)
    buffer_load_dwordx4 v247, s[24:27], s46 offen offset:0 nt lds
    v_mul_f32 v29, s54, v29
    v_mfma_f32_16x16x32_bf16 v[36:39], a[224:227], v[152:155], v[36:39]
    s_waitcnt lgkmcnt(4)
    ds_read_b64_tr_b16 a[208:209], v240 offset:49152
    v_mul_f32 v32, s54, v32
    v_mfma_f32_16x16x32_bf16 v[36:39], a[228:231], v[164:167], v[36:39]
    ds_read_b64_tr_b16 a[210:211], v240 offset:53248
    v_mul_f32 v33, s54, v33
    v_mfma_f32_16x16x32_bf16 v[40:43], a[232:235], v[180:183], v[40:43]
    ds_read_b64_tr_b16 a[212:213], v240 offset:57344
    v_mul_f32 v30, s54, v30
    v_mfma_f32_16x16x32_bf16 v[40:43], a[236:239], v[192:195], v[40:43]
    ds_read_b64_tr_b16 a[214:215], v240 offset:61440
    v_mul_f32 v31, s54, v31
    v_mfma_f32_16x16x32_bf16 v[40:43], a[224:227], v[156:159], v[40:43]
    buffer_load_dwordx4 v248, s[24:27], s46 offen offset:1024 nt lds
    v_mul_f32 v36, s54, v36
    v_mfma_f32_16x16x32_bf16 v[40:43], a[228:231], v[168:171], v[40:43]
    v_mul_f32 v37, s54, v37
    v_mul_f32 v38, s54, v38
    v_mfma_f32_16x16x32_bf16 v[44:47], a[232:235], v[184:187], v[44:47]
    ds_read_b64_tr_b16 a[232:233], v241 offset:49152
    v_mul_f32 v39, s54, v39
    v_mfma_f32_16x16x32_bf16 v[44:47], a[236:239], v[196:199], v[44:47]
    ds_read_b64_tr_b16 a[234:235], v241 offset:53248
    v_cvt_pk_bf16_f32 v36, v36, v37
    v_mfma_f32_16x16x32_bf16 v[44:47], a[224:227], v[160:163], v[44:47]
    ds_read_b64_tr_b16 a[236:237], v241 offset:57344
    v_mul_f32 v40, s54, v40
    v_mfma_f32_16x16x32_bf16 v[44:47], a[228:231], v[172:175], v[44:47]
    s_waitcnt lgkmcnt(9)
    buffer_load_dwordx4 v247, s[24:27], s46 offen offset:2048 nt lds
    v_mul_f32 v41, s54, v41
    v_mfma_f32_16x16x32_bf16 v[48:51], a[216:219], v[176:179], v[48:51]
    s_waitcnt lgkmcnt(7)
    ds_read_b64_tr_b16 a[238:239], v241 offset:61440
    v_xor_b32 v241, 0x10000, v241
    v_mfma_f32_16x16x32_bf16 v[48:51], a[220:223], v[188:191], v[48:51]
    s_waitcnt lgkmcnt(6)
    ds_read_b64_tr_b16 a[224:225], v241 offset:49152
    v_mul_f32 v44, s54, v44
    v_mfma_f32_16x16x32_bf16 v[48:51], a[208:211], v[152:155], v[48:51]
    s_waitcnt lgkmcnt(5)
    ds_read_b64_tr_b16 a[226:227], v241 offset:53248
    v_mul_f32 v45, s54, v45
    v_mfma_f32_16x16x32_bf16 v[48:51], a[212:215], v[164:167], v[48:51]
    ds_read_b64_tr_b16 a[228:229], v241 offset:57344
    v_mul_f32 v42, s54, v42
    v_mfma_f32_16x16x32_bf16 v[52:55], a[216:219], v[180:183], v[52:55]
    ds_read_b64_tr_b16 a[230:231], v241 offset:61440
    v_mul_f32 v43, s54, v43
    v_mfma_f32_16x16x32_bf16 v[52:55], a[220:223], v[192:195], v[52:55]
    buffer_load_dwordx4 v248, s[24:27], s46 offen offset:3072 nt lds
    v_cvt_pk_bf16_f32 v28, v28, v29
    v_mfma_f32_16x16x32_bf16 v[52:55], a[208:211], v[156:159], v[52:55]
    v_cvt_pk_bf16_f32 v40, v40, v41
    v_mul_f32 v34, s54, v34
    v_mfma_f32_16x16x32_bf16 v[52:55], a[212:215], v[168:171], v[52:55]
    v_mul_f32 v35, s54, v35
    v_mul_f32 v46, s54, v46
    v_mfma_f32_16x16x32_bf16 v[56:59], a[216:219], v[184:187], v[56:59]
    ds_read_b64_tr_b16 a[216:217], v242 offset:49152
    v_mul_f32 v47, s54, v47
    v_mfma_f32_16x16x32_bf16 v[56:59], a[220:223], v[196:199], v[56:59]
    ds_read_b64_tr_b16 a[218:219], v242 offset:53248
    v_cvt_pk_bf16_f32 v32, v32, v33
    v_mfma_f32_16x16x32_bf16 v[56:59], a[208:211], v[160:163], v[56:59]
    ds_read_b64_tr_b16 a[220:221], v242 offset:57344
    v_cvt_pk_bf16_f32 v44, v44, v45
    v_mfma_f32_16x16x32_bf16 v[56:59], a[212:215], v[172:175], v[56:59]
    s_waitcnt lgkmcnt(9)
    ds_read_b64_tr_b16 a[222:223], v242 offset:61440
    v_xor_b32 v242, 0x10000, v242
    v_mfma_f32_16x16x32_bf16 v[60:63], a[232:235], v[176:179], v[60:63]
    s_waitcnt lgkmcnt(8)
    ds_read_b64_tr_b16 a[208:209], v242 offset:49152
    v_cvt_pk_bf16_f32 v1, v2, v3
    v_mfma_f32_16x16x32_bf16 v[60:63], a[236:239], v[188:191], v[60:63]
    s_waitcnt lgkmcnt(7)
    ds_read_b64_tr_b16 a[210:211], v242 offset:53248
    v_cvt_pk_bf16_f32 v13, v14, v15
    v_mfma_f32_16x16x32_bf16 v[60:63], a[224:227], v[152:155], v[60:63]
    s_waitcnt lgkmcnt(6)
    ds_read_b64_tr_b16 a[212:213], v242 offset:57344
    v_cvt_pk_bf16_f32 v5, v6, v7
    v_mfma_f32_16x16x32_bf16 v[60:63], a[228:231], v[164:167], v[60:63]
    ds_read_b64_tr_b16 a[214:215], v242 offset:61440
    v_cvt_pk_bf16_f32 v17, v18, v19
    v_mfma_f32_16x16x32_bf16 v[64:67], a[232:235], v[180:183], v[64:67]
    v_cvt_pk_bf16_f32 v9, v10, v11
    v_cvt_pk_bf16_f32 v21, v22, v23
    v_mfma_f32_16x16x32_bf16 v[64:67], a[236:239], v[192:195], v[64:67]
    v_cvt_pk_bf16_f32 v98, v100, v101
    v_cvt_pk_bf16_f32 v99, v102, v103
    v_mfma_f32_16x16x32_bf16 v[64:67], a[224:227], v[156:159], v[64:67]
    v_cvt_pk_bf16_f32 v25, v26, v27
    v_cvt_pk_bf16_f32 v37, v38, v39
    v_mfma_f32_16x16x32_bf16 v[64:67], a[228:231], v[168:171], v[64:67]
    v_cvt_pk_bf16_f32 v29, v30, v31
    v_cvt_pk_bf16_f32 v41, v42, v43
    v_mfma_f32_16x16x32_bf16 v[68:71], a[232:235], v[184:187], v[68:71]
    ds_read_b64_tr_b16 a[232:233], v243 offset:49152
    v_cvt_pk_bf16_f32 v33, v34, v35
    v_mfma_f32_16x16x32_bf16 v[68:71], a[236:239], v[196:199], v[68:71]
    ds_read_b64_tr_b16 a[234:235], v243 offset:53248
    v_cvt_pk_bf16_f32 v45, v46, v47
    v_mfma_f32_16x16x32_bf16 v[68:71], a[224:227], v[160:163], v[68:71]
    ds_read_b64_tr_b16 a[236:237], v243 offset:57344
    v_cndmask_b32 v2, v0, v12, s[50:51]
    v_mfma_f32_16x16x32_bf16 v[68:71], a[228:231], v[172:175], v[68:71]
    s_waitcnt lgkmcnt(9)
    ds_read_b64_tr_b16 a[238:239], v243 offset:61440
    v_xor_b32 v243, 0x10000, v243
    v_mfma_f32_16x16x32_bf16 v[72:75], a[216:219], v[176:179], v[72:75]
    s_waitcnt lgkmcnt(8)
    ds_read_b64_tr_b16 a[224:225], v243 offset:49152
    v_cndmask_b32 v3, v1, v13, s[50:51]
    v_mfma_f32_16x16x32_bf16 v[72:75], a[220:223], v[188:191], v[72:75]
    s_waitcnt lgkmcnt(7)
    ds_read_b64_tr_b16 a[226:227], v243 offset:53248
    v_cndmask_b32 v14, v12, v0, s[50:51]
    v_mfma_f32_16x16x32_bf16 v[72:75], a[208:211], v[152:155], v[72:75]
    s_waitcnt lgkmcnt(6)
    ds_read_b64_tr_b16 a[228:229], v243 offset:57344
    v_cndmask_b32 v15, v13, v1, s[50:51]
    v_mfma_f32_16x16x32_bf16 v[72:75], a[212:215], v[164:167], v[72:75]
    ds_read_b64_tr_b16 a[230:231], v243 offset:61440
    v_cndmask_b32 v6, v4, v16, s[50:51]
    v_mfma_f32_16x16x32_bf16 v[76:79], a[216:219], v[180:183], v[76:79]
    v_cndmask_b32 v7, v5, v17, s[50:51]
    v_cndmask_b32 v18, v16, v4, s[50:51]
    v_mfma_f32_16x16x32_bf16 v[76:79], a[220:223], v[192:195], v[76:79]
    v_cndmask_b32 v19, v17, v5, s[50:51]
    v_cndmask_b32 v10, v8, v20, s[50:51]
    v_mfma_f32_16x16x32_bf16 v[76:79], a[208:211], v[156:159], v[76:79]
    v_cndmask_b32 v11, v9, v21, s[50:51]
    v_cndmask_b32 v22, v20, v8, s[50:51]
    v_mfma_f32_16x16x32_bf16 v[76:79], a[212:215], v[168:171], v[76:79]
    v_cndmask_b32 v23, v21, v9, s[50:51]
    v_cndmask_b32 v100, v96, v98, s[50:51]
    v_mfma_f32_16x16x32_bf16 v[80:83], a[216:219], v[184:187], v[80:83]
    v_cndmask_b32 v101, v97, v99, s[50:51]
    v_cndmask_b32 v102, v98, v96, s[50:51]
    v_mfma_f32_16x16x32_bf16 v[80:83], a[220:223], v[196:199], v[80:83]
    v_cndmask_b32 v103, v99, v97, s[50:51]
    v_cndmask_b32 v26, v24, v36, s[50:51]
    v_mfma_f32_16x16x32_bf16 v[80:83], a[208:211], v[160:163], v[80:83]
    v_cndmask_b32 v27, v25, v37, s[50:51]
    v_cndmask_b32 v38, v36, v24, s[50:51]
    v_mfma_f32_16x16x32_bf16 v[80:83], a[212:215], v[172:175], v[80:83]
    s_waitcnt lgkmcnt(6)
    v_cndmask_b32 v39, v37, v25, s[50:51]
    v_cndmask_b32 v30, v28, v40, s[50:51]
    v_mfma_f32_16x16x32_bf16 v[84:87], a[232:235], v[176:179], v[84:87]
    s_waitcnt lgkmcnt(4)
    v_cndmask_b32 v31, v29, v41, s[50:51]
    v_cndmask_b32 v42, v40, v28, s[50:51]
    v_mfma_f32_16x16x32_bf16 v[84:87], a[236:239], v[188:191], v[84:87]
    s_waitcnt lgkmcnt(2)
    v_cndmask_b32 v43, v41, v29, s[50:51]
    v_cndmask_b32 v34, v32, v44, s[50:51]
    v_mfma_f32_16x16x32_bf16 v[84:87], a[224:227], v[152:155], v[84:87]
    s_waitcnt lgkmcnt(0)
    v_cndmask_b32 v35, v33, v45, s[50:51]
    v_cndmask_b32 v46, v44, v32, s[50:51]
    v_mfma_f32_16x16x32_bf16 v[84:87], a[228:231], v[164:167], v[84:87]
    v_cndmask_b32 v47, v45, v33, s[50:51]
    v_accvgpr_write_b32 a144, v2
    v_mfma_f32_16x16x32_bf16 v[88:91], a[232:235], v[180:183], v[88:91]
    v_accvgpr_write_b32 a145, v3
    v_accvgpr_write_b32 a146, v14
    v_mfma_f32_16x16x32_bf16 v[88:91], a[236:239], v[192:195], v[88:91]
    v_accvgpr_write_b32 a147, v15
    v_accvgpr_write_b32 a148, v6
    v_mfma_f32_16x16x32_bf16 v[88:91], a[224:227], v[156:159], v[88:91]
    v_accvgpr_write_b32 a149, v7
    v_accvgpr_write_b32 a150, v18
    v_mfma_f32_16x16x32_bf16 v[88:91], a[228:231], v[168:171], v[88:91]
    v_accvgpr_write_b32 a151, v19
    v_accvgpr_write_b32 a152, v10
    v_mfma_f32_16x16x32_bf16 v[92:95], a[232:235], v[184:187], v[92:95]
    v_accvgpr_write_b32 a153, v11
    v_accvgpr_write_b32 a154, v22
    v_mfma_f32_16x16x32_bf16 v[92:95], a[236:239], v[196:199], v[92:95]
    v_accvgpr_write_b32 a155, v23
    v_accvgpr_write_b32 a156, v26
    v_mfma_f32_16x16x32_bf16 v[92:95], a[224:227], v[160:163], v[92:95]
    ds_write_b128 v245, v[100:103] offset:20480
    v_mfma_f32_16x16x32_bf16 v[92:95], a[228:231], v[172:175], v[92:95]
    v_accvgpr_write_b32 a157, v27
    v_accvgpr_write_b32 a158, v38
    v_accvgpr_write_b32 a159, v39
    v_accvgpr_write_b32 a160, v30
    v_accvgpr_write_b32 a161, v31
    v_accvgpr_write_b32 a162, v42
    v_accvgpr_write_b32 a163, v43
    v_accvgpr_write_b32 a164, v34
    v_accvgpr_write_b32 a165, v35
    v_accvgpr_write_b32 a166, v46
    v_accvgpr_write_b32 a167, v47
L_qdone:
    s_waitcnt lgkmcnt(0)
    s_barrier
    ds_read_b128 a[208:211], v228 offset:0
    ds_read_b128 a[212:215], v229 offset:0
    ds_read_b128 a[216:219], v230 offset:0
    ds_read_b128 a[220:223], v231 offset:0
    v_mul_f32 v48, s54, v48
    v_mul_f32 v49, s54, v49
    v_mul_f32 v60, s54, v60
    v_mul_f32 v61, s54, v61
    v_mul_f32 v50, s54, v50
    v_mul_f32 v51, s54, v51
    v_mul_f32 v62, s54, v62
    v_mul_f32 v63, s54, v63
    v_cvt_pk_bf16_f32 v48, v48, v49
    v_cvt_pk_bf16_f32 v60, v60, v61
    v_cvt_pk_bf16_f32 v49, v50, v51
    v_cvt_pk_bf16_f32 v61, v62, v63
    v_cndmask_b32 v50, v48, v60, s[50:51]
    v_cndmask_b32 v51, v49, v61, s[50:51]
    v_cndmask_b32 v62, v60, v48, s[50:51]
    v_cndmask_b32 v63, v61, v49, s[50:51]
    v_accvgpr_write_b32 a168, v50
    s_waitcnt lgkmcnt(3)
    v_mfma_f32_16x16x32_bf16 v[120:123], a[208:211], a[144:147], 0
    s_waitcnt lgkmcnt(2)
    v_accvgpr_write_b32 a169, v51
    v_accvgpr_write_b32 a170, v62
    v_mfma_f32_16x16x32_bf16 v[120:123], a[212:215], a[156:159], v[120:123]
    s_add_u32 s46, s40, 49152
    v_accvgpr_write_b32 a171, v63
    v_mul_f32 v72, s54, v72
    v_mul_f32 v73, s54, v73
    s_waitcnt lgkmcnt(1)
    v_mfma_f32_16x16x32_bf16 v[120:123], a[216:219], a[168:171], v[120:123]
    s_add_u32 m0, s41, 49152
    v_mul_f32 v84, s54, v84
    v_mul_f32 v85, s54, v85
    v_mul_f32 v74, s54, v74
    v_mul_f32 v75, s54, v75
    v_mul_f32 v86, s54, v86
    v_mul_f32 v87, s54, v87
    v_cvt_pk_bf16_f32 v72, v72, v73
    v_cvt_pk_bf16_f32 v84, v84, v85
    v_cvt_pk_bf16_f32 v73, v74, v75
    v_cvt_pk_bf16_f32 v85, v86, v87
    v_cndmask_b32 v74, v72, v84, s[50:51]
    v_cndmask_b32 v75, v73, v85, s[50:51]
    v_cndmask_b32 v86, v84, v72, s[50:51]
    v_cndmask_b32 v87, v85, v73, s[50:51]
    v_accvgpr_write_b32 a180, v74
    v_accvgpr_write_b32 a181, v75
    v_accvgpr_write_b32 a182, v86
    v_accvgpr_write_b32 a183, v87
    v_mul_f32 v52, s54, v52
    v_mul_f32 v53, s54, v53
    s_waitcnt lgkmcnt(0)
    v_mfma_f32_16x16x32_bf16 v[120:123], a[220:223], a[180:183], v[120:123]
    v_mul_f32 v64, s54, v64
    v_mul_f32 v65, s54, v65
    v_mfma_f32_16x16x32_bf16 v[124:127], a[208:211], a[148:151], 0
    v_mul_f32 v54, s54, v54
    v_mul_f32 v55, s54, v55
    v_mfma_f32_16x16x32_bf16 v[124:127], a[212:215], a[160:163], v[124:127]
    v_mul_f32 v66, s54, v66
    v_mul_f32 v67, s54, v67
    v_cvt_pk_bf16_f32 v52, v52, v53
    v_cvt_pk_bf16_f32 v64, v64, v65
    v_cvt_pk_bf16_f32 v53, v54, v55
    v_cvt_pk_bf16_f32 v65, v66, v67
    v_cndmask_b32 v54, v52, v64, s[50:51]
    v_cndmask_b32 v55, v53, v65, s[50:51]
    v_cndmask_b32 v66, v64, v52, s[50:51]
    v_cndmask_b32 v67, v65, v53, s[50:51]
    v_accvgpr_write_b32 a172, v54
    v_accvgpr_write_b32 a173, v55
    v_accvgpr_write_b32 a174, v66
    v_accvgpr_write_b32 a175, v67
    v_mul_f32 v76, s54, v76
    v_mul_f32 v77, s54, v77
    v_mfma_f32_16x16x32_bf16 v[124:127], a[216:219], a[172:175], v[124:127]
    v_mul_f32 v88, s54, v88
    v_mul_f32 v89, s54, v89
    v_mul_f32 v78, s54, v78
    v_mul_f32 v79, s54, v79
    v_mul_f32 v90, s54, v90
    v_mul_f32 v91, s54, v91
    v_cvt_pk_bf16_f32 v76, v76, v77
    v_cvt_pk_bf16_f32 v88, v88, v89
    v_cvt_pk_bf16_f32 v77, v78, v79
    v_cvt_pk_bf16_f32 v89, v90, v91
    v_cndmask_b32 v78, v76, v88, s[50:51]
    v_cndmask_b32 v79, v77, v89, s[50:51]
    v_cndmask_b32 v90, v88, v76, s[50:51]
    v_cndmask_b32 v91, v89, v77, s[50:51]
    v_accvgpr_write_b32 a184, v78
    v_accvgpr_write_b32 a185, v79
    v_accvgpr_write_b32 a186, v90
    v_accvgpr_write_b32 a187, v91
    v_mul_f32 v56, s54, v56
    v_mul_f32 v57, s54, v57
    v_mfma_f32_16x16x32_bf16 v[124:127], a[220:223], a[184:187], v[124:127]
    v_mul_f32 v68, s54, v68
    v_mul_f32 v69, s54, v69
    v_mfma_f32_16x16x32_bf16 v[128:131], a[208:211], a[152:155], 0
    ds_read_b128 a[208:211], v228 offset:4096
    v_mul_f32 v58, s54, v58
    v_mfma_f32_16x16x32_bf16 v[128:131], a[212:215], a[164:167], v[128:131]
    ds_read_b128 a[212:215], v229 offset:4096
    v_mul_f32 v59, s54, v59
    v_mul_f32 v70, s54, v70
    v_mul_f32 v71, s54, v71
    v_cvt_pk_bf16_f32 v56, v56, v57
    v_cvt_pk_bf16_f32 v68, v68, v69
    v_cvt_pk_bf16_f32 v57, v58, v59
    v_cvt_pk_bf16_f32 v69, v70, v71
    v_cndmask_b32 v58, v56, v68, s[50:51]
    v_cndmask_b32 v59, v57, v69, s[50:51]
    v_cndmask_b32 v70, v68, v56, s[50:51]
    v_cndmask_b32 v71, v69, v57, s[50:51]
    v_accvgpr_write_b32 a176, v58
    v_accvgpr_write_b32 a177, v59
    v_accvgpr_write_b32 a178, v70
    v_accvgpr_write_b32 a179, v71
    v_mul_f32 v80, s54, v80
    v_mul_f32 v81, s54, v81
    v_mfma_f32_16x16x32_bf16 v[128:131], a[216:219], a[176:179], v[128:131]
    ds_read_b128 a[216:219], v230 offset:4096
    v_mul_f32 v92, s54, v92
    v_mul_f32 v93, s54, v93
    v_mul_f32 v82, s54, v82
    v_mul_f32 v83, s54, v83
    v_mul_f32 v94, s54, v94
    v_mul_f32 v95, s54, v95
    v_cvt_pk_bf16_f32 v80, v80, v81
    v_cvt_pk_bf16_f32 v92, v92, v93
    v_cvt_pk_bf16_f32 v81, v82, v83
    v_cvt_pk_bf16_f32 v93, v94, v95
    buffer_load_dwordx4 v247, s[20:23], s46 offen offset:0 nt lds
    v_cndmask_b32 v82, v80, v92, s[50:51]
    v_cndmask_b32 v83, v81, v93, s[50:51]
    v_cndmask_b32 v94, v92, v80, s[50:51]
    v_cndmask_b32 v95, v93, v81, s[50:51]
    v_accvgpr_write_b32 a188, v82
    v_accvgpr_write_b32 a189, v83
    v_accvgpr_write_b32 a190, v94
    v_accvgpr_write_b32 a191, v95
    buffer_load_dwordx4 v248, s[20:23], s46 offen offset:1024 nt lds
    buffer_load_dwordx4 v247, s[20:23], s46 offen offset:2048 nt lds
    v_mfma_f32_16x16x32_bf16 v[128:131], a[220:223], a[188:191], v[128:131]
    s_waitcnt lgkmcnt(2)
    ds_read_b128 a[220:223], v231 offset:4096
    ds_read_b128 a[192:195], v245 offset:20480
    v_mfma_f32_16x16x32_bf16 v[132:135], a[208:211], a[144:147], 0
    s_waitcnt lgkmcnt(3)
    ds_read_b128 a[224:227], v232 offset:0
    v_xor_b32 v204, 1024, v245
    v_mfma_f32_16x16x32_bf16 v[132:135], a[212:215], a[156:159], v[132:135]
    s_waitcnt lgkmcnt(3)
    ds_read_b128 a[196:199], v204 offset:20480
    ds_read_b128 a[228:231], v233 offset:0
    v_mfma_f32_16x16x32_bf16 v[132:135], a[216:219], a[168:171], v[132:135]
    s_waitcnt lgkmcnt(4)
    buffer_load_dwordx4 v248, s[20:23], s46 offen offset:3072 nt lds
    v_lshrrev_b32 v206, 4, v244
    v_exp_f32 v120, v120
    v_exp_f32 v121, v121
    v_exp_f32 v122, v122
    v_exp_f32 v123, v123
    v_mfma_f32_16x16x32_bf16 v[132:135], a[220:223], a[180:183], v[132:135]
    v_cvt_pk_bf16_f32 v148, v120, v121
    v_cvt_pk_bf16_f32 v149, v122, v123
    v_mfma_f32_16x16x32_bf16 v[136:139], a[208:211], a[148:151], 0
    v_exp_f32 v124, v124
    v_mfma_f32_16x16x32_bf16 v[136:139], a[212:215], a[160:163], v[136:139]
    v_exp_f32 v125, v125
    v_mfma_f32_16x16x32_bf16 v[136:139], a[216:219], a[172:175], v[136:139]
    v_exp_f32 v126, v126
    v_mfma_f32_16x16x32_bf16 v[136:139], a[220:223], a[184:187], v[136:139]
    v_exp_f32 v127, v127
    v_mfma_f32_16x16x32_bf16 v[140:143], a[208:211], a[152:155], 0
    ds_read_b128 a[208:211], v228 offset:8192
    v_cvt_pk_bf16_f32 v152, v124, v125
    v_mfma_f32_16x16x32_bf16 v[140:143], a[212:215], a[164:167], v[140:143]
    s_add_u32 s46, s40, 49152
    ds_read_b128 a[212:215], v229 offset:8192
    v_cvt_pk_bf16_f32 v153, v126, v127
    v_mfma_f32_16x16x32_bf16 v[140:143], a[216:219], a[176:179], v[140:143]
    s_add_u32 m0, s41, 114688
    ds_read_b128 a[216:219], v230 offset:8192
    buffer_load_dwordx4 v247, s[24:27], s46 offen offset:0 nt lds
    v_mfma_f32_16x16x32_bf16 v[140:143], a[220:223], a[188:191], v[140:143]
    s_waitcnt lgkmcnt(5)
    ds_read_b128 a[220:223], v231 offset:8192
    v_and_b32 v206, 63, v206
    v_mfma_f32_16x16x32_bf16 v[144:147], a[224:227], a[192:195], 0
    s_waitcnt lgkmcnt(4)
    v_lshrrev_b32 v213, 4, v206
    v_lshlrev_b32 v213, 1, v213
    v_mfma_f32_16x16x32_bf16 v[144:147], a[228:231], a[196:199], v[144:147]
    s_waitcnt lgkmcnt(3)
    v_and_b32 v207, 7, v206
    v_xor_b32 v205, 2048, v245
    v_mfma_f32_16x16x32_bf16 v[120:123], a[208:211], a[144:147], 0
    s_waitcnt lgkmcnt(2)
    v_xor_b32 v207, v207, v213
    v_lshlrev_b32 v207, 4, v207
    v_mfma_f32_16x16x32_bf16 v[120:123], a[212:215], a[156:159], v[120:123]
    s_waitcnt lgkmcnt(1)
    ds_read_b128 a[200:203], v205 offset:20480
    ds_read_b128 a[224:227], v234 offset:0
    v_mfma_f32_16x16x32_bf16 v[120:123], a[216:219], a[168:171], v[120:123]
    s_waitcnt lgkmcnt(2)
    v_lshrrev_b32 v206, 3, v206
    v_lshl_add_u32 v207, v206, 10, v207
    v_mfma_f32_16x16x32_bf16 v[120:123], a[220:223], a[180:183], v[120:123]
    s_add_u32 s80, s39, 1
    v_exp_f32 v128, v128
    v_mfma_f32_16x16x32_bf16 v[124:127], a[208:211], a[148:151], 0
    s_and_b32 s80, s80, 7
    v_exp_f32 v129, v129
    v_mfma_f32_16x16x32_bf16 v[124:127], a[212:215], a[160:163], v[124:127]
    s_lshl_b32 s80, s80, 7
    v_exp_f32 v130, v130
    v_mfma_f32_16x16x32_bf16 v[124:127], a[216:219], a[172:175], v[124:127]
    s_add_u32 s81, s39, 2
    v_exp_f32 v131, v131
    v_mfma_f32_16x16x32_bf16 v[124:127], a[220:223], a[184:187], v[124:127]
    s_and_b32 s81, s81, 7
    v_xor_b32 v206, 3072, v245
    v_cvt_pk_bf16_f32 v156, v128, v129
    ds_read_b128 a[204:207], v206 offset:20480
    v_cvt_pk_bf16_f32 v157, v130, v131
    v_mfma_f32_16x16x32_bf16 v[128:131], a[208:211], a[152:155], 0
    s_lshl_b32 s81, s81, 7
    ds_read_b128 a[228:231], v235 offset:0
    buffer_load_dwordx4 v248, s[24:27], s46 offen offset:1024 nt lds
    v_mfma_f32_16x16x32_bf16 v[128:131], a[212:215], a[164:167], v[128:131]
    s_sub_u32 s81, s81, s80
    ds_read_b128 a[208:211], v228 offset:12288
    ds_read_b128 a[212:215], v229 offset:12288
    v_mfma_f32_16x16x32_bf16 v[128:131], a[216:219], a[176:179], v[128:131]
    s_sub_u32 s81, s81, 0x40000
    ds_read_b128 a[216:219], v230 offset:12288
    buffer_load_dwordx4 v247, s[24:27], s46 offen offset:2048 nt lds
    v_mfma_f32_16x16x32_bf16 v[128:131], a[220:223], a[188:191], v[128:131]
    s_waitcnt lgkmcnt(5)
    ds_read_b128 a[220:223], v231 offset:12288
    buffer_load_dwordx4 v248, s[24:27], s46 offen offset:3072 nt lds
    v_mfma_f32_16x16x32_bf16 v[144:147], a[224:227], a[200:203], v[144:147]
    s_waitcnt lgkmcnt(4)
    v_exp_f32 v132, v132
    v_exp_f32 v133, v133
    v_exp_f32 v134, v134
    v_mfma_f32_16x16x32_bf16 v[144:147], a[228:231], a[204:207], v[144:147]
    s_lshl_b32 s82, s36, 15
    v_exp_f32 v135, v135
    v_cvt_pk_bf16_f32 v150, v132, v133
    v_cvt_pk_bf16_f32 v151, v134, v135
    v_exp_f32 v136, v136
    v_exp_f32 v137, v137
    v_exp_f32 v138, v138
    v_exp_f32 v139, v139
    v_exp_f32 v144, v144
    v_exp_f32 v145, v145
    v_exp_f32 v146, v146
    v_exp_f32 v147, v147
    v_cvt_pk_bf16_f32 v204, v144, v145
    v_cvt_pk_bf16_f32 v205, v146, v147
    ds_write_b64 v246, v[204:205] offset:0
    v_cvt_pk_bf16_f32 v154, v136, v137
    v_cvt_pk_bf16_f32 v155, v138, v139
    v_exp_f32 v140, v140
    v_exp_f32 v141, v141
    v_exp_f32 v142, v142
    v_exp_f32 v143, v143
    v_cvt_pk_bf16_f32 v158, v140, v141
    v_cvt_pk_bf16_f32 v159, v142, v143
    v_exp_f32 v120, v120
    v_exp_f32 v121, v121
    v_exp_f32 v122, v122
    s_waitcnt vmcnt(20) lgkmcnt(0)
    s_barrier
    v_mfma_f32_16x16x32_bf16 v[132:135], a[208:211], a[144:147], 0
    s_add_u32 s80, s80, s82
    v_exp_f32 v123, v123
    v_mfma_f32_16x16x32_bf16 v[132:135], a[212:215], a[156:159], v[132:135]
    s_cmp_eq_u32 s37, 3
    v_cvt_pk_bf16_f32 v160, v120, v121
    v_cvt_pk_bf16_f32 v161, v122, v123
    v_mfma_f32_16x16x32_bf16 v[132:135], a[216:219], a[168:171], v[132:135]
    s_cselect_b64 s[32:33], s[16:17], s[12:13]
    s_cselect_b32 s34, s18, s14
    v_exp_f32 v124, v124
    v_mfma_f32_16x16x32_bf16 v[132:135], a[220:223], a[180:183], v[132:135]
    s_cselect_b64 s[52:53], -1, 0
    s_cselect_b32 s42, s80, s58
    v_exp_f32 v125, v125
    v_mfma_f32_16x16x32_bf16 v[136:139], a[208:211], a[148:151], 0
    s_cselect_b32 s63, s81, 0x100000
    s_cselect_b32 s44, 4, 16
    v_exp_f32 v126, v126
    v_mfma_f32_16x16x32_bf16 v[136:139], a[212:215], a[160:163], v[136:139]
    s_cselect_b32 s60, 2, 8
    s_cselect_b32 s45, 7, 63
    v_exp_f32 v127, v127
    v_mfma_f32_16x16x32_bf16 v[136:139], a[216:219], a[172:175], v[136:139]
    s_lshl_b32 s44, s44, 16
    s_lshl_b32 s60, s60, 16
    v_cvt_pk_bf16_f32 v164, v124, v125
    v_mfma_f32_16x16x32_bf16 v[136:139], a[220:223], a[184:187], v[136:139]
    s_lshl_b32 s45, s45, 10
    s_add_u32 s43, s42, s60
    v_cvt_pk_bf16_f32 v165, v126, v127
    v_mfma_f32_16x16x32_bf16 v[140:143], a[208:211], a[152:155], 0
    s_add_u32 s46, s40, 65536
    ds_read_b128 a[208:211], v228 offset:16384
    v_xor_b32 v236, v254, v236
    v_mfma_f32_16x16x32_bf16 v[140:143], a[212:215], a[164:167], v[140:143]
    s_add_u32 m0, s41, 0
    ds_read_b128 a[212:215], v229 offset:16384
    buffer_load_dwordx4 v247, s[20:23], s46 offen offset:0 nt lds
    v_mfma_f32_16x16x32_bf16 v[140:143], a[216:219], a[176:179], v[140:143]
    ds_read_b128 a[216:219], v230 offset:16384
    v_xor_b32 v237, v255, v237
    v_mfma_f32_16x16x32_bf16 v[140:143], a[220:223], a[188:191], v[140:143]
    s_waitcnt lgkmcnt(2)
    ds_read_b128 a[220:223], v231 offset:16384
    buffer_load_dwordx4 v248, s[20:23], s46 offen offset:1024 nt lds
    v_exp_f32 v128, v128
    v_exp_f32 v129, v129
    v_exp_f32 v130, v130
    v_exp_f32 v131, v131
    v_mfma_f32_16x16x32_bf16 v[120:123], a[208:211], a[144:147], 0
    s_waitcnt lgkmcnt(2)
    v_cvt_pk_bf16_f32 v168, v128, v129
    v_cvt_pk_bf16_f32 v169, v130, v131
    v_mfma_f32_16x16x32_bf16 v[120:123], a[212:215], a[156:159], v[120:123]
    s_waitcnt lgkmcnt(1)
    ds_read_b64_tr_b16 a[232:233], v236 offset:0
    ds_read_b64_tr_b16 a[234:235], v236 offset:4096
    v_mfma_f32_16x16x32_bf16 v[120:123], a[216:219], a[168:171], v[120:123]
    s_waitcnt lgkmcnt(2)
    ds_read_b64_tr_b16 a[236:237], v236 offset:8192
    ds_read_b64_tr_b16 a[238:239], v236 offset:12288
    v_mfma_f32_16x16x32_bf16 v[120:123], a[220:223], a[180:183], v[120:123]
    v_exp_f32 v132, v132
    v_mfma_f32_16x16x32_bf16 v[124:127], a[208:211], a[148:151], 0
    v_exp_f32 v133, v133
    v_mfma_f32_16x16x32_bf16 v[124:127], a[212:215], a[160:163], v[124:127]
    v_exp_f32 v134, v134
    v_mfma_f32_16x16x32_bf16 v[124:127], a[216:219], a[172:175], v[124:127]
    v_exp_f32 v135, v135
    v_mfma_f32_16x16x32_bf16 v[124:127], a[220:223], a[184:187], v[124:127]
    buffer_load_dwordx4 v247, s[20:23], s46 offen offset:2048 nt lds
    v_cvt_pk_bf16_f32 v162, v132, v133
    v_mfma_f32_16x16x32_bf16 v[128:131], a[208:211], a[152:155], 0
    v_cvt_pk_bf16_f32 v163, v134, v135
    v_xor_b32 v238, v254, v238
    v_mfma_f32_16x16x32_bf16 v[128:131], a[212:215], a[164:167], v[128:131]
    ds_read_b128 v[196:199], v244 offset:16384
    v_xor_b32 v239, v255, v239
    v_mfma_f32_16x16x32_bf16 v[128:131], a[216:219], a[176:179], v[128:131]
    v_exp_f32 v136, v136
    v_mfma_f32_16x16x32_bf16 v[128:131], a[220:223], a[188:191], v[128:131]
    v_exp_f32 v137, v137
    v_mfma_f32_16x16x32_bf16 v[104:107], a[248:251], v[148:151], 0
    v_exp_f32 v138, v138
    v_mfma_f32_16x16x32_bf16 v[104:107], a[248:251], v[160:163], v[104:107]
    s_waitcnt lgkmcnt(3)
    v_exp_f32 v139, v139
    v_mfma_f32_16x16x32_bf16 v[0:3], a[232:235], v[148:151], 0
    s_waitcnt lgkmcnt(1)
    ds_read_b128 v[200:203], v244 offset:17408
    v_cvt_pk_bf16_f32 v166, v136, v137
    v_mfma_f32_16x16x32_bf16 v[0:3], a[236:239], v[160:163], v[0:3]
    v_cvt_pk_bf16_f32 v167, v138, v139
    v_xor_b32 v240, v254, v240
    v_mfma_f32_16x16x32_bf16 v[4:7], a[232:235], v[152:155], 0
    ds_read_b64_tr_b16 a[240:241], v237 offset:0
    v_xor_b32 v241, v255, v241
    v_mfma_f32_16x16x32_bf16 v[4:7], a[236:239], v[164:167], v[4:7]
    ds_read_b64_tr_b16 a[242:243], v237 offset:4096
    v_xor_b32 v242, v254, v242
    v_mfma_f32_16x16x32_bf16 v[8:11], a[232:235], v[156:159], 0
    buffer_load_dwordx4 v248, s[20:23], s46 offen offset:3072 nt lds
    v_xor_b32 v243, v255, v243
    v_exp_f32 v140, v140
    v_exp_f32 v141, v141
    v_exp_f32 v142, v142
    v_exp_f32 v143, v143
    ds_read_b64_tr_b16 a[244:245], v237 offset:8192
    ds_read_b64_tr_b16 a[246:247], v237 offset:12288
    v_cvt_pk_bf16_f32 v170, v140, v141
    v_cvt_pk_bf16_f32 v171, v142, v143
    ds_read_b128 a[208:211], v228 offset:20480
    ds_read_b128 a[212:215], v229 offset:20480
    v_mfma_f32_16x16x32_bf16 v[8:11], a[236:239], v[168:171], v[8:11]
    s_waitcnt lgkmcnt(7)
    ds_read_b128 a[216:219], v230 offset:20480
    ds_read_b128 a[220:223], v231 offset:20480
    v_mfma_f32_16x16x32_bf16 v[96:99], a[232:235], v[196:199], 0
    s_waitcnt lgkmcnt(8)
    ds_read_b64_tr_b16 a[232:233], v238 offset:0
    ds_read_b64_tr_b16 a[234:235], v238 offset:4096
    v_mfma_f32_16x16x32_bf16 v[96:99], a[236:239], v[200:203], v[96:99]
    s_waitcnt lgkmcnt(8)
    ds_read_b64_tr_b16 a[236:237], v238 offset:8192
    ds_read_b64_tr_b16 a[238:239], v238 offset:12288
    v_mfma_f32_16x16x32_bf16 v[12:15], a[240:243], v[148:151], 0
    s_waitcnt lgkmcnt(8)
    ds_read_b128 a[224:227], v232 offset:16384
    ds_read_b128 a[228:231], v233 offset:16384
    v_mfma_f32_16x16x32_bf16 v[12:15], a[244:247], v[160:163], v[12:15]
    v_exp_f32 v120, v120
    v_mfma_f32_16x16x32_bf16 v[16:19], a[240:243], v[152:155], 0
    v_exp_f32 v121, v121
    v_mfma_f32_16x16x32_bf16 v[16:19], a[244:247], v[164:167], v[16:19]
    v_exp_f32 v122, v122
    v_mfma_f32_16x16x32_bf16 v[20:23], a[240:243], v[156:159], 0
    v_exp_f32 v123, v123
    v_mfma_f32_16x16x32_bf16 v[20:23], a[244:247], v[168:171], v[20:23]
    v_cvt_pk_bf16_f32 v172, v120, v121
    v_cvt_pk_bf16_f32 v173, v122, v123
    v_mfma_f32_16x16x32_bf16 v[100:103], a[240:243], v[196:199], 0
    ds_read_b64_tr_b16 a[240:241], v239 offset:0
    v_cndmask_b32 v249, v249, v207, s[52:53]
    v_mfma_f32_16x16x32_bf16 v[100:103], a[244:247], v[200:203], v[100:103]
    s_waitcnt lgkmcnt(10)
    ds_read_b64_tr_b16 a[242:243], v239 offset:4096
    ds_read_b64_tr_b16 a[244:245], v239 offset:8192
    v_mfma_f32_16x16x32_bf16 v[132:135], a[208:211], a[144:147], 0
    s_waitcnt lgkmcnt(11)
    ds_read_b64_tr_b16 a[246:247], v239 offset:12288
    v_cndmask_b32 v250, v250, v207, s[52:53]
    v_mfma_f32_16x16x32_bf16 v[132:135], a[212:215], a[156:159], v[132:135]
    s_waitcnt lgkmcnt(11)
    v_exp_f32 v124, v124
    v_mfma_f32_16x16x32_bf16 v[132:135], a[216:219], a[168:171], v[132:135]
    s_waitcnt lgkmcnt(10)
    v_exp_f32 v125, v125
    v_mfma_f32_16x16x32_bf16 v[132:135], a[220:223], a[180:183], v[132:135]
    v_exp_f32 v126, v126
    v_mfma_f32_16x16x32_bf16 v[136:139], a[208:211], a[148:151], 0
    v_exp_f32 v127, v127
    v_mfma_f32_16x16x32_bf16 v[136:139], a[212:215], a[160:163], v[136:139]
    v_cvt_pk_bf16_f32 v176, v124, v125
    v_cvt_pk_bf16_f32 v177, v126, v127
    v_mfma_f32_16x16x32_bf16 v[136:139], a[216:219], a[172:175], v[136:139]
    v_exp_f32 v128, v128
    v_mfma_f32_16x16x32_bf16 v[136:139], a[220:223], a[184:187], v[136:139]
    v_exp_f32 v129, v129
    v_mfma_f32_16x16x32_bf16 v[140:143], a[208:211], a[152:155], 0
    ds_read_b128 a[208:211], v228 offset:24576
    v_cvt_pk_bf16_f32 v180, v128, v129
    v_mfma_f32_16x16x32_bf16 v[140:143], a[212:215], a[164:167], v[140:143]
    ds_read_b128 a[212:215], v229 offset:24576
    v_mfma_f32_16x16x32_bf16 v[140:143], a[216:219], a[176:179], v[140:143]
    ds_read_b128 a[216:219], v230 offset:24576
    v_mfma_f32_16x16x32_bf16 v[140:143], a[220:223], a[188:191], v[140:143]
    ds_read_b128 a[220:223], v231 offset:24576
    v_mfma_f32_16x16x32_bf16 v[108:111], a[248:251], v[152:155], 0
    v_exp_f32 v130, v130
    v_mfma_f32_16x16x32_bf16 v[108:111], a[248:251], v[164:167], v[108:111]
    s_waitcnt lgkmcnt(12)
    v_exp_f32 v131, v131
    v_mfma_f32_16x16x32_bf16 v[24:27], a[232:235], v[148:151], 0
    s_waitcnt lgkmcnt(10)
    v_cvt_pk_bf16_f32 v181, v130, v131
    v_mfma_f32_16x16x32_bf16 v[24:27], a[236:239], v[160:163], v[24:27]
    v_exp_f32 v132, v132
    v_mfma_f32_16x16x32_bf16 v[28:31], a[232:235], v[152:155], 0
    v_exp_f32 v133, v133
    v_mfma_f32_16x16x32_bf16 v[28:31], a[236:239], v[164:167], v[28:31]
    v_exp_f32 v134, v134
    v_mfma_f32_16x16x32_bf16 v[32:35], a[232:235], v[156:159], 0
    ds_read_b64_tr_b16 a[232:233], v240 offset:0
    v_cvt_pk_bf16_f32 v174, v132, v133
    v_mfma_f32_16x16x32_bf16 v[32:35], a[236:239], v[168:171], v[32:35]
    s_waitcnt lgkmcnt(7)
    ds_read_b64_tr_b16 a[234:235], v240 offset:4096
    ds_read_b64_tr_b16 a[236:237], v240 offset:8192
    v_mfma_f32_16x16x32_bf16 v[36:39], a[240:243], v[148:151], 0
    s_waitcnt lgkmcnt(7)
    ds_read_b64_tr_b16 a[238:239], v240 offset:12288
    v_mfma_f32_16x16x32_bf16 v[36:39], a[244:247], v[160:163], v[36:39]
    v_exp_f32 v135, v135
    v_mfma_f32_16x16x32_bf16 v[40:43], a[240:243], v[152:155], 0
    v_cvt_pk_bf16_f32 v175, v134, v135
    v_mfma_f32_16x16x32_bf16 v[40:43], a[244:247], v[164:167], v[40:43]
    v_exp_f32 v136, v136
    v_mfma_f32_16x16x32_bf16 v[44:47], a[240:243], v[156:159], 0
    ds_read_b64_tr_b16 a[240:241], v241 offset:0
    v_mfma_f32_16x16x32_bf16 v[44:47], a[244:247], v[168:171], v[44:47]
    ds_read_b64_tr_b16 a[242:243], v241 offset:4096
    v_mfma_f32_16x16x32_bf16 v[144:147], a[224:227], a[192:195], 0
    ds_read_b64_tr_b16 a[244:245], v241 offset:8192
    v_mfma_f32_16x16x32_bf16 v[144:147], a[228:231], a[196:199], v[144:147]
    s_waitcnt lgkmcnt(10)
    ds_read_b64_tr_b16 a[246:247], v241 offset:12288
    ds_read_b128 a[224:227], v234 offset:16384
    v_mfma_f32_16x16x32_bf16 v[120:123], a[208:211], a[144:147], 0
    s_waitcnt lgkmcnt(11)
    ds_read_b128 a[228:231], v235 offset:16384
    v_mfma_f32_16x16x32_bf16 v[120:123], a[212:215], a[156:159], v[120:123]
    s_waitcnt lgkmcnt(11)
    v_exp_f32 v137, v137
    v_mfma_f32_16x16x32_bf16 v[120:123], a[216:219], a[168:171], v[120:123]
    s_waitcnt lgkmcnt(10)
    v_exp_f32 v138, v138
    v_mfma_f32_16x16x32_bf16 v[120:123], a[220:223], a[180:183], v[120:123]
    v_exp_f32 v139, v139
    v_mfma_f32_16x16x32_bf16 v[124:127], a[208:211], a[148:151], 0
    v_cvt_pk_bf16_f32 v178, v136, v137
    v_cvt_pk_bf16_f32 v179, v138, v139
    v_mfma_f32_16x16x32_bf16 v[124:127], a[212:215], a[160:163], v[124:127]
    v_exp_f32 v140, v140
    v_mfma_f32_16x16x32_bf16 v[124:127], a[216:219], a[172:175], v[124:127]
    v_exp_f32 v141, v141
    v_mfma_f32_16x16x32_bf16 v[124:127], a[220:223], a[184:187], v[124:127]
    v_exp_f32 v142, v142
    v_mfma_f32_16x16x32_bf16 v[128:131], a[208:211], a[152:155], 0
    ds_read_b128 a[208:211], v228 offset:28672
    v_cvt_pk_bf16_f32 v182, v140, v141
    v_mfma_f32_16x16x32_bf16 v[128:131], a[212:215], a[164:167], v[128:131]
    ds_read_b128 a[212:215], v229 offset:28672
    v_mfma_f32_16x16x32_bf16 v[128:131], a[216:219], a[176:179], v[128:131]
    ds_read_b128 a[216:219], v230 offset:28672
    v_mfma_f32_16x16x32_bf16 v[128:131], a[220:223], a[188:191], v[128:131]
    ds_read_b128 a[220:223], v231 offset:28672
    v_mfma_f32_16x16x32_bf16 v[112:115], a[248:251], v[156:159], 0
    v_exp_f32 v143, v143
    v_mfma_f32_16x16x32_bf16 v[112:115], a[248:251], v[168:171], v[112:115]
    s_waitcnt lgkmcnt(12)
    v_cvt_pk_bf16_f32 v183, v142, v143
    v_mfma_f32_16x16x32_bf16 v[48:51], a[232:235], v[148:151], 0
    s_waitcnt lgkmcnt(10)
    v_exp_f32 v120, v120
    v_mfma_f32_16x16x32_bf16 v[48:51], a[236:239], v[160:163], v[48:51]
    v_exp_f32 v121, v121
    v_mfma_f32_16x16x32_bf16 v[52:55], a[232:235], v[152:155], 0
    v_exp_f32 v122, v122
    v_mfma_f32_16x16x32_bf16 v[52:55], a[236:239], v[164:167], v[52:55]
    v_exp_f32 v123, v123
    v_mfma_f32_16x16x32_bf16 v[56:59], a[232:235], v[156:159], 0
    ds_read_b64_tr_b16 a[232:233], v242 offset:0
    v_cvt_pk_bf16_f32 v184, v120, v121
    v_mfma_f32_16x16x32_bf16 v[56:59], a[236:239], v[168:171], v[56:59]
    s_waitcnt lgkmcnt(9)
    ds_read_b64_tr_b16 a[234:235], v242 offset:4096
    ds_read_b64_tr_b16 a[236:237], v242 offset:8192
    v_mfma_f32_16x16x32_bf16 v[60:63], a[240:243], v[148:151], 0
    s_waitcnt lgkmcnt(9)
    ds_read_b64_tr_b16 a[238:239], v242 offset:12288
    v_cvt_pk_bf16_f32 v185, v122, v123
    v_mfma_f32_16x16x32_bf16 v[60:63], a[244:247], v[160:163], v[60:63]
    v_exp_f32 v124, v124
    v_mfma_f32_16x16x32_bf16 v[64:67], a[240:243], v[152:155], 0
    v_exp_f32 v125, v125
    v_mfma_f32_16x16x32_bf16 v[64:67], a[244:247], v[164:167], v[64:67]
    v_exp_f32 v126, v126
    v_mfma_f32_16x16x32_bf16 v[68:71], a[240:243], v[156:159], 0
    ds_read_b64_tr_b16 a[240:241], v243 offset:0
    v_cvt_pk_bf16_f32 v188, v124, v125
    v_mfma_f32_16x16x32_bf16 v[68:71], a[244:247], v[168:171], v[68:71]
    s_waitcnt lgkmcnt(10)
    ds_read_b64_tr_b16 a[242:243], v243 offset:4096
    ds_read_b64_tr_b16 a[244:245], v243 offset:8192
    v_mfma_f32_16x16x32_bf16 v[144:147], a[224:227], a[200:203], v[144:147]
    s_waitcnt lgkmcnt(11)
    ds_read_b64_tr_b16 a[246:247], v243 offset:12288
    v_mfma_f32_16x16x32_bf16 v[144:147], a[228:231], a[204:207], v[144:147]
    s_waitcnt lgkmcnt(11)
    v_exp_f32 v127, v127
    v_mfma_f32_16x16x32_bf16 v[132:135], a[208:211], a[144:147], 0
    s_waitcnt lgkmcnt(10)
    v_cvt_pk_bf16_f32 v189, v126, v127
    v_mfma_f32_16x16x32_bf16 v[132:135], a[212:215], a[156:159], v[132:135]
    s_waitcnt lgkmcnt(9)
    v_exp_f32 v128, v128
    v_mfma_f32_16x16x32_bf16 v[132:135], a[216:219], a[168:171], v[132:135]
    s_waitcnt lgkmcnt(8)
    v_exp_f32 v144, v144
    v_mfma_f32_16x16x32_bf16 v[132:135], a[220:223], a[180:183], v[132:135]
    v_exp_f32 v145, v145
    v_mfma_f32_16x16x32_bf16 v[136:139], a[208:211], a[148:151], 0
    v_exp_f32 v146, v146
    v_mfma_f32_16x16x32_bf16 v[136:139], a[212:215], a[160:163], v[136:139]
    v_exp_f32 v147, v147
    v_mfma_f32_16x16x32_bf16 v[136:139], a[216:219], a[172:175], v[136:139]
    v_cvt_pk_bf16_f32 v204, v144, v145
    v_cvt_pk_bf16_f32 v205, v146, v147
    v_mfma_f32_16x16x32_bf16 v[136:139], a[220:223], a[184:187], v[136:139]
    ds_write_b64 v246, v[204:205] offset:2048
    v_mfma_f32_16x16x32_bf16 v[140:143], a[208:211], a[152:155], 0
    v_exp_f32 v129, v129
    v_mfma_f32_16x16x32_bf16 v[140:143], a[212:215], a[164:167], v[140:143]
    v_exp_f32 v130, v130
    v_mfma_f32_16x16x32_bf16 v[140:143], a[216:219], a[176:179], v[140:143]
    v_exp_f32 v131, v131
    v_mfma_f32_16x16x32_bf16 v[140:143], a[220:223], a[188:191], v[140:143]
    s_waitcnt vmcnt(16) lgkmcnt(0)
    v_cvt_pk_bf16_f32 v192, v128, v129
    v_cvt_pk_bf16_f32 v193, v130, v131
    v_exp_f32 v132, v132
    s_barrier
    v_mfma_f32_16x16x32_bf16 v[72:75], a[232:235], v[148:151], 0
    ds_read_b128 a[208:211], v228 offset:32768
    v_mfma_f32_16x16x32_bf16 v[72:75], a[236:239], v[160:163], v[72:75]
    ds_read_b128 a[212:215], v229 offset:32768
    v_mfma_f32_16x16x32_bf16 v[76:79], a[232:235], v[152:155], 0
    ds_read_b128 a[216:219], v230 offset:32768
    v_mfma_f32_16x16x32_bf16 v[76:79], a[236:239], v[164:167], v[76:79]
    ds_read_b128 a[220:223], v231 offset:32768
    v_mfma_f32_16x16x32_bf16 v[80:83], a[232:235], v[156:159], 0
    ds_read_b64_tr_b16 a[232:233], v236 offset:16384
    v_mfma_f32_16x16x32_bf16 v[80:83], a[236:239], v[168:171], v[80:83]
    s_add_u32 s46, s40, 81920
    s_add_u32 m0, s41, 16384
    ds_read_b64_tr_b16 a[234:235], v236 offset:20480
    v_mfma_f32_16x16x32_bf16 v[84:87], a[240:243], v[148:151], 0
    buffer_load_dwordx4 v247, s[20:23], s46 offen offset:0 nt lds
    v_mfma_f32_16x16x32_bf16 v[84:87], a[244:247], v[160:163], v[84:87]
    ds_read_b64_tr_b16 a[236:237], v236 offset:24576
    v_mfma_f32_16x16x32_bf16 v[88:91], a[240:243], v[152:155], 0
    ds_read_b64_tr_b16 a[238:239], v236 offset:28672
    v_mfma_f32_16x16x32_bf16 v[88:91], a[244:247], v[164:167], v[88:91]
    v_exp_f32 v133, v133
    v_mfma_f32_16x16x32_bf16 v[92:95], a[240:243], v[156:159], 0
    buffer_load_dwordx4 v248, s[20:23], s46 offen offset:1024 nt lds
    v_cvt_pk_bf16_f32 v186, v132, v133
    v_mfma_f32_16x16x32_bf16 v[92:95], a[244:247], v[168:171], v[92:95]
    v_exp_f32 v134, v134
    v_mfma_f32_16x16x32_bf16 v[116:119], a[248:251], v[196:199], 0
    v_exp_f32 v135, v135
    v_mfma_f32_16x16x32_bf16 v[116:119], a[248:251], v[200:203], v[116:119]
    s_waitcnt lgkmcnt(7)
    v_cvt_pk_bf16_f32 v187, v134, v135
    v_mfma_f32_16x16x32_bf16 v[120:123], a[208:211], a[144:147], 0
    s_waitcnt lgkmcnt(6)
    ds_read_b128 v[196:199], v244 offset:18432
    ds_read_b128 v[200:203], v244 offset:19456
    v_mfma_f32_16x16x32_bf16 v[120:123], a[212:215], a[156:159], v[120:123]
    s_waitcnt lgkmcnt(7)
    buffer_load_dwordx4 v247, s[20:23], s46 offen offset:2048 nt lds
    ds_read_b64_tr_b16 a[240:241], v237 offset:16384
    v_mfma_f32_16x16x32_bf16 v[120:123], a[216:219], a[168:171], v[120:123]
    s_waitcnt lgkmcnt(7)
    v_exp_f32 v136, v136
    v_mfma_f32_16x16x32_bf16 v[120:123], a[220:223], a[180:183], v[120:123]
    v_exp_f32 v137, v137
    v_mfma_f32_16x16x32_bf16 v[124:127], a[208:211], a[148:151], 0
    v_exp_f32 v138, v138
    v_mfma_f32_16x16x32_bf16 v[124:127], a[212:215], a[160:163], v[124:127]
    v_exp_f32 v139, v139
    v_mfma_f32_16x16x32_bf16 v[124:127], a[216:219], a[172:175], v[124:127]
    buffer_load_dwordx4 v248, s[20:23], s46 offen offset:3072 nt lds
    v_cvt_pk_bf16_f32 v190, v136, v137
    v_mfma_f32_16x16x32_bf16 v[124:127], a[220:223], a[184:187], v[124:127]
    v_cvt_pk_bf16_f32 v191, v138, v139
    v_mfma_f32_16x16x32_bf16 v[128:131], a[208:211], a[152:155], 0
    ds_read_b64_tr_b16 a[242:243], v237 offset:20480
    v_mfma_f32_16x16x32_bf16 v[128:131], a[212:215], a[164:167], v[128:131]
    v_exp_f32 v140, v140
    v_mfma_f32_16x16x32_bf16 v[128:131], a[216:219], a[176:179], v[128:131]
    v_exp_f32 v141, v141
    v_mfma_f32_16x16x32_bf16 v[128:131], a[220:223], a[188:191], v[128:131]
    v_exp_f32 v142, v142
    v_mfma_f32_16x16x32_bf16 v[104:107], a[248:251], v[172:175], v[104:107]
    v_exp_f32 v143, v143
    v_mfma_f32_16x16x32_bf16 v[104:107], a[248:251], v[184:187], v[104:107]
    s_waitcnt lgkmcnt(6)
    ds_read_b64_tr_b16 a[244:245], v237 offset:24576
    ds_read_b64_tr_b16 a[246:247], v237 offset:28672
    v_mfma_f32_16x16x32_bf16 v[0:3], a[232:235], v[172:175], v[0:3]
    s_waitcnt lgkmcnt(6)
    v_cvt_pk_bf16_f32 v194, v140, v141
    v_cvt_pk_bf16_f32 v195, v142, v143
    v_mfma_f32_16x16x32_bf16 v[0:3], a[236:239], v[184:187], v[0:3]
    ds_read_b128 a[208:211], v228 offset:36864
    v_mfma_f32_16x16x32_bf16 v[4:7], a[232:235], v[176:179], v[4:7]
    ds_read_b128 a[212:215], v229 offset:36864
    v_mfma_f32_16x16x32_bf16 v[4:7], a[236:239], v[188:191], v[4:7]
    ds_read_b128 a[216:219], v230 offset:36864
    v_mfma_f32_16x16x32_bf16 v[8:11], a[232:235], v[180:183], v[8:11]
    ds_read_b128 a[220:223], v231 offset:36864
    v_mfma_f32_16x16x32_bf16 v[8:11], a[236:239], v[192:195], v[8:11]
    s_waitcnt lgkmcnt(9)
    ds_read_b128 a[224:227], v232 offset:32768
    ds_read_b128 a[228:231], v233 offset:32768
    v_mfma_f32_16x16x32_bf16 v[96:99], a[232:235], v[196:199], v[96:99]
    s_waitcnt lgkmcnt(10)
    ds_read_b64_tr_b16 a[232:233], v238 offset:16384
    ds_read_b64_tr_b16 a[234:235], v238 offset:20480
    v_mfma_f32_16x16x32_bf16 v[96:99], a[236:239], v[200:203], v[96:99]
    s_waitcnt lgkmcnt(10)
    ds_read_b64_tr_b16 a[236:237], v238 offset:24576
    ds_read_b64_tr_b16 a[238:239], v238 offset:28672
    v_mfma_f32_16x16x32_bf16 v[12:15], a[240:243], v[172:175], v[12:15]
    s_waitcnt lgkmcnt(10)
    v_exp_f32 v120, v120
    v_mfma_f32_16x16x32_bf16 v[12:15], a[244:247], v[184:187], v[12:15]
    v_exp_f32 v121, v121
    v_mfma_f32_16x16x32_bf16 v[16:19], a[240:243], v[176:179], v[16:19]
    v_exp_f32 v122, v122
    v_mfma_f32_16x16x32_bf16 v[16:19], a[244:247], v[188:191], v[16:19]
    s_add_u32 s46, s40, 65536
    s_add_u32 m0, s41, 65536
    v_exp_f32 v123, v123
    v_mfma_f32_16x16x32_bf16 v[20:23], a[240:243], v[180:183], v[20:23]
    buffer_load_dwordx4 v247, s[24:27], s46 offen offset:0 nt lds
    v_cvt_pk_bf16_f32 v148, v120, v121
    v_mfma_f32_16x16x32_bf16 v[20:23], a[244:247], v[192:195], v[20:23]
    v_cvt_pk_bf16_f32 v149, v122, v123
    v_mfma_f32_16x16x32_bf16 v[100:103], a[240:243], v[196:199], v[100:103]
    ds_read_b64_tr_b16 a[240:241], v239 offset:16384
    v_mfma_f32_16x16x32_bf16 v[100:103], a[244:247], v[200:203], v[100:103]
    s_waitcnt lgkmcnt(10)
    ds_read_b64_tr_b16 a[242:243], v239 offset:20480
    ds_read_b64_tr_b16 a[244:245], v239 offset:24576
    v_mfma_f32_16x16x32_bf16 v[132:135], a[208:211], a[144:147], 0
    s_waitcnt lgkmcnt(11)
    buffer_load_dwordx4 v248, s[24:27], s46 offen offset:1024 nt lds
    ds_read_b64_tr_b16 a[246:247], v239 offset:28672
    v_mfma_f32_16x16x32_bf16 v[132:135], a[212:215], a[156:159], v[132:135]
    s_waitcnt lgkmcnt(11)
    v_exp_f32 v124, v124
    v_mfma_f32_16x16x32_bf16 v[132:135], a[216:219], a[168:171], v[132:135]
    s_waitcnt lgkmcnt(10)
    v_exp_f32 v125, v125
    v_mfma_f32_16x16x32_bf16 v[132:135], a[220:223], a[180:183], v[132:135]
    v_exp_f32 v126, v126
    v_mfma_f32_16x16x32_bf16 v[136:139], a[208:211], a[148:151], 0
    v_exp_f32 v127, v127
    v_mfma_f32_16x16x32_bf16 v[136:139], a[212:215], a[160:163], v[136:139]
    buffer_load_dwordx4 v247, s[24:27], s46 offen offset:2048 nt lds
    v_cvt_pk_bf16_f32 v152, v124, v125
    v_mfma_f32_16x16x32_bf16 v[136:139], a[216:219], a[172:175], v[136:139]
    v_cvt_pk_bf16_f32 v153, v126, v127
    v_mfma_f32_16x16x32_bf16 v[136:139], a[220:223], a[184:187], v[136:139]
    v_exp_f32 v128, v128
    v_mfma_f32_16x16x32_bf16 v[140:143], a[208:211], a[152:155], 0
    ds_read_b128 a[208:211], v228 offset:40960
    v_mfma_f32_16x16x32_bf16 v[140:143], a[212:215], a[164:167], v[140:143]
    ds_read_b128 a[212:215], v229 offset:40960
    v_mfma_f32_16x16x32_bf16 v[140:143], a[216:219], a[176:179], v[140:143]
    buffer_load_dwordx4 v248, s[24:27], s46 offen offset:3072 nt lds
    v_mfma_f32_16x16x32_bf16 v[140:143], a[220:223], a[188:191], v[140:143]
    ds_read_b128 a[216:219], v230 offset:40960
    v_mfma_f32_16x16x32_bf16 v[108:111], a[248:251], v[176:179], v[108:111]
    ds_read_b128 a[220:223], v231 offset:40960
    v_mfma_f32_16x16x32_bf16 v[108:111], a[248:251], v[188:191], v[108:111]
    s_waitcnt lgkmcnt(10)
    v_exp_f32 v129, v129
    v_mfma_f32_16x16x32_bf16 v[24:27], a[232:235], v[172:175], v[24:27]
    s_waitcnt lgkmcnt(8)
    v_exp_f32 v130, v130
    v_mfma_f32_16x16x32_bf16 v[24:27], a[236:239], v[184:187], v[24:27]
    v_exp_f32 v131, v131
    v_mfma_f32_16x16x32_bf16 v[28:31], a[232:235], v[176:179], v[28:31]
    v_cvt_pk_bf16_f32 v156, v128, v129
    v_cvt_pk_bf16_f32 v157, v130, v131
    v_mfma_f32_16x16x32_bf16 v[28:31], a[236:239], v[188:191], v[28:31]
    v_exp_f32 v132, v132
    v_mfma_f32_16x16x32_bf16 v[32:35], a[232:235], v[180:183], v[32:35]
    ds_read_b64_tr_b16 a[232:233], v240 offset:16384
    v_mfma_f32_16x16x32_bf16 v[32:35], a[236:239], v[192:195], v[32:35]
    s_waitcnt lgkmcnt(7)
    ds_read_b64_tr_b16 a[234:235], v240 offset:20480
    ds_read_b64_tr_b16 a[236:237], v240 offset:24576
    v_mfma_f32_16x16x32_bf16 v[36:39], a[240:243], v[172:175], v[36:39]
    s_waitcnt lgkmcnt(7)
    ds_read_b64_tr_b16 a[238:239], v240 offset:28672
    v_mfma_f32_16x16x32_bf16 v[36:39], a[244:247], v[184:187], v[36:39]
    v_exp_f32 v133, v133
    v_mfma_f32_16x16x32_bf16 v[40:43], a[240:243], v[176:179], v[40:43]
    v_exp_f32 v134, v134
    v_mfma_f32_16x16x32_bf16 v[40:43], a[244:247], v[188:191], v[40:43]
    v_exp_f32 v135, v135
    v_mfma_f32_16x16x32_bf16 v[44:47], a[240:243], v[180:183], v[44:47]
    ds_read_b64_tr_b16 a[240:241], v241 offset:16384
    v_cvt_pk_bf16_f32 v150, v132, v133
    v_mfma_f32_16x16x32_bf16 v[44:47], a[244:247], v[192:195], v[44:47]
    ds_read_b64_tr_b16 a[242:243], v241 offset:20480
    v_cvt_pk_bf16_f32 v151, v134, v135
    v_mfma_f32_16x16x32_bf16 v[144:147], a[224:227], a[192:195], 0
    ds_read_b64_tr_b16 a[244:245], v241 offset:24576
    v_mfma_f32_16x16x32_bf16 v[144:147], a[228:231], a[196:199], v[144:147]
    s_waitcnt lgkmcnt(10)
    ds_read_b64_tr_b16 a[246:247], v241 offset:28672
    ds_read_b128 a[224:227], v234 offset:32768
    v_mfma_f32_16x16x32_bf16 v[120:123], a[208:211], a[144:147], 0
    s_waitcnt lgkmcnt(11)
    ds_read_b128 a[228:231], v235 offset:32768
    v_mfma_f32_16x16x32_bf16 v[120:123], a[212:215], a[156:159], v[120:123]
    s_waitcnt lgkmcnt(11)
    v_exp_f32 v136, v136
    v_mfma_f32_16x16x32_bf16 v[120:123], a[216:219], a[168:171], v[120:123]
    s_waitcnt lgkmcnt(10)
    v_exp_f32 v137, v137
    v_mfma_f32_16x16x32_bf16 v[120:123], a[220:223], a[180:183], v[120:123]
    v_exp_f32 v138, v138
    v_mfma_f32_16x16x32_bf16 v[124:127], a[208:211], a[148:151], 0
    v_exp_f32 v139, v139
    v_mfma_f32_16x16x32_bf16 v[124:127], a[212:215], a[160:163], v[124:127]
    v_cvt_pk_bf16_f32 v154, v136, v137
    v_cvt_pk_bf16_f32 v155, v138, v139
    v_mfma_f32_16x16x32_bf16 v[124:127], a[216:219], a[172:175], v[124:127]
    v_exp_f32 v140, v140
    v_mfma_f32_16x16x32_bf16 v[124:127], a[220:223], a[184:187], v[124:127]
    v_exp_f32 v141, v141
    v_mfma_f32_16x16x32_bf16 v[128:131], a[208:211], a[152:155], 0
    ds_read_b128 a[208:211], v228 offset:45056
    v_cvt_pk_bf16_f32 v158, v140, v141
    v_mfma_f32_16x16x32_bf16 v[128:131], a[212:215], a[164:167], v[128:131]
    ds_read_b128 a[212:215], v229 offset:45056
    v_mfma_f32_16x16x32_bf16 v[128:131], a[216:219], a[176:179], v[128:131]
    ds_read_b128 a[216:219], v230 offset:45056
    v_mfma_f32_16x16x32_bf16 v[128:131], a[220:223], a[188:191], v[128:131]
    ds_read_b128 a[220:223], v231 offset:45056
    v_mfma_f32_16x16x32_bf16 v[112:115], a[248:251], v[180:183], v[112:115]
    v_exp_f32 v142, v142
    v_mfma_f32_16x16x32_bf16 v[112:115], a[248:251], v[192:195], v[112:115]
    s_waitcnt lgkmcnt(12)
    v_exp_f32 v143, v143
    v_mfma_f32_16x16x32_bf16 v[48:51], a[232:235], v[172:175], v[48:51]
    s_waitcnt lgkmcnt(10)
    v_cvt_pk_bf16_f32 v159, v142, v143
    v_mfma_f32_16x16x32_bf16 v[48:51], a[236:239], v[184:187], v[48:51]
    v_exp_f32 v120, v120
    v_mfma_f32_16x16x32_bf16 v[52:55], a[232:235], v[176:179], v[52:55]
    v_exp_f32 v121, v121
    v_mfma_f32_16x16x32_bf16 v[52:55], a[236:239], v[188:191], v[52:55]
    v_exp_f32 v122, v122
    v_mfma_f32_16x16x32_bf16 v[56:59], a[232:235], v[180:183], v[56:59]
    ds_read_b64_tr_b16 a[232:233], v242 offset:16384
    v_cvt_pk_bf16_f32 v160, v120, v121
    v_mfma_f32_16x16x32_bf16 v[56:59], a[236:239], v[192:195], v[56:59]
    s_waitcnt lgkmcnt(9)
    ds_read_b64_tr_b16 a[234:235], v242 offset:20480
    ds_read_b64_tr_b16 a[236:237], v242 offset:24576
    v_mfma_f32_16x16x32_bf16 v[60:63], a[240:243], v[172:175], v[60:63]
    s_waitcnt lgkmcnt(9)
    ds_read_b64_tr_b16 a[238:239], v242 offset:28672
    v_mfma_f32_16x16x32_bf16 v[60:63], a[244:247], v[184:187], v[60:63]
    v_exp_f32 v123, v123
    v_mfma_f32_16x16x32_bf16 v[64:67], a[240:243], v[176:179], v[64:67]
    v_cvt_pk_bf16_f32 v161, v122, v123
    v_mfma_f32_16x16x32_bf16 v[64:67], a[244:247], v[188:191], v[64:67]
    v_exp_f32 v124, v124
    v_mfma_f32_16x16x32_bf16 v[68:71], a[240:243], v[180:183], v[68:71]
    ds_read_b64_tr_b16 a[240:241], v243 offset:16384
    v_mfma_f32_16x16x32_bf16 v[68:71], a[244:247], v[192:195], v[68:71]
    s_waitcnt lgkmcnt(10)
    ds_read_b64_tr_b16 a[242:243], v243 offset:20480
    ds_read_b64_tr_b16 a[244:245], v243 offset:24576
    v_mfma_f32_16x16x32_bf16 v[144:147], a[224:227], a[200:203], v[144:147]
    s_waitcnt lgkmcnt(11)
    ds_read_b64_tr_b16 a[246:247], v243 offset:28672
    v_mfma_f32_16x16x32_bf16 v[144:147], a[228:231], a[204:207], v[144:147]
    s_waitcnt lgkmcnt(11)
    v_exp_f32 v125, v125
    v_mfma_f32_16x16x32_bf16 v[132:135], a[208:211], a[144:147], 0
    s_waitcnt lgkmcnt(10)
    v_exp_f32 v126, v126
    v_mfma_f32_16x16x32_bf16 v[132:135], a[212:215], a[156:159], v[132:135]
    s_waitcnt lgkmcnt(9)
    v_exp_f32 v127, v127
    v_mfma_f32_16x16x32_bf16 v[132:135], a[216:219], a[168:171], v[132:135]
    s_waitcnt lgkmcnt(8)
    v_exp_f32 v144, v144
    v_mfma_f32_16x16x32_bf16 v[132:135], a[220:223], a[180:183], v[132:135]
    v_exp_f32 v145, v145
    v_mfma_f32_16x16x32_bf16 v[136:139], a[208:211], a[148:151], 0
    v_exp_f32 v146, v146
    v_mfma_f32_16x16x32_bf16 v[136:139], a[212:215], a[160:163], v[136:139]
    v_exp_f32 v147, v147
    v_mfma_f32_16x16x32_bf16 v[136:139], a[216:219], a[172:175], v[136:139]
    v_cvt_pk_bf16_f32 v204, v144, v145
    v_cvt_pk_bf16_f32 v205, v146, v147
    v_mfma_f32_16x16x32_bf16 v[136:139], a[220:223], a[184:187], v[136:139]
    ds_write_b64 v246, v[204:205] offset:0
    v_mfma_f32_16x16x32_bf16 v[140:143], a[208:211], a[152:155], 0
    v_cvt_pk_bf16_f32 v164, v124, v125
    v_cvt_pk_bf16_f32 v165, v126, v127
    v_mfma_f32_16x16x32_bf16 v[140:143], a[212:215], a[164:167], v[140:143]
    v_exp_f32 v128, v128
    v_mfma_f32_16x16x32_bf16 v[140:143], a[216:219], a[176:179], v[140:143]
    v_exp_f32 v129, v129
    v_mfma_f32_16x16x32_bf16 v[140:143], a[220:223], a[188:191], v[140:143]
    s_waitcnt vmcnt(16) lgkmcnt(0)
    v_exp_f32 v130, v130
    v_exp_f32 v131, v131
    s_barrier
    v_mfma_f32_16x16x32_bf16 v[72:75], a[232:235], v[172:175], v[72:75]
    ds_read_b128 a[208:211], v228 offset:49152
    v_cvt_pk_bf16_f32 v168, v128, v129
    v_mfma_f32_16x16x32_bf16 v[72:75], a[236:239], v[184:187], v[72:75]
    ds_read_b128 a[212:215], v229 offset:49152
    v_cvt_pk_bf16_f32 v169, v130, v131
    v_mfma_f32_16x16x32_bf16 v[76:79], a[232:235], v[176:179], v[76:79]
    ds_read_b128 a[216:219], v230 offset:49152
    v_mfma_f32_16x16x32_bf16 v[76:79], a[236:239], v[188:191], v[76:79]
    ds_read_b128 a[220:223], v231 offset:49152
    v_mfma_f32_16x16x32_bf16 v[80:83], a[232:235], v[180:183], v[80:83]
    ds_read_b64_tr_b16 a[232:233], v236 offset:32768
    v_mfma_f32_16x16x32_bf16 v[80:83], a[236:239], v[192:195], v[80:83]
    s_add_u32 s46, s40, 98304
    s_add_u32 m0, s41, 32768
    ds_read_b64_tr_b16 a[234:235], v236 offset:36864
    v_mfma_f32_16x16x32_bf16 v[84:87], a[240:243], v[172:175], v[84:87]
    buffer_load_dwordx4 v247, s[20:23], s46 offen offset:0 nt lds
    v_mfma_f32_16x16x32_bf16 v[84:87], a[244:247], v[184:187], v[84:87]
    ds_read_b64_tr_b16 a[236:237], v236 offset:40960
    v_mfma_f32_16x16x32_bf16 v[88:91], a[240:243], v[176:179], v[88:91]
    ds_read_b64_tr_b16 a[238:239], v236 offset:45056
    v_mfma_f32_16x16x32_bf16 v[88:91], a[244:247], v[188:191], v[88:91]
    v_exp_f32 v132, v132
    v_mfma_f32_16x16x32_bf16 v[92:95], a[240:243], v[180:183], v[92:95]
    buffer_load_dwordx4 v248, s[20:23], s46 offen offset:1024 nt lds
    v_mfma_f32_16x16x32_bf16 v[92:95], a[244:247], v[192:195], v[92:95]
    v_exp_f32 v133, v133
    v_mfma_f32_16x16x32_bf16 v[116:119], a[248:251], v[196:199], v[116:119]
    v_exp_f32 v134, v134
    v_mfma_f32_16x16x32_bf16 v[116:119], a[248:251], v[200:203], v[116:119]
    s_waitcnt lgkmcnt(7)
    v_exp_f32 v135, v135
    v_mfma_f32_16x16x32_bf16 v[120:123], a[208:211], a[144:147], 0
    s_waitcnt lgkmcnt(6)
    v_cvt_pk_bf16_f32 v162, v132, v133
    v_cvt_pk_bf16_f32 v163, v134, v135
    v_mfma_f32_16x16x32_bf16 v[120:123], a[212:215], a[156:159], v[120:123]
    s_waitcnt lgkmcnt(5)
    buffer_load_dwordx4 v247, s[20:23], s46 offen offset:2048 nt lds
    ds_read_b128 v[196:199], v244 offset:16384
    v_mfma_f32_16x16x32_bf16 v[120:123], a[216:219], a[168:171], v[120:123]
    s_waitcnt lgkmcnt(5)
    v_exp_f32 v136, v136
    v_mfma_f32_16x16x32_bf16 v[120:123], a[220:223], a[180:183], v[120:123]
    v_exp_f32 v137, v137
    v_mfma_f32_16x16x32_bf16 v[124:127], a[208:211], a[148:151], 0
    v_exp_f32 v138, v138
    v_mfma_f32_16x16x32_bf16 v[124:127], a[212:215], a[160:163], v[124:127]
    v_exp_f32 v139, v139
    v_mfma_f32_16x16x32_bf16 v[124:127], a[216:219], a[172:175], v[124:127]
    buffer_load_dwordx4 v248, s[20:23], s46 offen offset:3072 nt lds
    v_cvt_pk_bf16_f32 v166, v136, v137
    v_mfma_f32_16x16x32_bf16 v[124:127], a[220:223], a[184:187], v[124:127]
    ds_read_b128 v[200:203], v244 offset:17408
    v_cvt_pk_bf16_f32 v167, v138, v139
    v_mfma_f32_16x16x32_bf16 v[128:131], a[208:211], a[152:155], 0
    ds_read_b64_tr_b16 a[240:241], v237 offset:32768
    v_mfma_f32_16x16x32_bf16 v[128:131], a[212:215], a[164:167], v[128:131]
    ds_read_b64_tr_b16 a[242:243], v237 offset:36864
    v_mfma_f32_16x16x32_bf16 v[128:131], a[216:219], a[176:179], v[128:131]
    v_exp_f32 v140, v140
    v_mfma_f32_16x16x32_bf16 v[128:131], a[220:223], a[188:191], v[128:131]
    v_exp_f32 v141, v141
    v_mfma_f32_16x16x32_bf16 v[104:107], a[248:251], v[148:151], v[104:107]
    v_exp_f32 v142, v142
    v_mfma_f32_16x16x32_bf16 v[104:107], a[248:251], v[160:163], v[104:107]
    s_waitcnt lgkmcnt(6)
    v_exp_f32 v143, v143
    v_mfma_f32_16x16x32_bf16 v[0:3], a[232:235], v[148:151], v[0:3]
    s_waitcnt lgkmcnt(4)
    ds_read_b64_tr_b16 a[244:245], v237 offset:40960
    ds_read_b64_tr_b16 a[246:247], v237 offset:45056
    v_mfma_f32_16x16x32_bf16 v[0:3], a[236:239], v[160:163], v[0:3]
    v_cvt_pk_bf16_f32 v170, v140, v141
    v_cvt_pk_bf16_f32 v171, v142, v143
    v_mfma_f32_16x16x32_bf16 v[4:7], a[232:235], v[152:155], v[4:7]
    ds_read_b128 a[208:211], v228 offset:53248
    v_mfma_f32_16x16x32_bf16 v[4:7], a[236:239], v[164:167], v[4:7]
    ds_read_b128 a[212:215], v229 offset:53248
    v_mfma_f32_16x16x32_bf16 v[8:11], a[232:235], v[156:159], v[8:11]
    ds_read_b128 a[216:219], v230 offset:53248
    v_mfma_f32_16x16x32_bf16 v[8:11], a[236:239], v[168:171], v[8:11]
    s_waitcnt lgkmcnt(8)
    ds_read_b128 a[220:223], v231 offset:53248
    ds_read_b128 a[224:227], v232 offset:49152
    v_mfma_f32_16x16x32_bf16 v[96:99], a[232:235], v[196:199], v[96:99]
    s_waitcnt lgkmcnt(9)
    ds_read_b64_tr_b16 a[232:233], v238 offset:32768
    ds_read_b64_tr_b16 a[234:235], v238 offset:36864
    v_mfma_f32_16x16x32_bf16 v[96:99], a[236:239], v[200:203], v[96:99]
    s_waitcnt lgkmcnt(9)
    ds_read_b64_tr_b16 a[236:237], v238 offset:40960
    ds_read_b64_tr_b16 a[238:239], v238 offset:45056
    v_mfma_f32_16x16x32_bf16 v[12:15], a[240:243], v[148:151], v[12:15]
    s_waitcnt lgkmcnt(9)
    ds_read_b128 a[228:231], v233 offset:49152
    v_mfma_f32_16x16x32_bf16 v[12:15], a[244:247], v[160:163], v[12:15]
    v_exp_f32 v120, v120
    v_mfma_f32_16x16x32_bf16 v[16:19], a[240:243], v[152:155], v[16:19]
    v_exp_f32 v121, v121
    v_mfma_f32_16x16x32_bf16 v[16:19], a[244:247], v[164:167], v[16:19]
    s_add_u32 s46, s40, 81920
    s_add_u32 m0, s41, 81920
    v_exp_f32 v122, v122
    v_mfma_f32_16x16x32_bf16 v[20:23], a[240:243], v[156:159], v[20:23]
    buffer_load_dwordx4 v247, s[24:27], s46 offen offset:0 nt lds
    v_cvt_pk_bf16_f32 v172, v120, v121
    v_mfma_f32_16x16x32_bf16 v[20:23], a[244:247], v[168:171], v[20:23]
    v_exp_f32 v123, v123
    v_mfma_f32_16x16x32_bf16 v[100:103], a[240:243], v[196:199], v[100:103]
    ds_read_b64_tr_b16 a[240:241], v239 offset:32768
    v_cvt_pk_bf16_f32 v173, v122, v123
    v_mfma_f32_16x16x32_bf16 v[100:103], a[244:247], v[200:203], v[100:103]
    s_waitcnt lgkmcnt(10)
    ds_read_b64_tr_b16 a[242:243], v239 offset:36864
    ds_read_b64_tr_b16 a[244:245], v239 offset:40960
    v_mfma_f32_16x16x32_bf16 v[132:135], a[208:211], a[144:147], 0
    s_waitcnt lgkmcnt(11)
    buffer_load_dwordx4 v248, s[24:27], s46 offen offset:1024 nt lds
    ds_read_b64_tr_b16 a[246:247], v239 offset:45056
    v_mfma_f32_16x16x32_bf16 v[132:135], a[212:215], a[156:159], v[132:135]
    s_waitcnt lgkmcnt(11)
    v_exp_f32 v124, v124
    v_mfma_f32_16x16x32_bf16 v[132:135], a[216:219], a[168:171], v[132:135]
    s_waitcnt lgkmcnt(10)
    v_exp_f32 v125, v125
    v_mfma_f32_16x16x32_bf16 v[132:135], a[220:223], a[180:183], v[132:135]
    v_exp_f32 v126, v126
    v_mfma_f32_16x16x32_bf16 v[136:139], a[208:211], a[148:151], 0
    v_exp_f32 v127, v127
    v_mfma_f32_16x16x32_bf16 v[136:139], a[212:215], a[160:163], v[136:139]
    buffer_load_dwordx4 v247, s[24:27], s46 offen offset:2048 nt lds
    v_cvt_pk_bf16_f32 v176, v124, v125
    v_mfma_f32_16x16x32_bf16 v[136:139], a[216:219], a[172:175], v[136:139]
    v_cvt_pk_bf16_f32 v177, v126, v127
    v_mfma_f32_16x16x32_bf16 v[136:139], a[220:223], a[184:187], v[136:139]
    v_exp_f32 v128, v128
    v_mfma_f32_16x16x32_bf16 v[140:143], a[208:211], a[152:155], 0
    ds_read_b128 a[208:211], v228 offset:57344
    v_mfma_f32_16x16x32_bf16 v[140:143], a[212:215], a[164:167], v[140:143]
    ds_read_b128 a[212:215], v229 offset:57344
    v_mfma_f32_16x16x32_bf16 v[140:143], a[216:219], a[176:179], v[140:143]
    buffer_load_dwordx4 v248, s[24:27], s46 offen offset:3072 nt lds
    v_mfma_f32_16x16x32_bf16 v[140:143], a[220:223], a[188:191], v[140:143]
    ds_read_b128 a[216:219], v230 offset:57344
    v_mfma_f32_16x16x32_bf16 v[108:111], a[248:251], v[152:155], v[108:111]
    ds_read_b128 a[220:223], v231 offset:57344
    v_mfma_f32_16x16x32_bf16 v[108:111], a[248:251], v[164:167], v[108:111]
    s_waitcnt lgkmcnt(11)
    v_exp_f32 v129, v129
    v_mfma_f32_16x16x32_bf16 v[24:27], a[232:235], v[148:151], v[24:27]
    s_waitcnt lgkmcnt(9)
    v_exp_f32 v130, v130
    v_mfma_f32_16x16x32_bf16 v[24:27], a[236:239], v[160:163], v[24:27]
    v_exp_f32 v131, v131
    v_mfma_f32_16x16x32_bf16 v[28:31], a[232:235], v[152:155], v[28:31]
    v_cvt_pk_bf16_f32 v180, v128, v129
    v_cvt_pk_bf16_f32 v181, v130, v131
    v_mfma_f32_16x16x32_bf16 v[28:31], a[236:239], v[164:167], v[28:31]
    v_exp_f32 v132, v132
    v_mfma_f32_16x16x32_bf16 v[32:35], a[232:235], v[156:159], v[32:35]
    ds_read_b64_tr_b16 a[232:233], v240 offset:32768
    v_mfma_f32_16x16x32_bf16 v[32:35], a[236:239], v[168:171], v[32:35]
    s_waitcnt lgkmcnt(7)
    ds_read_b64_tr_b16 a[234:235], v240 offset:36864
    ds_read_b64_tr_b16 a[236:237], v240 offset:40960
    v_mfma_f32_16x16x32_bf16 v[36:39], a[240:243], v[148:151], v[36:39]
    s_waitcnt lgkmcnt(7)
    ds_read_b64_tr_b16 a[238:239], v240 offset:45056
    v_mfma_f32_16x16x32_bf16 v[36:39], a[244:247], v[160:163], v[36:39]
    v_exp_f32 v133, v133
    v_mfma_f32_16x16x32_bf16 v[40:43], a[240:243], v[152:155], v[40:43]
    v_exp_f32 v134, v134
    v_mfma_f32_16x16x32_bf16 v[40:43], a[244:247], v[164:167], v[40:43]
    v_exp_f32 v135, v135
    v_mfma_f32_16x16x32_bf16 v[44:47], a[240:243], v[156:159], v[44:47]
    ds_read_b64_tr_b16 a[240:241], v241 offset:32768
    v_cvt_pk_bf16_f32 v174, v132, v133
    v_mfma_f32_16x16x32_bf16 v[44:47], a[244:247], v[168:171], v[44:47]
    ds_read_b64_tr_b16 a[242:243], v241 offset:36864
    v_cvt_pk_bf16_f32 v175, v134, v135
    v_mfma_f32_16x16x32_bf16 v[144:147], a[224:227], a[192:195], 0
    ds_read_b64_tr_b16 a[244:245], v241 offset:40960
    v_mfma_f32_16x16x32_bf16 v[144:147], a[228:231], a[196:199], v[144:147]
    s_waitcnt lgkmcnt(10)
    ds_read_b64_tr_b16 a[246:247], v241 offset:45056
    ds_read_b128 a[224:227], v234 offset:49152
    v_mfma_f32_16x16x32_bf16 v[120:123], a[208:211], a[144:147], 0
    s_waitcnt lgkmcnt(11)
    ds_read_b128 a[228:231], v235 offset:49152
    v_mfma_f32_16x16x32_bf16 v[120:123], a[212:215], a[156:159], v[120:123]
    s_waitcnt lgkmcnt(11)
    v_exp_f32 v136, v136
    v_mfma_f32_16x16x32_bf16 v[120:123], a[216:219], a[168:171], v[120:123]
    s_waitcnt lgkmcnt(10)
    v_exp_f32 v137, v137
    v_mfma_f32_16x16x32_bf16 v[120:123], a[220:223], a[180:183], v[120:123]
    v_exp_f32 v138, v138
    v_mfma_f32_16x16x32_bf16 v[124:127], a[208:211], a[148:151], 0
    v_exp_f32 v139, v139
    v_mfma_f32_16x16x32_bf16 v[124:127], a[212:215], a[160:163], v[124:127]
    v_cvt_pk_bf16_f32 v178, v136, v137
    v_cvt_pk_bf16_f32 v179, v138, v139
    v_mfma_f32_16x16x32_bf16 v[124:127], a[216:219], a[172:175], v[124:127]
    v_exp_f32 v140, v140
    v_mfma_f32_16x16x32_bf16 v[124:127], a[220:223], a[184:187], v[124:127]
    v_exp_f32 v141, v141
    v_mfma_f32_16x16x32_bf16 v[128:131], a[208:211], a[152:155], 0
    ds_read_b128 a[208:211], v228 offset:61440
    v_cvt_pk_bf16_f32 v182, v140, v141
    v_mfma_f32_16x16x32_bf16 v[128:131], a[212:215], a[164:167], v[128:131]
    ds_read_b128 a[212:215], v229 offset:61440
    v_mfma_f32_16x16x32_bf16 v[128:131], a[216:219], a[176:179], v[128:131]
    ds_read_b128 a[216:219], v230 offset:61440
    v_mfma_f32_16x16x32_bf16 v[128:131], a[220:223], a[188:191], v[128:131]
    ds_read_b128 a[220:223], v231 offset:61440
    v_mfma_f32_16x16x32_bf16 v[112:115], a[248:251], v[156:159], v[112:115]
    v_exp_f32 v142, v142
    v_mfma_f32_16x16x32_bf16 v[112:115], a[248:251], v[168:171], v[112:115]
    s_waitcnt lgkmcnt(12)
    v_exp_f32 v143, v143
    v_mfma_f32_16x16x32_bf16 v[48:51], a[232:235], v[148:151], v[48:51]
    s_waitcnt lgkmcnt(10)
    v_cvt_pk_bf16_f32 v183, v142, v143
    v_mfma_f32_16x16x32_bf16 v[48:51], a[236:239], v[160:163], v[48:51]
    v_exp_f32 v120, v120
    v_mfma_f32_16x16x32_bf16 v[52:55], a[232:235], v[152:155], v[52:55]
    v_exp_f32 v121, v121
    v_mfma_f32_16x16x32_bf16 v[52:55], a[236:239], v[164:167], v[52:55]
    v_exp_f32 v122, v122
    v_mfma_f32_16x16x32_bf16 v[56:59], a[232:235], v[156:159], v[56:59]
    ds_read_b64_tr_b16 a[232:233], v242 offset:32768
    v_cvt_pk_bf16_f32 v184, v120, v121
    v_mfma_f32_16x16x32_bf16 v[56:59], a[236:239], v[168:171], v[56:59]
    s_waitcnt lgkmcnt(9)
    ds_read_b64_tr_b16 a[234:235], v242 offset:36864
    ds_read_b64_tr_b16 a[236:237], v242 offset:40960
    v_mfma_f32_16x16x32_bf16 v[60:63], a[240:243], v[148:151], v[60:63]
    s_waitcnt lgkmcnt(9)
    ds_read_b64_tr_b16 a[238:239], v242 offset:45056
    v_mfma_f32_16x16x32_bf16 v[60:63], a[244:247], v[160:163], v[60:63]
    v_exp_f32 v123, v123
    v_mfma_f32_16x16x32_bf16 v[64:67], a[240:243], v[152:155], v[64:67]
    v_cvt_pk_bf16_f32 v185, v122, v123
    v_mfma_f32_16x16x32_bf16 v[64:67], a[244:247], v[164:167], v[64:67]
    v_exp_f32 v124, v124
    v_mfma_f32_16x16x32_bf16 v[68:71], a[240:243], v[156:159], v[68:71]
    ds_read_b64_tr_b16 a[240:241], v243 offset:32768
    v_mfma_f32_16x16x32_bf16 v[68:71], a[244:247], v[168:171], v[68:71]
    s_waitcnt lgkmcnt(10)
    ds_read_b64_tr_b16 a[242:243], v243 offset:36864
    ds_read_b64_tr_b16 a[244:245], v243 offset:40960
    v_mfma_f32_16x16x32_bf16 v[144:147], a[224:227], a[200:203], v[144:147]
    s_waitcnt lgkmcnt(11)
    ds_read_b64_tr_b16 a[246:247], v243 offset:45056
    v_mfma_f32_16x16x32_bf16 v[144:147], a[228:231], a[204:207], v[144:147]
    s_waitcnt lgkmcnt(11)
    v_exp_f32 v125, v125
    v_mfma_f32_16x16x32_bf16 v[132:135], a[208:211], a[144:147], 0
    s_waitcnt lgkmcnt(10)
    v_exp_f32 v126, v126
    v_mfma_f32_16x16x32_bf16 v[132:135], a[212:215], a[156:159], v[132:135]
    s_waitcnt lgkmcnt(9)
    v_exp_f32 v127, v127
    v_mfma_f32_16x16x32_bf16 v[132:135], a[216:219], a[168:171], v[132:135]
    s_waitcnt lgkmcnt(8)
    v_exp_f32 v144, v144
    v_mfma_f32_16x16x32_bf16 v[132:135], a[220:223], a[180:183], v[132:135]
    v_exp_f32 v145, v145
    v_mfma_f32_16x16x32_bf16 v[136:139], a[208:211], a[148:151], 0
    v_exp_f32 v146, v146
    v_mfma_f32_16x16x32_bf16 v[136:139], a[212:215], a[160:163], v[136:139]
    v_exp_f32 v147, v147
    v_mfma_f32_16x16x32_bf16 v[136:139], a[216:219], a[172:175], v[136:139]
    v_cvt_pk_bf16_f32 v204, v144, v145
    v_cvt_pk_bf16_f32 v205, v146, v147
    v_mfma_f32_16x16x32_bf16 v[136:139], a[220:223], a[184:187], v[136:139]
    ds_write_b64 v246, v[204:205] offset:2048
    v_mfma_f32_16x16x32_bf16 v[140:143], a[208:211], a[152:155], 0
    v_cvt_pk_bf16_f32 v188, v124, v125
    v_cvt_pk_bf16_f32 v189, v126, v127
    v_mfma_f32_16x16x32_bf16 v[140:143], a[212:215], a[164:167], v[140:143]
    v_exp_f32 v128, v128
    v_mfma_f32_16x16x32_bf16 v[140:143], a[216:219], a[176:179], v[140:143]
    v_exp_f32 v129, v129
    v_mfma_f32_16x16x32_bf16 v[140:143], a[220:223], a[188:191], v[140:143]
    s_waitcnt vmcnt(16) lgkmcnt(0)
    v_exp_f32 v130, v130
    v_exp_f32 v131, v131
    s_barrier
    v_mfma_f32_16x16x32_bf16 v[72:75], a[232:235], v[148:151], v[72:75]
    ds_read_b128 a[208:211], v228 offset:0
    v_cvt_pk_bf16_f32 v192, v128, v129
    v_mfma_f32_16x16x32_bf16 v[72:75], a[236:239], v[160:163], v[72:75]
    ds_read_b128 a[212:215], v229 offset:0
    v_cvt_pk_bf16_f32 v193, v130, v131
    v_mfma_f32_16x16x32_bf16 v[76:79], a[232:235], v[152:155], v[76:79]
    ds_read_b128 a[216:219], v230 offset:0
    v_mfma_f32_16x16x32_bf16 v[76:79], a[236:239], v[164:167], v[76:79]
    ds_read_b128 a[220:223], v231 offset:0
    v_mfma_f32_16x16x32_bf16 v[80:83], a[232:235], v[156:159], v[80:83]
    ds_read_b64_tr_b16 a[232:233], v236 offset:49152
    v_mfma_f32_16x16x32_bf16 v[80:83], a[236:239], v[168:171], v[80:83]
    s_add_u32 s46, s40, 114688
    s_add_u32 m0, s41, 49152
    ds_read_b64_tr_b16 a[234:235], v236 offset:53248
    v_mfma_f32_16x16x32_bf16 v[84:87], a[240:243], v[148:151], v[84:87]
    buffer_load_dwordx4 v247, s[20:23], s46 offen offset:0 nt lds
    v_mfma_f32_16x16x32_bf16 v[84:87], a[244:247], v[160:163], v[84:87]
    ds_read_b64_tr_b16 a[236:237], v236 offset:57344
    v_mfma_f32_16x16x32_bf16 v[88:91], a[240:243], v[152:155], v[88:91]
    ds_read_b64_tr_b16 a[238:239], v236 offset:61440
    v_mfma_f32_16x16x32_bf16 v[88:91], a[244:247], v[164:167], v[88:91]
    v_exp_f32 v132, v132
    v_mfma_f32_16x16x32_bf16 v[92:95], a[240:243], v[156:159], v[92:95]
    buffer_load_dwordx4 v248, s[20:23], s46 offen offset:1024 nt lds
    v_mfma_f32_16x16x32_bf16 v[92:95], a[244:247], v[168:171], v[92:95]
    v_exp_f32 v133, v133
    v_mfma_f32_16x16x32_bf16 v[116:119], a[248:251], v[196:199], v[116:119]
    v_exp_f32 v134, v134
    v_mfma_f32_16x16x32_bf16 v[116:119], a[248:251], v[200:203], v[116:119]
    s_waitcnt lgkmcnt(7)
    v_exp_f32 v135, v135
    v_mfma_f32_16x16x32_bf16 v[120:123], a[208:211], a[144:147], 0
    s_waitcnt lgkmcnt(6)
    v_cvt_pk_bf16_f32 v186, v132, v133
    v_cvt_pk_bf16_f32 v187, v134, v135
    v_mfma_f32_16x16x32_bf16 v[120:123], a[212:215], a[156:159], v[120:123]
    s_waitcnt lgkmcnt(5)
    buffer_load_dwordx4 v247, s[20:23], s46 offen offset:2048 nt lds
    ds_read_b128 v[196:199], v244 offset:18432
    v_mfma_f32_16x16x32_bf16 v[120:123], a[216:219], a[168:171], v[120:123]
    s_waitcnt lgkmcnt(5)
    v_exp_f32 v136, v136
    v_mfma_f32_16x16x32_bf16 v[120:123], a[220:223], a[180:183], v[120:123]
    v_exp_f32 v137, v137
    v_mfma_f32_16x16x32_bf16 v[124:127], a[208:211], a[148:151], 0
    v_exp_f32 v138, v138
    v_mfma_f32_16x16x32_bf16 v[124:127], a[212:215], a[160:163], v[124:127]
    v_exp_f32 v139, v139
    v_mfma_f32_16x16x32_bf16 v[124:127], a[216:219], a[172:175], v[124:127]
    buffer_load_dwordx4 v248, s[20:23], s46 offen offset:3072 nt lds
    v_cvt_pk_bf16_f32 v190, v136, v137
    v_mfma_f32_16x16x32_bf16 v[124:127], a[220:223], a[184:187], v[124:127]
    ds_read_b128 v[200:203], v244 offset:19456
    v_cvt_pk_bf16_f32 v191, v138, v139
    v_mfma_f32_16x16x32_bf16 v[128:131], a[208:211], a[152:155], 0
    ds_read_b64_tr_b16 a[240:241], v237 offset:49152
    v_mfma_f32_16x16x32_bf16 v[128:131], a[212:215], a[164:167], v[128:131]
    ds_read_b64_tr_b16 a[242:243], v237 offset:53248
    v_mfma_f32_16x16x32_bf16 v[128:131], a[216:219], a[176:179], v[128:131]
    v_exp_f32 v140, v140
    v_mfma_f32_16x16x32_bf16 v[128:131], a[220:223], a[188:191], v[128:131]
    v_exp_f32 v141, v141
    v_mfma_f32_16x16x32_bf16 v[104:107], a[248:251], v[172:175], v[104:107]
    v_exp_f32 v142, v142
    v_mfma_f32_16x16x32_bf16 v[104:107], a[248:251], v[184:187], v[104:107]
    s_waitcnt lgkmcnt(6)
    v_exp_f32 v143, v143
    v_mfma_f32_16x16x32_bf16 v[0:3], a[232:235], v[172:175], v[0:3]
    s_waitcnt lgkmcnt(4)
    ds_read_b64_tr_b16 a[244:245], v237 offset:57344
    ds_read_b64_tr_b16 a[246:247], v237 offset:61440
    v_mfma_f32_16x16x32_bf16 v[0:3], a[236:239], v[184:187], v[0:3]
    v_cvt_pk_bf16_f32 v194, v140, v141
    v_cvt_pk_bf16_f32 v195, v142, v143
    v_mfma_f32_16x16x32_bf16 v[4:7], a[232:235], v[176:179], v[4:7]
    ds_read_b128 a[208:211], v228 offset:4096
    v_mfma_f32_16x16x32_bf16 v[4:7], a[236:239], v[188:191], v[4:7]
    ds_read_b128 a[212:215], v229 offset:4096
    v_mfma_f32_16x16x32_bf16 v[8:11], a[232:235], v[180:183], v[8:11]
    ds_read_b128 a[216:219], v230 offset:4096
    v_mfma_f32_16x16x32_bf16 v[8:11], a[236:239], v[192:195], v[8:11]
    s_waitcnt lgkmcnt(8)
    ds_read_b128 a[220:223], v231 offset:4096
    ds_read_b128 a[224:227], v232 offset:0
    v_mfma_f32_16x16x32_bf16 v[96:99], a[232:235], v[196:199], v[96:99]
    s_waitcnt lgkmcnt(9)
    ds_read_b64_tr_b16 a[232:233], v238 offset:49152
    ds_read_b64_tr_b16 a[234:235], v238 offset:53248
    v_mfma_f32_16x16x32_bf16 v[96:99], a[236:239], v[200:203], v[96:99]
    s_waitcnt lgkmcnt(9)
    ds_read_b64_tr_b16 a[236:237], v238 offset:57344
    ds_read_b64_tr_b16 a[238:239], v238 offset:61440
    v_mfma_f32_16x16x32_bf16 v[12:15], a[240:243], v[172:175], v[12:15]
    s_waitcnt lgkmcnt(9)
    ds_read_b128 a[228:231], v233 offset:0
    v_mfma_f32_16x16x32_bf16 v[12:15], a[244:247], v[184:187], v[12:15]
    v_exp_f32 v120, v120
    v_mfma_f32_16x16x32_bf16 v[16:19], a[240:243], v[176:179], v[16:19]
    v_exp_f32 v121, v121
    v_mfma_f32_16x16x32_bf16 v[16:19], a[244:247], v[188:191], v[16:19]
    s_add_u32 s46, s40, 98304
    s_add_u32 m0, s41, 98304
    v_exp_f32 v122, v122
    v_mfma_f32_16x16x32_bf16 v[20:23], a[240:243], v[180:183], v[20:23]
    s_lshl_b32 s95, s38, 3
    buffer_load_dwordx4 v247, s[24:27], s46 offen offset:0 nt lds
    v_cvt_pk_bf16_f32 v148, v120, v121
    v_mfma_f32_16x16x32_bf16 v[20:23], a[244:247], v[192:195], v[20:23]
    v_exp_f32 v123, v123
    v_mfma_f32_16x16x32_bf16 v[100:103], a[240:243], v[196:199], v[100:103]
    ds_read_b64_tr_b16 a[240:241], v239 offset:49152
    v_cvt_pk_bf16_f32 v149, v122, v123
    v_mfma_f32_16x16x32_bf16 v[100:103], a[244:247], v[200:203], v[100:103]
    s_waitcnt lgkmcnt(10)
    ds_read_b64_tr_b16 a[242:243], v239 offset:53248
    ds_read_b64_tr_b16 a[244:245], v239 offset:57344
    v_mfma_f32_16x16x32_bf16 v[132:135], a[208:211], a[144:147], 0
    s_waitcnt lgkmcnt(11)
    buffer_load_dwordx4 v248, s[24:27], s46 offen offset:1024 nt lds
    ds_read_b64_tr_b16 a[246:247], v239 offset:61440
    v_mfma_f32_16x16x32_bf16 v[132:135], a[212:215], a[156:159], v[132:135]
    s_waitcnt lgkmcnt(11)
    v_exp_f32 v124, v124
    v_mfma_f32_16x16x32_bf16 v[132:135], a[216:219], a[168:171], v[132:135]
    s_waitcnt lgkmcnt(10)
    v_exp_f32 v125, v125
    v_mfma_f32_16x16x32_bf16 v[132:135], a[220:223], a[180:183], v[132:135]
    v_exp_f32 v126, v126
    v_mfma_f32_16x16x32_bf16 v[136:139], a[208:211], a[148:151], 0
    v_exp_f32 v127, v127
    v_mfma_f32_16x16x32_bf16 v[136:139], a[212:215], a[160:163], v[136:139]
    buffer_load_dwordx4 v247, s[24:27], s46 offen offset:2048 nt lds
    v_cvt_pk_bf16_f32 v152, v124, v125
    v_mfma_f32_16x16x32_bf16 v[136:139], a[216:219], a[172:175], v[136:139]
    v_cvt_pk_bf16_f32 v153, v126, v127
    v_mov_b32 v210, s95
    v_mfma_f32_16x16x32_bf16 v[136:139], a[220:223], a[184:187], v[136:139]
    v_exp_f32 v128, v128
    v_mfma_f32_16x16x32_bf16 v[140:143], a[208:211], a[152:155], 0
    ds_read_b128 a[208:211], v228 offset:8192
    v_mfma_f32_16x16x32_bf16 v[140:143], a[212:215], a[164:167], v[140:143]
    ds_read_b128 a[212:215], v229 offset:8192
    v_mfma_f32_16x16x32_bf16 v[140:143], a[216:219], a[176:179], v[140:143]
    buffer_load_dwordx4 v248, s[24:27], s46 offen offset:3072 nt lds
    v_mfma_f32_16x16x32_bf16 v[140:143], a[220:223], a[188:191], v[140:143]
    ds_read_b128 a[216:219], v230 offset:8192
    v_mfma_f32_16x16x32_bf16 v[108:111], a[248:251], v[176:179], v[108:111]
    ds_read_b128 a[220:223], v231 offset:8192
    v_mfma_f32_16x16x32_bf16 v[108:111], a[248:251], v[188:191], v[108:111]
    s_waitcnt lgkmcnt(11)
    v_exp_f32 v129, v129
    v_mfma_f32_16x16x32_bf16 v[24:27], a[232:235], v[172:175], v[24:27]
    s_waitcnt lgkmcnt(9)
    v_exp_f32 v130, v130
    v_mfma_f32_16x16x32_bf16 v[24:27], a[236:239], v[184:187], v[24:27]
    v_exp_f32 v131, v131
    v_mfma_f32_16x16x32_bf16 v[28:31], a[232:235], v[176:179], v[28:31]
    v_cvt_pk_bf16_f32 v156, v128, v129
    v_cvt_pk_bf16_f32 v157, v130, v131
    v_mfma_f32_16x16x32_bf16 v[28:31], a[236:239], v[188:191], v[28:31]
    v_exp_f32 v132, v132
    v_mfma_f32_16x16x32_bf16 v[32:35], a[232:235], v[180:183], v[32:35]
    ds_read_b64_tr_b16 a[232:233], v240 offset:49152
    v_mfma_f32_16x16x32_bf16 v[32:35], a[236:239], v[192:195], v[32:35]
    s_waitcnt lgkmcnt(7)
    ds_read_b64_tr_b16 a[234:235], v240 offset:53248
    ds_read_b64_tr_b16 a[236:237], v240 offset:57344
    v_mfma_f32_16x16x32_bf16 v[36:39], a[240:243], v[172:175], v[36:39]
    s_waitcnt lgkmcnt(7)
    ds_read_b64_tr_b16 a[238:239], v240 offset:61440
    v_mfma_f32_16x16x32_bf16 v[36:39], a[244:247], v[184:187], v[36:39]
    v_exp_f32 v133, v133
    v_mfma_f32_16x16x32_bf16 v[40:43], a[240:243], v[176:179], v[40:43]
    v_exp_f32 v134, v134
    v_mfma_f32_16x16x32_bf16 v[40:43], a[244:247], v[188:191], v[40:43]
    v_exp_f32 v135, v135
    v_mfma_f32_16x16x32_bf16 v[44:47], a[240:243], v[180:183], v[44:47]
    ds_read_b64_tr_b16 a[240:241], v241 offset:49152
    v_cvt_pk_bf16_f32 v150, v132, v133
    v_mfma_f32_16x16x32_bf16 v[44:47], a[244:247], v[192:195], v[44:47]
    ds_read_b64_tr_b16 a[242:243], v241 offset:53248
    v_cvt_pk_bf16_f32 v151, v134, v135
    v_mfma_f32_16x16x32_bf16 v[144:147], a[224:227], a[192:195], 0
    ds_read_b64_tr_b16 a[244:245], v241 offset:57344
    v_mfma_f32_16x16x32_bf16 v[144:147], a[228:231], a[196:199], v[144:147]
    s_waitcnt lgkmcnt(10)
    ds_read_b64_tr_b16 a[246:247], v241 offset:61440
    ds_read_b128 a[224:227], v234 offset:0
    v_mfma_f32_16x16x32_bf16 v[120:123], a[208:211], a[144:147], 0
    s_waitcnt lgkmcnt(11)
    ds_read_b128 a[228:231], v235 offset:0
    v_mfma_f32_16x16x32_bf16 v[120:123], a[212:215], a[156:159], v[120:123]
    s_waitcnt lgkmcnt(11)
    v_exp_f32 v136, v136
    v_mfma_f32_16x16x32_bf16 v[120:123], a[216:219], a[168:171], v[120:123]
    s_waitcnt lgkmcnt(10)
    v_exp_f32 v137, v137
    v_mfma_f32_16x16x32_bf16 v[120:123], a[220:223], a[180:183], v[120:123]
    v_exp_f32 v138, v138
    v_mfma_f32_16x16x32_bf16 v[124:127], a[208:211], a[148:151], 0
    v_exp_f32 v139, v139
    v_mfma_f32_16x16x32_bf16 v[124:127], a[212:215], a[160:163], v[124:127]
    v_cvt_pk_bf16_f32 v154, v136, v137
    v_cvt_pk_bf16_f32 v155, v138, v139
    v_mfma_f32_16x16x32_bf16 v[124:127], a[216:219], a[172:175], v[124:127]
    v_exp_f32 v140, v140
    v_mfma_f32_16x16x32_bf16 v[124:127], a[220:223], a[184:187], v[124:127]
    v_exp_f32 v141, v141
    v_mfma_f32_16x16x32_bf16 v[128:131], a[208:211], a[152:155], 0
    ds_read_b128 a[208:211], v228 offset:12288
    v_cvt_pk_bf16_f32 v158, v140, v141
    v_mfma_f32_16x16x32_bf16 v[128:131], a[212:215], a[164:167], v[128:131]
    ds_read_b128 a[212:215], v229 offset:12288
    v_mfma_f32_16x16x32_bf16 v[128:131], a[216:219], a[176:179], v[128:131]
    ds_read_b128 a[216:219], v230 offset:12288
    v_mfma_f32_16x16x32_bf16 v[128:131], a[220:223], a[188:191], v[128:131]
    ds_read_b128 a[220:223], v231 offset:12288
    v_mfma_f32_16x16x32_bf16 v[112:115], a[248:251], v[180:183], v[112:115]
    v_exp_f32 v142, v142
    v_mfma_f32_16x16x32_bf16 v[112:115], a[248:251], v[192:195], v[112:115]
    s_waitcnt lgkmcnt(12)
    v_exp_f32 v143, v143
    v_mfma_f32_16x16x32_bf16 v[48:51], a[232:235], v[172:175], v[48:51]
    s_waitcnt lgkmcnt(10)
    v_cvt_pk_bf16_f32 v159, v142, v143
    v_mfma_f32_16x16x32_bf16 v[48:51], a[236:239], v[184:187], v[48:51]
    v_exp_f32 v120, v120
    v_mfma_f32_16x16x32_bf16 v[52:55], a[232:235], v[176:179], v[52:55]
    v_exp_f32 v121, v121
    v_mfma_f32_16x16x32_bf16 v[52:55], a[236:239], v[188:191], v[52:55]
    v_exp_f32 v122, v122
    v_mfma_f32_16x16x32_bf16 v[56:59], a[232:235], v[180:183], v[56:59]
    ds_read_b64_tr_b16 a[232:233], v242 offset:49152
    v_cvt_pk_bf16_f32 v160, v120, v121
    v_mfma_f32_16x16x32_bf16 v[56:59], a[236:239], v[192:195], v[56:59]
    s_waitcnt lgkmcnt(9)
    ds_read_b64_tr_b16 a[234:235], v242 offset:53248
    ds_read_b64_tr_b16 a[236:237], v242 offset:57344
    v_mfma_f32_16x16x32_bf16 v[60:63], a[240:243], v[172:175], v[60:63]
    s_waitcnt lgkmcnt(9)
    ds_read_b64_tr_b16 a[238:239], v242 offset:61440
    buffer_load_dwordx2 v[208:209], v210, s[4:7], s89 offen sc1
    v_mfma_f32_16x16x32_bf16 v[60:63], a[244:247], v[184:187], v[60:63]
    v_exp_f32 v123, v123
    v_mfma_f32_16x16x32_bf16 v[64:67], a[240:243], v[176:179], v[64:67]
    v_cvt_pk_bf16_f32 v161, v122, v123
    v_mfma_f32_16x16x32_bf16 v[64:67], a[244:247], v[188:191], v[64:67]
    v_exp_f32 v124, v124
    v_mfma_f32_16x16x32_bf16 v[68:71], a[240:243], v[180:183], v[68:71]
    ds_read_b64_tr_b16 a[240:241], v243 offset:49152
    v_mfma_f32_16x16x32_bf16 v[68:71], a[244:247], v[192:195], v[68:71]
    s_waitcnt lgkmcnt(10)
    ds_read_b64_tr_b16 a[242:243], v243 offset:53248
    ds_read_b64_tr_b16 a[244:245], v243 offset:57344
    v_mfma_f32_16x16x32_bf16 v[144:147], a[224:227], a[200:203], v[144:147]
    s_waitcnt lgkmcnt(11)
    ds_read_b64_tr_b16 a[246:247], v243 offset:61440
    v_mfma_f32_16x16x32_bf16 v[144:147], a[228:231], a[204:207], v[144:147]
    s_waitcnt lgkmcnt(11)
    v_exp_f32 v125, v125
    v_mfma_f32_16x16x32_bf16 v[132:135], a[208:211], a[144:147], 0
    s_waitcnt lgkmcnt(10)
    v_exp_f32 v126, v126
    v_mfma_f32_16x16x32_bf16 v[132:135], a[212:215], a[156:159], v[132:135]
    s_waitcnt lgkmcnt(9)
    v_exp_f32 v127, v127
    v_mfma_f32_16x16x32_bf16 v[132:135], a[216:219], a[168:171], v[132:135]
    s_waitcnt lgkmcnt(8)
    v_exp_f32 v144, v144
    v_mfma_f32_16x16x32_bf16 v[132:135], a[220:223], a[180:183], v[132:135]
    v_exp_f32 v145, v145
    v_mfma_f32_16x16x32_bf16 v[136:139], a[208:211], a[148:151], 0
    v_exp_f32 v146, v146
    v_mfma_f32_16x16x32_bf16 v[136:139], a[212:215], a[160:163], v[136:139]
    v_exp_f32 v147, v147
    v_mfma_f32_16x16x32_bf16 v[136:139], a[216:219], a[172:175], v[136:139]
    v_cvt_pk_bf16_f32 v204, v144, v145
    v_cvt_pk_bf16_f32 v205, v146, v147
    v_mfma_f32_16x16x32_bf16 v[136:139], a[220:223], a[184:187], v[136:139]
    ds_write_b64 v246, v[204:205] offset:0
    v_mfma_f32_16x16x32_bf16 v[140:143], a[208:211], a[152:155], 0
    v_cvt_pk_bf16_f32 v164, v124, v125
    v_cvt_pk_bf16_f32 v165, v126, v127
    v_mfma_f32_16x16x32_bf16 v[140:143], a[212:215], a[164:167], v[140:143]
    v_exp_f32 v128, v128
    v_mfma_f32_16x16x32_bf16 v[140:143], a[216:219], a[176:179], v[140:143]
    v_exp_f32 v129, v129
    v_mfma_f32_16x16x32_bf16 v[140:143], a[220:223], a[188:191], v[140:143]
    s_waitcnt vmcnt(17) lgkmcnt(0)
    v_exp_f32 v130, v130
    v_exp_f32 v131, v131
    s_barrier
    v_mfma_f32_16x16x32_bf16 v[72:75], a[232:235], v[172:175], v[72:75]
    ds_read_b128 a[208:211], v228 offset:16384
    v_cvt_pk_bf16_f32 v168, v128, v129
    v_mfma_f32_16x16x32_bf16 v[72:75], a[236:239], v[184:187], v[72:75]
    ds_read_b128 a[212:215], v229 offset:16384
    v_cvt_pk_bf16_f32 v169, v130, v131
    v_mfma_f32_16x16x32_bf16 v[76:79], a[232:235], v[176:179], v[76:79]
    ds_read_b128 a[216:219], v230 offset:16384
    v_mfma_f32_16x16x32_bf16 v[76:79], a[236:239], v[188:191], v[76:79]
    ds_read_b128 a[220:223], v231 offset:16384
    v_mfma_f32_16x16x32_bf16 v[80:83], a[232:235], v[180:183], v[80:83]
    ds_read_b64_tr_b16 a[232:233], v236 offset:0
    v_mfma_f32_16x16x32_bf16 v[80:83], a[236:239], v[192:195], v[80:83]
    s_add_u32 m0, s41, 0
    ds_read_b64_tr_b16 a[234:235], v236 offset:4096
    buffer_load_dwordx4 v249, s[32:35], s42 offen offset:0 lds
    v_mfma_f32_16x16x32_bf16 v[84:87], a[240:243], v[172:175], v[84:87]
    ds_read_b64_tr_b16 a[236:237], v236 offset:8192
    v_mfma_f32_16x16x32_bf16 v[84:87], a[244:247], v[184:187], v[84:87]
    ds_read_b64_tr_b16 a[238:239], v236 offset:12288
    v_mfma_f32_16x16x32_bf16 v[88:91], a[240:243], v[176:179], v[88:91]
    v_exp_f32 v132, v132
    v_mfma_f32_16x16x32_bf16 v[88:91], a[244:247], v[188:191], v[88:91]
    v_exp_f32 v133, v133
    v_mfma_f32_16x16x32_bf16 v[92:95], a[240:243], v[180:183], v[92:95]
    s_add_u32 s47, s42, s45
    buffer_load_dwordx4 v250, s[32:35], s47 offen offset:1024 lds
    v_cvt_pk_bf16_f32 v162, v132, v133
    v_mfma_f32_16x16x32_bf16 v[92:95], a[244:247], v[192:195], v[92:95]
    v_exp_f32 v134, v134
    v_mfma_f32_16x16x32_bf16 v[116:119], a[248:251], v[196:199], v[116:119]
    v_exp_f32 v135, v135
    v_mfma_f32_16x16x32_bf16 v[116:119], a[248:251], v[200:203], v[116:119]
    s_waitcnt lgkmcnt(7)
    v_cvt_pk_bf16_f32 v163, v134, v135
    v_mfma_f32_16x16x32_bf16 v[120:123], a[208:211], a[144:147], 0
    s_waitcnt lgkmcnt(6)
    ds_read_b128 v[196:199], v244 offset:16384
    ds_read_b128 v[200:203], v244 offset:17408
    v_mfma_f32_16x16x32_bf16 v[120:123], a[212:215], a[156:159], v[120:123]
    s_waitcnt lgkmcnt(7)
    s_add_u32 s48, s47, s45
    v_exp_f32 v136, v136
    v_mfma_f32_16x16x32_bf16 v[120:123], a[216:219], a[168:171], v[120:123]
    s_waitcnt lgkmcnt(6)
    buffer_load_dwordx4 v249, s[32:35], s48 offen offset:2048 lds
    ds_read_b64_tr_b16 a[240:241], v237 offset:0
    v_mfma_f32_16x16x32_bf16 v[120:123], a[220:223], a[180:183], v[120:123]
    v_exp_f32 v137, v137
    v_mfma_f32_16x16x32_bf16 v[124:127], a[208:211], a[148:151], 0
    v_exp_f32 v138, v138
    v_mfma_f32_16x16x32_bf16 v[124:127], a[212:215], a[160:163], v[124:127]
    v_exp_f32 v139, v139
    v_mfma_f32_16x16x32_bf16 v[124:127], a[216:219], a[172:175], v[124:127]
    s_add_u32 s49, s48, s45
    buffer_load_dwordx4 v250, s[32:35], s49 offen offset:3072 lds
    v_cvt_pk_bf16_f32 v166, v136, v137
    v_mfma_f32_16x16x32_bf16 v[124:127], a[220:223], a[184:187], v[124:127]
    s_add_u32 s42, s42, s44
    v_cvt_pk_bf16_f32 v167, v138, v139
    v_mfma_f32_16x16x32_bf16 v[128:131], a[208:211], a[152:155], 0
    ds_read_b64_tr_b16 a[242:243], v237 offset:4096
    v_mfma_f32_16x16x32_bf16 v[128:131], a[212:215], a[164:167], v[128:131]
    v_exp_f32 v140, v140
    v_mfma_f32_16x16x32_bf16 v[128:131], a[216:219], a[176:179], v[128:131]
    v_exp_f32 v141, v141
    v_mfma_f32_16x16x32_bf16 v[128:131], a[220:223], a[188:191], v[128:131]
    v_exp_f32 v142, v142
    v_mfma_f32_16x16x32_bf16 v[104:107], a[248:251], v[148:151], v[104:107]
    v_exp_f32 v143, v143
    v_mfma_f32_16x16x32_bf16 v[104:107], a[248:251], v[160:163], v[104:107]
    s_waitcnt lgkmcnt(6)
    ds_read_b64_tr_b16 a[244:245], v237 offset:8192
    ds_read_b64_tr_b16 a[246:247], v237 offset:12288
    v_mfma_f32_16x16x32_bf16 v[0:3], a[232:235], v[148:151], v[0:3]
    s_waitcnt lgkmcnt(6)
    v_cvt_pk_bf16_f32 v170, v140, v141
    v_cvt_pk_bf16_f32 v171, v142, v143
    v_mfma_f32_16x16x32_bf16 v[0:3], a[236:239], v[160:163], v[0:3]
    ds_read_b128 a[208:211], v228 offset:20480
    v_mfma_f32_16x16x32_bf16 v[4:7], a[232:235], v[152:155], v[4:7]
    ds_read_b128 a[212:215], v229 offset:20480
    v_mfma_f32_16x16x32_bf16 v[4:7], a[236:239], v[164:167], v[4:7]
    ds_read_b128 a[216:219], v230 offset:20480
    v_mfma_f32_16x16x32_bf16 v[8:11], a[232:235], v[156:159], v[8:11]
    ds_read_b128 a[220:223], v231 offset:20480
    v_mfma_f32_16x16x32_bf16 v[8:11], a[236:239], v[168:171], v[8:11]
    s_waitcnt lgkmcnt(9)
    ds_read_b128 a[224:227], v232 offset:16384
    ds_read_b128 a[228:231], v233 offset:16384
    v_mfma_f32_16x16x32_bf16 v[96:99], a[232:235], v[196:199], v[96:99]
    s_waitcnt lgkmcnt(10)
    ds_read_b64_tr_b16 a[232:233], v238 offset:0
    ds_read_b64_tr_b16 a[234:235], v238 offset:4096
    v_mfma_f32_16x16x32_bf16 v[96:99], a[236:239], v[200:203], v[96:99]
    s_waitcnt lgkmcnt(10)
    ds_read_b64_tr_b16 a[236:237], v238 offset:8192
    ds_read_b64_tr_b16 a[238:239], v238 offset:12288
    v_mfma_f32_16x16x32_bf16 v[12:15], a[240:243], v[148:151], v[12:15]
    s_waitcnt lgkmcnt(10)
    v_exp_f32 v120, v120
    v_mfma_f32_16x16x32_bf16 v[12:15], a[244:247], v[160:163], v[12:15]
    v_exp_f32 v121, v121
    v_mfma_f32_16x16x32_bf16 v[16:19], a[240:243], v[152:155], v[16:19]
    v_exp_f32 v122, v122
    v_mfma_f32_16x16x32_bf16 v[16:19], a[244:247], v[164:167], v[16:19]
    s_add_u32 s46, s40, 114688
    s_add_u32 m0, s41, 114688
    v_exp_f32 v123, v123
    v_mfma_f32_16x16x32_bf16 v[20:23], a[240:243], v[156:159], v[20:23]
    buffer_load_dwordx4 v247, s[24:27], s46 offen offset:0 nt lds
    v_cvt_pk_bf16_f32 v172, v120, v121
    v_mfma_f32_16x16x32_bf16 v[20:23], a[244:247], v[168:171], v[20:23]
    v_cvt_pk_bf16_f32 v173, v122, v123
    s_waitcnt vmcnt(5)
    v_and_b32 v208, v208, v209
    v_mfma_f32_16x16x32_bf16 v[100:103], a[240:243], v[196:199], v[100:103]
    ds_read_b64_tr_b16 a[240:241], v239 offset:0
    v_cmp_ne_u32 vcc, 0x01010101, v208
    v_mfma_f32_16x16x32_bf16 v[100:103], a[244:247], v[200:203], v[100:103]
    s_waitcnt lgkmcnt(10)
    ds_read_b64_tr_b16 a[242:243], v239 offset:4096
    ds_read_b64_tr_b16 a[244:245], v239 offset:8192
    v_mfma_f32_16x16x32_bf16 v[132:135], a[208:211], a[144:147], 0
    s_waitcnt lgkmcnt(11)
    buffer_load_dwordx4 v248, s[24:27], s46 offen offset:1024 nt lds
    ds_read_b64_tr_b16 a[246:247], v239 offset:12288
    v_mfma_f32_16x16x32_bf16 v[132:135], a[212:215], a[156:159], v[132:135]
    s_waitcnt lgkmcnt(11)
    v_exp_f32 v124, v124
    v_mfma_f32_16x16x32_bf16 v[132:135], a[216:219], a[168:171], v[132:135]
    s_waitcnt lgkmcnt(10)
    v_exp_f32 v125, v125
    v_mfma_f32_16x16x32_bf16 v[132:135], a[220:223], a[180:183], v[132:135]
    v_exp_f32 v126, v126
    v_mfma_f32_16x16x32_bf16 v[136:139], a[208:211], a[148:151], 0
    v_exp_f32 v127, v127
    v_mfma_f32_16x16x32_bf16 v[136:139], a[212:215], a[160:163], v[136:139]
    buffer_load_dwordx4 v247, s[24:27], s46 offen offset:2048 nt lds
    v_cvt_pk_bf16_f32 v176, v124, v125
    v_mfma_f32_16x16x32_bf16 v[136:139], a[216:219], a[172:175], v[136:139]
    v_cvt_pk_bf16_f32 v177, v126, v127
    v_mfma_f32_16x16x32_bf16 v[136:139], a[220:223], a[184:187], v[136:139]
    v_exp_f32 v128, v128
    v_mfma_f32_16x16x32_bf16 v[140:143], a[208:211], a[152:155], 0
    ds_read_b128 a[208:211], v228 offset:24576
    v_mfma_f32_16x16x32_bf16 v[140:143], a[212:215], a[164:167], v[140:143]
    ds_read_b128 a[212:215], v229 offset:24576
    v_mfma_f32_16x16x32_bf16 v[140:143], a[216:219], a[176:179], v[140:143]
    buffer_load_dwordx4 v248, s[24:27], s46 offen offset:3072 nt lds
    v_mfma_f32_16x16x32_bf16 v[140:143], a[220:223], a[188:191], v[140:143]
    ds_read_b128 a[216:219], v230 offset:24576
    v_mfma_f32_16x16x32_bf16 v[108:111], a[248:251], v[152:155], v[108:111]
    ds_read_b128 a[220:223], v231 offset:24576
    v_mfma_f32_16x16x32_bf16 v[108:111], a[248:251], v[164:167], v[108:111]
    s_waitcnt lgkmcnt(10)
    v_exp_f32 v129, v129
    v_mfma_f32_16x16x32_bf16 v[24:27], a[232:235], v[148:151], v[24:27]
    s_waitcnt lgkmcnt(8)
    v_exp_f32 v130, v130
    v_mfma_f32_16x16x32_bf16 v[24:27], a[236:239], v[160:163], v[24:27]
    v_exp_f32 v131, v131
    v_mfma_f32_16x16x32_bf16 v[28:31], a[232:235], v[152:155], v[28:31]
    v_cvt_pk_bf16_f32 v180, v128, v129
    v_cvt_pk_bf16_f32 v181, v130, v131
    v_mfma_f32_16x16x32_bf16 v[28:31], a[236:239], v[164:167], v[28:31]
    v_exp_f32 v132, v132
    v_mfma_f32_16x16x32_bf16 v[32:35], a[232:235], v[156:159], v[32:35]
    ds_read_b64_tr_b16 a[232:233], v240 offset:0
    v_mfma_f32_16x16x32_bf16 v[32:35], a[236:239], v[168:171], v[32:35]
    s_waitcnt lgkmcnt(7)
    ds_read_b64_tr_b16 a[234:235], v240 offset:4096
    ds_read_b64_tr_b16 a[236:237], v240 offset:8192
    v_mfma_f32_16x16x32_bf16 v[36:39], a[240:243], v[148:151], v[36:39]
    s_waitcnt lgkmcnt(7)
    ds_read_b64_tr_b16 a[238:239], v240 offset:12288
    v_mfma_f32_16x16x32_bf16 v[36:39], a[244:247], v[160:163], v[36:39]
    v_exp_f32 v133, v133
    v_mfma_f32_16x16x32_bf16 v[40:43], a[240:243], v[152:155], v[40:43]
    v_exp_f32 v134, v134
    v_mfma_f32_16x16x32_bf16 v[40:43], a[244:247], v[164:167], v[40:43]
    v_exp_f32 v135, v135
    v_mfma_f32_16x16x32_bf16 v[44:47], a[240:243], v[156:159], v[44:47]
    ds_read_b64_tr_b16 a[240:241], v241 offset:0
    v_cvt_pk_bf16_f32 v174, v132, v133
    v_mfma_f32_16x16x32_bf16 v[44:47], a[244:247], v[168:171], v[44:47]
    ds_read_b64_tr_b16 a[242:243], v241 offset:4096
    v_cvt_pk_bf16_f32 v175, v134, v135
    v_mfma_f32_16x16x32_bf16 v[144:147], a[224:227], a[192:195], 0
    ds_read_b64_tr_b16 a[244:245], v241 offset:8192
    v_mfma_f32_16x16x32_bf16 v[144:147], a[228:231], a[196:199], v[144:147]
    s_waitcnt lgkmcnt(10)
    ds_read_b64_tr_b16 a[246:247], v241 offset:12288
    ds_read_b128 a[224:227], v234 offset:16384
    v_mfma_f32_16x16x32_bf16 v[120:123], a[208:211], a[144:147], 0
    s_waitcnt lgkmcnt(11)
    ds_read_b128 a[228:231], v235 offset:16384
    v_mfma_f32_16x16x32_bf16 v[120:123], a[212:215], a[156:159], v[120:123]
    s_waitcnt lgkmcnt(11)
    v_exp_f32 v136, v136
    v_mfma_f32_16x16x32_bf16 v[120:123], a[216:219], a[168:171], v[120:123]
    s_waitcnt lgkmcnt(10)
    v_exp_f32 v137, v137
    v_mfma_f32_16x16x32_bf16 v[120:123], a[220:223], a[180:183], v[120:123]
    v_exp_f32 v138, v138
    v_mfma_f32_16x16x32_bf16 v[124:127], a[208:211], a[148:151], 0
    v_exp_f32 v139, v139
    v_mfma_f32_16x16x32_bf16 v[124:127], a[212:215], a[160:163], v[124:127]
    v_cvt_pk_bf16_f32 v178, v136, v137
    v_cvt_pk_bf16_f32 v179, v138, v139
    v_mfma_f32_16x16x32_bf16 v[124:127], a[216:219], a[172:175], v[124:127]
    v_exp_f32 v140, v140
    v_mfma_f32_16x16x32_bf16 v[124:127], a[220:223], a[184:187], v[124:127]
    v_exp_f32 v141, v141
    v_mfma_f32_16x16x32_bf16 v[128:131], a[208:211], a[152:155], 0
    ds_read_b128 a[208:211], v228 offset:28672
    v_cvt_pk_bf16_f32 v182, v140, v141
    v_mfma_f32_16x16x32_bf16 v[128:131], a[212:215], a[164:167], v[128:131]
    ds_read_b128 a[212:215], v229 offset:28672
    v_mfma_f32_16x16x32_bf16 v[128:131], a[216:219], a[176:179], v[128:131]
    ds_read_b128 a[216:219], v230 offset:28672
    v_mfma_f32_16x16x32_bf16 v[128:131], a[220:223], a[188:191], v[128:131]
    ds_read_b128 a[220:223], v231 offset:28672
    v_mfma_f32_16x16x32_bf16 v[112:115], a[248:251], v[156:159], v[112:115]
    v_exp_f32 v142, v142
    v_mfma_f32_16x16x32_bf16 v[112:115], a[248:251], v[168:171], v[112:115]
    s_waitcnt lgkmcnt(12)
    v_exp_f32 v143, v143
    v_mfma_f32_16x16x32_bf16 v[48:51], a[232:235], v[148:151], v[48:51]
    s_waitcnt lgkmcnt(10)
    v_cvt_pk_bf16_f32 v183, v142, v143
    v_mfma_f32_16x16x32_bf16 v[48:51], a[236:239], v[160:163], v[48:51]
    v_exp_f32 v120, v120
    v_mfma_f32_16x16x32_bf16 v[52:55], a[232:235], v[152:155], v[52:55]
    v_exp_f32 v121, v121
    v_mfma_f32_16x16x32_bf16 v[52:55], a[236:239], v[164:167], v[52:55]
    v_exp_f32 v122, v122
    v_mfma_f32_16x16x32_bf16 v[56:59], a[232:235], v[156:159], v[56:59]
    ds_read_b64_tr_b16 a[232:233], v242 offset:0
    v_cvt_pk_bf16_f32 v184, v120, v121
    v_mfma_f32_16x16x32_bf16 v[56:59], a[236:239], v[168:171], v[56:59]
    s_waitcnt lgkmcnt(9)
    ds_read_b64_tr_b16 a[234:235], v242 offset:4096
    ds_read_b64_tr_b16 a[236:237], v242 offset:8192
    v_mfma_f32_16x16x32_bf16 v[60:63], a[240:243], v[148:151], v[60:63]
    s_waitcnt lgkmcnt(9)
    ds_read_b64_tr_b16 a[238:239], v242 offset:12288
    v_mfma_f32_16x16x32_bf16 v[60:63], a[244:247], v[160:163], v[60:63]
    v_exp_f32 v123, v123
    v_mfma_f32_16x16x32_bf16 v[64:67], a[240:243], v[152:155], v[64:67]
    v_cvt_pk_bf16_f32 v185, v122, v123
    v_mfma_f32_16x16x32_bf16 v[64:67], a[244:247], v[164:167], v[64:67]
    v_exp_f32 v124, v124
    v_mfma_f32_16x16x32_bf16 v[68:71], a[240:243], v[156:159], v[68:71]
    ds_read_b64_tr_b16 a[240:241], v243 offset:0
    v_mfma_f32_16x16x32_bf16 v[68:71], a[244:247], v[168:171], v[68:71]
    s_waitcnt lgkmcnt(10)
    ds_read_b64_tr_b16 a[242:243], v243 offset:4096
    ds_read_b64_tr_b16 a[244:245], v243 offset:8192
    v_mfma_f32_16x16x32_bf16 v[144:147], a[224:227], a[200:203], v[144:147]
    s_waitcnt lgkmcnt(11)
    ds_read_b64_tr_b16 a[246:247], v243 offset:12288
    v_mfma_f32_16x16x32_bf16 v[144:147], a[228:231], a[204:207], v[144:147]
    s_waitcnt lgkmcnt(11)
    v_exp_f32 v125, v125
    v_mfma_f32_16x16x32_bf16 v[132:135], a[208:211], a[144:147], 0
    s_waitcnt lgkmcnt(10)
    v_exp_f32 v126, v126
    v_mfma_f32_16x16x32_bf16 v[132:135], a[212:215], a[156:159], v[132:135]
    s_waitcnt lgkmcnt(9)
    v_exp_f32 v127, v127
    v_mfma_f32_16x16x32_bf16 v[132:135], a[216:219], a[168:171], v[132:135]
    s_waitcnt lgkmcnt(8)
    v_exp_f32 v144, v144
    v_mfma_f32_16x16x32_bf16 v[132:135], a[220:223], a[180:183], v[132:135]
    v_exp_f32 v145, v145
    v_mfma_f32_16x16x32_bf16 v[136:139], a[208:211], a[148:151], 0
    v_exp_f32 v146, v146
    v_mfma_f32_16x16x32_bf16 v[136:139], a[212:215], a[160:163], v[136:139]
    v_exp_f32 v147, v147
    v_mfma_f32_16x16x32_bf16 v[136:139], a[216:219], a[172:175], v[136:139]
    v_cvt_pk_bf16_f32 v204, v144, v145
    v_cvt_pk_bf16_f32 v205, v146, v147
    v_mfma_f32_16x16x32_bf16 v[136:139], a[220:223], a[184:187], v[136:139]
    ds_write_b64 v246, v[204:205] offset:2048
    v_mfma_f32_16x16x32_bf16 v[140:143], a[208:211], a[152:155], 0
    v_cvt_pk_bf16_f32 v188, v124, v125
    v_cvt_pk_bf16_f32 v189, v126, v127
    v_mfma_f32_16x16x32_bf16 v[140:143], a[212:215], a[164:167], v[140:143]
    v_exp_f32 v128, v128
    v_mfma_f32_16x16x32_bf16 v[140:143], a[216:219], a[176:179], v[140:143]
    v_exp_f32 v129, v129
    v_mfma_f32_16x16x32_bf16 v[140:143], a[220:223], a[188:191], v[140:143]
    s_waitcnt lgkmcnt(0)
    v_exp_f32 v130, v130
    v_exp_f32 v131, v131
    s_barrier
    v_mfma_f32_16x16x32_bf16 v[72:75], a[232:235], v[148:151], v[72:75]
    ds_read_b128 a[208:211], v228 offset:32768
    v_cvt_pk_bf16_f32 v192, v128, v129
    v_mfma_f32_16x16x32_bf16 v[72:75], a[236:239], v[160:163], v[72:75]
    ds_read_b128 a[212:215], v229 offset:32768
    v_cvt_pk_bf16_f32 v193, v130, v131
    v_mfma_f32_16x16x32_bf16 v[76:79], a[232:235], v[152:155], v[76:79]
    ds_read_b128 a[216:219], v230 offset:32768
    v_mfma_f32_16x16x32_bf16 v[76:79], a[236:239], v[164:167], v[76:79]
    ds_read_b128 a[220:223], v231 offset:32768
    v_mfma_f32_16x16x32_bf16 v[80:83], a[232:235], v[156:159], v[80:83]
    ds_read_b64_tr_b16 a[232:233], v236 offset:16384
    v_mfma_f32_16x16x32_bf16 v[80:83], a[236:239], v[168:171], v[80:83]
    s_add_u32 m0, s41, 16384
    ds_read_b64_tr_b16 a[234:235], v236 offset:20480
    buffer_load_dwordx4 v249, s[32:35], s42 offen offset:0 lds
    v_mfma_f32_16x16x32_bf16 v[84:87], a[240:243], v[148:151], v[84:87]
    ds_read_b64_tr_b16 a[236:237], v236 offset:24576
    v_mfma_f32_16x16x32_bf16 v[84:87], a[244:247], v[160:163], v[84:87]
    ds_read_b64_tr_b16 a[238:239], v236 offset:28672
    v_mfma_f32_16x16x32_bf16 v[88:91], a[240:243], v[152:155], v[88:91]
    v_exp_f32 v132, v132
    v_mfma_f32_16x16x32_bf16 v[88:91], a[244:247], v[164:167], v[88:91]
    v_exp_f32 v133, v133
    v_mfma_f32_16x16x32_bf16 v[92:95], a[240:243], v[156:159], v[92:95]
    s_add_u32 s47, s42, s45
    buffer_load_dwordx4 v250, s[32:35], s47 offen offset:1024 lds
    v_cvt_pk_bf16_f32 v186, v132, v133
    v_mfma_f32_16x16x32_bf16 v[92:95], a[244:247], v[168:171], v[92:95]
    v_exp_f32 v134, v134
    v_mfma_f32_16x16x32_bf16 v[116:119], a[248:251], v[196:199], v[116:119]
    v_exp_f32 v135, v135
    v_mfma_f32_16x16x32_bf16 v[116:119], a[248:251], v[200:203], v[116:119]
    s_waitcnt lgkmcnt(7)
    v_cvt_pk_bf16_f32 v187, v134, v135
    v_mfma_f32_16x16x32_bf16 v[120:123], a[208:211], a[144:147], 0
    s_waitcnt lgkmcnt(6)
    ds_read_b128 v[196:199], v244 offset:18432
    ds_read_b128 v[200:203], v244 offset:19456
    v_mfma_f32_16x16x32_bf16 v[120:123], a[212:215], a[156:159], v[120:123]
    s_waitcnt lgkmcnt(7)
    s_add_u32 s48, s47, s45
    v_exp_f32 v136, v136
    v_mfma_f32_16x16x32_bf16 v[120:123], a[216:219], a[168:171], v[120:123]
    s_waitcnt lgkmcnt(6)
    buffer_load_dwordx4 v249, s[32:35], s48 offen offset:2048 lds
    ds_read_b64_tr_b16 a[240:241], v237 offset:16384
    v_mfma_f32_16x16x32_bf16 v[120:123], a[220:223], a[180:183], v[120:123]
    v_exp_f32 v137, v137
    v_mfma_f32_16x16x32_bf16 v[124:127], a[208:211], a[148:151], 0
    v_exp_f32 v138, v138
    v_mfma_f32_16x16x32_bf16 v[124:127], a[212:215], a[160:163], v[124:127]
    v_exp_f32 v139, v139
    v_mfma_f32_16x16x32_bf16 v[124:127], a[216:219], a[172:175], v[124:127]
    s_add_u32 s49, s48, s45
    buffer_load_dwordx4 v250, s[32:35], s49 offen offset:3072 lds
    v_cvt_pk_bf16_f32 v190, v136, v137
    v_mfma_f32_16x16x32_bf16 v[124:127], a[220:223], a[184:187], v[124:127]
    s_add_u32 s42, s42, s63
    v_cvt_pk_bf16_f32 v191, v138, v139
    v_mfma_f32_16x16x32_bf16 v[128:131], a[208:211], a[152:155], 0
    ds_read_b64_tr_b16 a[242:243], v237 offset:20480
    v_mfma_f32_16x16x32_bf16 v[128:131], a[212:215], a[164:167], v[128:131]
    v_exp_f32 v140, v140
    v_mfma_f32_16x16x32_bf16 v[128:131], a[216:219], a[176:179], v[128:131]
    v_exp_f32 v141, v141
    v_mfma_f32_16x16x32_bf16 v[128:131], a[220:223], a[188:191], v[128:131]
    v_exp_f32 v142, v142
    v_mfma_f32_16x16x32_bf16 v[104:107], a[248:251], v[172:175], v[104:107]
    v_exp_f32 v143, v143
    v_mfma_f32_16x16x32_bf16 v[104:107], a[248:251], v[184:187], v[104:107]
    s_waitcnt lgkmcnt(6)
    ds_read_b64_tr_b16 a[244:245], v237 offset:24576
    ds_read_b64_tr_b16 a[246:247], v237 offset:28672
    v_mfma_f32_16x16x32_bf16 v[0:3], a[232:235], v[172:175], v[0:3]
    s_waitcnt lgkmcnt(6)
    v_cvt_pk_bf16_f32 v194, v140, v141
    v_cvt_pk_bf16_f32 v195, v142, v143
    v_mfma_f32_16x16x32_bf16 v[0:3], a[236:239], v[184:187], v[0:3]
    ds_read_b128 a[208:211], v228 offset:36864
    v_mfma_f32_16x16x32_bf16 v[4:7], a[232:235], v[176:179], v[4:7]
    ds_read_b128 a[212:215], v229 offset:36864
    v_mfma_f32_16x16x32_bf16 v[4:7], a[236:239], v[188:191], v[4:7]
    ds_read_b128 a[216:219], v230 offset:36864
    v_mfma_f32_16x16x32_bf16 v[8:11], a[232:235], v[180:183], v[8:11]
    ds_read_b128 a[220:223], v231 offset:36864
    v_mfma_f32_16x16x32_bf16 v[8:11], a[236:239], v[192:195], v[8:11]
    s_waitcnt lgkmcnt(9)
    ds_read_b128 a[224:227], v232 offset:32768
    ds_read_b128 a[228:231], v233 offset:32768
    v_mfma_f32_16x16x32_bf16 v[96:99], a[232:235], v[196:199], v[96:99]
    s_waitcnt lgkmcnt(10)
    ds_read_b64_tr_b16 a[232:233], v238 offset:16384
    ds_read_b64_tr_b16 a[234:235], v238 offset:20480
    v_mfma_f32_16x16x32_bf16 v[96:99], a[236:239], v[200:203], v[96:99]
    s_waitcnt lgkmcnt(10)
    ds_read_b64_tr_b16 a[236:237], v238 offset:24576
    ds_read_b64_tr_b16 a[238:239], v238 offset:28672
    v_mfma_f32_16x16x32_bf16 v[12:15], a[240:243], v[172:175], v[12:15]
    s_waitcnt lgkmcnt(10)
    v_exp_f32 v120, v120
    v_mfma_f32_16x16x32_bf16 v[12:15], a[244:247], v[184:187], v[12:15]
    v_exp_f32 v121, v121
    v_mfma_f32_16x16x32_bf16 v[16:19], a[240:243], v[176:179], v[16:19]
    v_exp_f32 v122, v122
    v_mfma_f32_16x16x32_bf16 v[16:19], a[244:247], v[188:191], v[16:19]
    s_add_u32 m0, s41, 65536
    v_exp_f32 v123, v123
    v_mfma_f32_16x16x32_bf16 v[20:23], a[240:243], v[180:183], v[20:23]
    buffer_load_dwordx4 v249, s[32:35], s43 offen offset:0 lds
    v_cvt_pk_bf16_f32 v148, v120, v121
    v_mfma_f32_16x16x32_bf16 v[20:23], a[244:247], v[192:195], v[20:23]
    v_cvt_pk_bf16_f32 v149, v122, v123
    v_mfma_f32_16x16x32_bf16 v[100:103], a[240:243], v[196:199], v[100:103]
    ds_read_b64_tr_b16 a[240:241], v239 offset:16384
    v_mfma_f32_16x16x32_bf16 v[100:103], a[244:247], v[200:203], v[100:103]
    s_waitcnt lgkmcnt(10)
    ds_read_b64_tr_b16 a[242:243], v239 offset:20480
    ds_read_b64_tr_b16 a[244:245], v239 offset:24576
    v_mfma_f32_16x16x32_bf16 v[132:135], a[208:211], a[144:147], 0
    s_waitcnt lgkmcnt(11)
    s_add_u32 s47, s43, s45
    ds_read_b64_tr_b16 a[246:247], v239 offset:28672
    v_mfma_f32_16x16x32_bf16 v[132:135], a[212:215], a[156:159], v[132:135]
    s_waitcnt lgkmcnt(11)
    buffer_load_dwordx4 v250, s[32:35], s47 offen offset:1024 lds
    v_mfma_f32_16x16x32_bf16 v[132:135], a[216:219], a[168:171], v[132:135]
    s_waitcnt lgkmcnt(10)
    v_exp_f32 v124, v124
    v_mfma_f32_16x16x32_bf16 v[132:135], a[220:223], a[180:183], v[132:135]
    v_exp_f32 v125, v125
    v_mfma_f32_16x16x32_bf16 v[136:139], a[208:211], a[148:151], 0
    v_exp_f32 v126, v126
    v_mfma_f32_16x16x32_bf16 v[136:139], a[212:215], a[160:163], v[136:139]
    s_add_u32 s48, s47, s45
    buffer_load_dwordx4 v249, s[32:35], s48 offen offset:2048 lds
    v_cvt_pk_bf16_f32 v152, v124, v125
    v_mfma_f32_16x16x32_bf16 v[136:139], a[216:219], a[172:175], v[136:139]
    v_exp_f32 v127, v127
    v_mfma_f32_16x16x32_bf16 v[136:139], a[220:223], a[184:187], v[136:139]
    v_cvt_pk_bf16_f32 v153, v126, v127
    v_mfma_f32_16x16x32_bf16 v[140:143], a[208:211], a[152:155], 0
    ds_read_b128 a[208:211], v228 offset:40960
    v_mfma_f32_16x16x32_bf16 v[140:143], a[212:215], a[164:167], v[140:143]
    ds_read_b128 a[212:215], v229 offset:40960
    v_mfma_f32_16x16x32_bf16 v[140:143], a[216:219], a[176:179], v[140:143]
    s_add_u32 s49, s48, s45
    buffer_load_dwordx4 v250, s[32:35], s49 offen offset:3072 lds
    ds_read_b128 a[216:219], v230 offset:40960
    v_mfma_f32_16x16x32_bf16 v[140:143], a[220:223], a[188:191], v[140:143]
    s_add_u32 s43, s43, s44
    ds_read_b128 a[220:223], v231 offset:40960
    v_mfma_f32_16x16x32_bf16 v[108:111], a[248:251], v[176:179], v[108:111]
    v_exp_f32 v128, v128
    v_mfma_f32_16x16x32_bf16 v[108:111], a[248:251], v[188:191], v[108:111]
    s_waitcnt lgkmcnt(10)
    v_exp_f32 v129, v129
    v_mfma_f32_16x16x32_bf16 v[24:27], a[232:235], v[172:175], v[24:27]
    s_waitcnt lgkmcnt(8)
    v_exp_f32 v130, v130
    v_mfma_f32_16x16x32_bf16 v[24:27], a[236:239], v[184:187], v[24:27]
    v_exp_f32 v131, v131
    v_mfma_f32_16x16x32_bf16 v[28:31], a[232:235], v[176:179], v[28:31]
    v_cvt_pk_bf16_f32 v156, v128, v129
    v_cvt_pk_bf16_f32 v157, v130, v131
    v_mfma_f32_16x16x32_bf16 v[28:31], a[236:239], v[188:191], v[28:31]
    v_exp_f32 v132, v132
    v_mfma_f32_16x16x32_bf16 v[32:35], a[232:235], v[180:183], v[32:35]
    ds_read_b64_tr_b16 a[232:233], v240 offset:16384
    v_mfma_f32_16x16x32_bf16 v[32:35], a[236:239], v[192:195], v[32:35]
    s_waitcnt lgkmcnt(7)
    ds_read_b64_tr_b16 a[234:235], v240 offset:20480
    ds_read_b64_tr_b16 a[236:237], v240 offset:24576
    v_mfma_f32_16x16x32_bf16 v[36:39], a[240:243], v[172:175], v[36:39]
    s_waitcnt lgkmcnt(7)
    ds_read_b64_tr_b16 a[238:239], v240 offset:28672
    v_mfma_f32_16x16x32_bf16 v[36:39], a[244:247], v[184:187], v[36:39]
    v_exp_f32 v133, v133
    v_mfma_f32_16x16x32_bf16 v[40:43], a[240:243], v[176:179], v[40:43]
    v_exp_f32 v134, v134
    v_mfma_f32_16x16x32_bf16 v[40:43], a[244:247], v[188:191], v[40:43]
    v_exp_f32 v135, v135
    v_mfma_f32_16x16x32_bf16 v[44:47], a[240:243], v[180:183], v[44:47]
    ds_read_b64_tr_b16 a[240:241], v241 offset:16384
    v_cvt_pk_bf16_f32 v150, v132, v133
    v_mfma_f32_16x16x32_bf16 v[44:47], a[244:247], v[192:195], v[44:47]
    ds_read_b64_tr_b16 a[242:243], v241 offset:20480
    v_cvt_pk_bf16_f32 v151, v134, v135
    v_mfma_f32_16x16x32_bf16 v[144:147], a[224:227], a[192:195], 0
    ds_read_b64_tr_b16 a[244:245], v241 offset:24576
    v_mfma_f32_16x16x32_bf16 v[144:147], a[228:231], a[196:199], v[144:147]
    s_waitcnt lgkmcnt(10)
    ds_read_b64_tr_b16 a[246:247], v241 offset:28672
    ds_read_b128 a[224:227], v234 offset:32768
    v_mfma_f32_16x16x32_bf16 v[120:123], a[208:211], a[144:147], 0
    s_waitcnt lgkmcnt(11)
    ds_read_b128 a[228:231], v235 offset:32768
    v_mfma_f32_16x16x32_bf16 v[120:123], a[212:215], a[156:159], v[120:123]
    s_waitcnt lgkmcnt(11)
    v_exp_f32 v136, v136
    v_mfma_f32_16x16x32_bf16 v[120:123], a[216:219], a[168:171], v[120:123]
    s_waitcnt lgkmcnt(10)
    v_exp_f32 v137, v137
    v_mfma_f32_16x16x32_bf16 v[120:123], a[220:223], a[180:183], v[120:123]
    v_exp_f32 v138, v138
    v_mfma_f32_16x16x32_bf16 v[124:127], a[208:211], a[148:151], 0
    v_exp_f32 v139, v139
    v_mfma_f32_16x16x32_bf16 v[124:127], a[212:215], a[160:163], v[124:127]
    v_cvt_pk_bf16_f32 v154, v136, v137
    v_cvt_pk_bf16_f32 v155, v138, v139
    v_mfma_f32_16x16x32_bf16 v[124:127], a[216:219], a[172:175], v[124:127]
    v_exp_f32 v140, v140
    v_mfma_f32_16x16x32_bf16 v[124:127], a[220:223], a[184:187], v[124:127]
    v_exp_f32 v141, v141
    v_mfma_f32_16x16x32_bf16 v[128:131], a[208:211], a[152:155], 0
    ds_read_b128 a[208:211], v228 offset:45056
    v_cvt_pk_bf16_f32 v158, v140, v141
    v_mfma_f32_16x16x32_bf16 v[128:131], a[212:215], a[164:167], v[128:131]
    ds_read_b128 a[212:215], v229 offset:45056
    v_mfma_f32_16x16x32_bf16 v[128:131], a[216:219], a[176:179], v[128:131]
    ds_read_b128 a[216:219], v230 offset:45056
    v_mfma_f32_16x16x32_bf16 v[128:131], a[220:223], a[188:191], v[128:131]
    ds_read_b128 a[220:223], v231 offset:45056
    v_mfma_f32_16x16x32_bf16 v[112:115], a[248:251], v[180:183], v[112:115]
    v_exp_f32 v142, v142
    v_mfma_f32_16x16x32_bf16 v[112:115], a[248:251], v[192:195], v[112:115]
    s_waitcnt lgkmcnt(12)
    v_exp_f32 v143, v143
    v_mfma_f32_16x16x32_bf16 v[48:51], a[232:235], v[172:175], v[48:51]
    s_waitcnt lgkmcnt(10)
    v_cvt_pk_bf16_f32 v159, v142, v143
    v_mfma_f32_16x16x32_bf16 v[48:51], a[236:239], v[184:187], v[48:51]
    v_exp_f32 v120, v120
    v_mfma_f32_16x16x32_bf16 v[52:55], a[232:235], v[176:179], v[52:55]
    v_exp_f32 v121, v121
    v_mfma_f32_16x16x32_bf16 v[52:55], a[236:239], v[188:191], v[52:55]
    v_exp_f32 v122, v122
    v_mfma_f32_16x16x32_bf16 v[56:59], a[232:235], v[180:183], v[56:59]
    ds_read_b64_tr_b16 a[232:233], v242 offset:16384
    v_cvt_pk_bf16_f32 v160, v120, v121
    v_mfma_f32_16x16x32_bf16 v[56:59], a[236:239], v[192:195], v[56:59]
    s_waitcnt lgkmcnt(9)
    ds_read_b64_tr_b16 a[234:235], v242 offset:20480
    ds_read_b64_tr_b16 a[236:237], v242 offset:24576
    v_mfma_f32_16x16x32_bf16 v[60:63], a[240:243], v[172:175], v[60:63]
    s_waitcnt lgkmcnt(9)
    ds_read_b64_tr_b16 a[238:239], v242 offset:28672
    v_mfma_f32_16x16x32_bf16 v[60:63], a[244:247], v[184:187], v[60:63]
    v_exp_f32 v123, v123
    v_mfma_f32_16x16x32_bf16 v[64:67], a[240:243], v[176:179], v[64:67]
    v_cvt_pk_bf16_f32 v161, v122, v123
    v_mfma_f32_16x16x32_bf16 v[64:67], a[244:247], v[188:191], v[64:67]
    v_exp_f32 v124, v124
    v_mfma_f32_16x16x32_bf16 v[68:71], a[240:243], v[180:183], v[68:71]
    ds_read_b64_tr_b16 a[240:241], v243 offset:16384
    v_mfma_f32_16x16x32_bf16 v[68:71], a[244:247], v[192:195], v[68:71]
    s_waitcnt lgkmcnt(10)
    ds_read_b64_tr_b16 a[242:243], v243 offset:20480
    ds_read_b64_tr_b16 a[244:245], v243 offset:24576
    v_mfma_f32_16x16x32_bf16 v[144:147], a[224:227], a[200:203], v[144:147]
    s_waitcnt lgkmcnt(11)
    ds_read_b64_tr_b16 a[246:247], v243 offset:28672
    v_mfma_f32_16x16x32_bf16 v[144:147], a[228:231], a[204:207], v[144:147]
    s_waitcnt lgkmcnt(11)
    v_exp_f32 v125, v125
    v_mfma_f32_16x16x32_bf16 v[132:135], a[208:211], a[144:147], 0
    s_waitcnt lgkmcnt(10)
    v_exp_f32 v126, v126
    v_mfma_f32_16x16x32_bf16 v[132:135], a[212:215], a[156:159], v[132:135]
    s_waitcnt lgkmcnt(9)
    v_exp_f32 v127, v127
    v_mfma_f32_16x16x32_bf16 v[132:135], a[216:219], a[168:171], v[132:135]
    s_waitcnt lgkmcnt(8)
    v_exp_f32 v144, v144
    v_mfma_f32_16x16x32_bf16 v[132:135], a[220:223], a[180:183], v[132:135]
    v_exp_f32 v145, v145
    v_mfma_f32_16x16x32_bf16 v[136:139], a[208:211], a[148:151], 0
    v_exp_f32 v146, v146
    v_mfma_f32_16x16x32_bf16 v[136:139], a[212:215], a[160:163], v[136:139]
    v_exp_f32 v147, v147
    v_mfma_f32_16x16x32_bf16 v[136:139], a[216:219], a[172:175], v[136:139]
    v_cvt_pk_bf16_f32 v204, v144, v145
    v_cvt_pk_bf16_f32 v205, v146, v147
    v_mfma_f32_16x16x32_bf16 v[136:139], a[220:223], a[184:187], v[136:139]
    ds_write_b64 v246, v[204:205] offset:0
    v_mfma_f32_16x16x32_bf16 v[140:143], a[208:211], a[152:155], 0
    v_cvt_pk_bf16_f32 v164, v124, v125
    v_cvt_pk_bf16_f32 v165, v126, v127
    v_mfma_f32_16x16x32_bf16 v[140:143], a[212:215], a[164:167], v[140:143]
    v_exp_f32 v128, v128
    v_mfma_f32_16x16x32_bf16 v[140:143], a[216:219], a[176:179], v[140:143]
    v_exp_f32 v129, v129
    v_mfma_f32_16x16x32_bf16 v[140:143], a[220:223], a[188:191], v[140:143]
    s_waitcnt lgkmcnt(0)
    v_exp_f32 v130, v130
    v_exp_f32 v131, v131
    s_barrier
    v_mfma_f32_16x16x32_bf16 v[72:75], a[232:235], v[172:175], v[72:75]
    ds_read_b128 a[208:211], v228 offset:49152
    v_cvt_pk_bf16_f32 v168, v128, v129
    v_mfma_f32_16x16x32_bf16 v[72:75], a[236:239], v[184:187], v[72:75]
    ds_read_b128 a[212:215], v229 offset:49152
    v_cvt_pk_bf16_f32 v169, v130, v131
    v_mfma_f32_16x16x32_bf16 v[76:79], a[232:235], v[176:179], v[76:79]
    ds_read_b128 a[216:219], v230 offset:49152
    v_mfma_f32_16x16x32_bf16 v[76:79], a[236:239], v[188:191], v[76:79]
    ds_read_b128 a[220:223], v231 offset:49152
    v_mfma_f32_16x16x32_bf16 v[80:83], a[232:235], v[180:183], v[80:83]
    ds_read_b64_tr_b16 a[232:233], v236 offset:32768
    v_mfma_f32_16x16x32_bf16 v[80:83], a[236:239], v[192:195], v[80:83]
    s_add_u32 m0, s41, 32768
    ds_read_b64_tr_b16 a[234:235], v236 offset:36864
    buffer_load_dwordx4 v249, s[32:35], s42 offen offset:0 lds
    v_mfma_f32_16x16x32_bf16 v[84:87], a[240:243], v[172:175], v[84:87]
    ds_read_b64_tr_b16 a[236:237], v236 offset:40960
    v_mfma_f32_16x16x32_bf16 v[84:87], a[244:247], v[184:187], v[84:87]
    ds_read_b64_tr_b16 a[238:239], v236 offset:45056
    v_mfma_f32_16x16x32_bf16 v[88:91], a[240:243], v[176:179], v[88:91]
    v_exp_f32 v132, v132
    v_mfma_f32_16x16x32_bf16 v[88:91], a[244:247], v[188:191], v[88:91]
    v_exp_f32 v133, v133
    v_mfma_f32_16x16x32_bf16 v[92:95], a[240:243], v[180:183], v[92:95]
    s_add_u32 s47, s42, s45
    buffer_load_dwordx4 v250, s[32:35], s47 offen offset:1024 lds
    v_cvt_pk_bf16_f32 v162, v132, v133
    v_mfma_f32_16x16x32_bf16 v[92:95], a[244:247], v[192:195], v[92:95]
    v_exp_f32 v134, v134
    v_mfma_f32_16x16x32_bf16 v[116:119], a[248:251], v[196:199], v[116:119]
    v_exp_f32 v135, v135
    v_mfma_f32_16x16x32_bf16 v[116:119], a[248:251], v[200:203], v[116:119]
    s_waitcnt lgkmcnt(7)
    v_cvt_pk_bf16_f32 v163, v134, v135
    v_mfma_f32_16x16x32_bf16 v[120:123], a[208:211], a[144:147], 0
    s_waitcnt lgkmcnt(6)
    ds_read_b128 v[196:199], v244 offset:16384
    ds_read_b128 v[200:203], v244 offset:17408
    v_mfma_f32_16x16x32_bf16 v[120:123], a[212:215], a[156:159], v[120:123]
    s_waitcnt lgkmcnt(7)
    s_add_u32 s48, s47, s45
    v_exp_f32 v136, v136
    v_mfma_f32_16x16x32_bf16 v[120:123], a[216:219], a[168:171], v[120:123]
    s_waitcnt lgkmcnt(6)
    buffer_load_dwordx4 v249, s[32:35], s48 offen offset:2048 lds
    ds_read_b64_tr_b16 a[240:241], v237 offset:32768
    v_mfma_f32_16x16x32_bf16 v[120:123], a[220:223], a[180:183], v[120:123]
    v_exp_f32 v137, v137
    v_mfma_f32_16x16x32_bf16 v[124:127], a[208:211], a[148:151], 0
    v_exp_f32 v138, v138
    v_mfma_f32_16x16x32_bf16 v[124:127], a[212:215], a[160:163], v[124:127]
    v_exp_f32 v139, v139
    v_mfma_f32_16x16x32_bf16 v[124:127], a[216:219], a[172:175], v[124:127]
    s_add_u32 s49, s48, s45
    buffer_load_dwordx4 v250, s[32:35], s49 offen offset:3072 lds
    v_cvt_pk_bf16_f32 v166, v136, v137
    v_mfma_f32_16x16x32_bf16 v[124:127], a[220:223], a[184:187], v[124:127]
    s_add_u32 s42, s42, s44
    v_cvt_pk_bf16_f32 v167, v138, v139
    v_mfma_f32_16x16x32_bf16 v[128:131], a[208:211], a[152:155], 0
    ds_read_b64_tr_b16 a[242:243], v237 offset:36864
    v_mfma_f32_16x16x32_bf16 v[128:131], a[212:215], a[164:167], v[128:131]
    v_exp_f32 v140, v140
    v_mfma_f32_16x16x32_bf16 v[128:131], a[216:219], a[176:179], v[128:131]
    v_exp_f32 v141, v141
    v_mfma_f32_16x16x32_bf16 v[128:131], a[220:223], a[188:191], v[128:131]
    v_exp_f32 v142, v142
    v_mfma_f32_16x16x32_bf16 v[104:107], a[248:251], v[148:151], v[104:107]
    v_exp_f32 v143, v143
    v_mfma_f32_16x16x32_bf16 v[104:107], a[248:251], v[160:163], v[104:107]
    s_waitcnt lgkmcnt(6)
    ds_read_b64_tr_b16 a[244:245], v237 offset:40960
    ds_read_b64_tr_b16 a[246:247], v237 offset:45056
    v_mfma_f32_16x16x32_bf16 v[0:3], a[232:235], v[148:151], v[0:3]
    s_waitcnt lgkmcnt(6)
    v_cvt_pk_bf16_f32 v170, v140, v141
    v_cvt_pk_bf16_f32 v171, v142, v143
    v_mfma_f32_16x16x32_bf16 v[0:3], a[236:239], v[160:163], v[0:3]
    ds_read_b128 a[208:211], v228 offset:53248
    v_mfma_f32_16x16x32_bf16 v[4:7], a[232:235], v[152:155], v[4:7]
    ds_read_b128 a[212:215], v229 offset:53248
    v_mfma_f32_16x16x32_bf16 v[4:7], a[236:239], v[164:167], v[4:7]
    ds_read_b128 a[216:219], v230 offset:53248
    v_mfma_f32_16x16x32_bf16 v[8:11], a[232:235], v[156:159], v[8:11]
    ds_read_b128 a[220:223], v231 offset:53248
    v_mfma_f32_16x16x32_bf16 v[8:11], a[236:239], v[168:171], v[8:11]
    s_waitcnt lgkmcnt(9)
    ds_read_b128 a[224:227], v232 offset:49152
    ds_read_b128 a[228:231], v233 offset:49152
    v_mfma_f32_16x16x32_bf16 v[96:99], a[232:235], v[196:199], v[96:99]
    s_waitcnt lgkmcnt(10)
    ds_read_b64_tr_b16 a[232:233], v238 offset:32768
    ds_read_b64_tr_b16 a[234:235], v238 offset:36864
    v_mfma_f32_16x16x32_bf16 v[96:99], a[236:239], v[200:203], v[96:99]
    s_waitcnt lgkmcnt(10)
    ds_read_b64_tr_b16 a[236:237], v238 offset:40960
    ds_read_b64_tr_b16 a[238:239], v238 offset:45056
    v_mfma_f32_16x16x32_bf16 v[12:15], a[240:243], v[148:151], v[12:15]
    s_waitcnt lgkmcnt(10)
    v_exp_f32 v120, v120
    v_mfma_f32_16x16x32_bf16 v[12:15], a[244:247], v[160:163], v[12:15]
    v_exp_f32 v121, v121
    v_mfma_f32_16x16x32_bf16 v[16:19], a[240:243], v[152:155], v[16:19]
    v_exp_f32 v122, v122
    v_mfma_f32_16x16x32_bf16 v[16:19], a[244:247], v[164:167], v[16:19]
    s_add_u32 m0, s41, 81920
    v_exp_f32 v123, v123
    v_mfma_f32_16x16x32_bf16 v[20:23], a[240:243], v[156:159], v[20:23]
    buffer_load_dwordx4 v249, s[32:35], s43 offen offset:0 lds
    v_cvt_pk_bf16_f32 v172, v120, v121
    v_mfma_f32_16x16x32_bf16 v[20:23], a[244:247], v[168:171], v[20:23]
    v_cvt_pk_bf16_f32 v173, v122, v123
    v_mfma_f32_16x16x32_bf16 v[100:103], a[240:243], v[196:199], v[100:103]
    ds_read_b64_tr_b16 a[240:241], v239 offset:32768
    v_mfma_f32_16x16x32_bf16 v[100:103], a[244:247], v[200:203], v[100:103]
    s_waitcnt lgkmcnt(10)
    ds_read_b64_tr_b16 a[242:243], v239 offset:36864
    ds_read_b64_tr_b16 a[244:245], v239 offset:40960
    v_mfma_f32_16x16x32_bf16 v[132:135], a[208:211], a[144:147], 0
    s_waitcnt lgkmcnt(11)
    s_add_u32 s47, s43, s45
    ds_read_b64_tr_b16 a[246:247], v239 offset:45056
    v_mfma_f32_16x16x32_bf16 v[132:135], a[212:215], a[156:159], v[132:135]
    s_waitcnt lgkmcnt(11)
    buffer_load_dwordx4 v250, s[32:35], s47 offen offset:1024 lds
    v_mfma_f32_16x16x32_bf16 v[132:135], a[216:219], a[168:171], v[132:135]
    s_waitcnt lgkmcnt(10)
    v_exp_f32 v124, v124
    v_mfma_f32_16x16x32_bf16 v[132:135], a[220:223], a[180:183], v[132:135]
    v_exp_f32 v125, v125
    v_mfma_f32_16x16x32_bf16 v[136:139], a[208:211], a[148:151], 0
    v_exp_f32 v126, v126
    v_mfma_f32_16x16x32_bf16 v[136:139], a[212:215], a[160:163], v[136:139]
    s_add_u32 s48, s47, s45
    buffer_load_dwordx4 v249, s[32:35], s48 offen offset:2048 lds
    v_cvt_pk_bf16_f32 v176, v124, v125
    v_mfma_f32_16x16x32_bf16 v[136:139], a[216:219], a[172:175], v[136:139]
    v_exp_f32 v127, v127
    v_mfma_f32_16x16x32_bf16 v[136:139], a[220:223], a[184:187], v[136:139]
    v_cvt_pk_bf16_f32 v177, v126, v127
    v_mfma_f32_16x16x32_bf16 v[140:143], a[208:211], a[152:155], 0
    ds_read_b128 a[208:211], v228 offset:57344
    v_mfma_f32_16x16x32_bf16 v[140:143], a[212:215], a[164:167], v[140:143]
    ds_read_b128 a[212:215], v229 offset:57344
    v_mfma_f32_16x16x32_bf16 v[140:143], a[216:219], a[176:179], v[140:143]
    s_add_u32 s49, s48, s45
    buffer_load_dwordx4 v250, s[32:35], s49 offen offset:3072 lds
    ds_read_b128 a[216:219], v230 offset:57344
    v_mfma_f32_16x16x32_bf16 v[140:143], a[220:223], a[188:191], v[140:143]
    s_add_u32 s43, s43, s63
    ds_read_b128 a[220:223], v231 offset:57344
    v_mfma_f32_16x16x32_bf16 v[108:111], a[248:251], v[152:155], v[108:111]
    v_exp_f32 v128, v128
    v_mfma_f32_16x16x32_bf16 v[108:111], a[248:251], v[164:167], v[108:111]
    s_waitcnt lgkmcnt(10)
    v_exp_f32 v129, v129
    v_mfma_f32_16x16x32_bf16 v[24:27], a[232:235], v[148:151], v[24:27]
    s_waitcnt lgkmcnt(8)
    v_exp_f32 v130, v130
    v_mfma_f32_16x16x32_bf16 v[24:27], a[236:239], v[160:163], v[24:27]
    v_exp_f32 v131, v131
    v_mfma_f32_16x16x32_bf16 v[28:31], a[232:235], v[152:155], v[28:31]
    v_cvt_pk_bf16_f32 v180, v128, v129
    v_cvt_pk_bf16_f32 v181, v130, v131
    v_mfma_f32_16x16x32_bf16 v[28:31], a[236:239], v[164:167], v[28:31]
    v_exp_f32 v132, v132
    v_mfma_f32_16x16x32_bf16 v[32:35], a[232:235], v[156:159], v[32:35]
    ds_read_b64_tr_b16 a[232:233], v240 offset:32768
    v_mfma_f32_16x16x32_bf16 v[32:35], a[236:239], v[168:171], v[32:35]
    s_waitcnt lgkmcnt(7)
    ds_read_b64_tr_b16 a[234:235], v240 offset:36864
    ds_read_b64_tr_b16 a[236:237], v240 offset:40960
    v_mfma_f32_16x16x32_bf16 v[36:39], a[240:243], v[148:151], v[36:39]
    s_waitcnt lgkmcnt(7)
    ds_read_b64_tr_b16 a[238:239], v240 offset:45056
    v_mfma_f32_16x16x32_bf16 v[36:39], a[244:247], v[160:163], v[36:39]
    v_exp_f32 v133, v133
    v_mfma_f32_16x16x32_bf16 v[40:43], a[240:243], v[152:155], v[40:43]
    v_exp_f32 v134, v134
    v_mfma_f32_16x16x32_bf16 v[40:43], a[244:247], v[164:167], v[40:43]
    v_exp_f32 v135, v135
    v_mfma_f32_16x16x32_bf16 v[44:47], a[240:243], v[156:159], v[44:47]
    ds_read_b64_tr_b16 a[240:241], v241 offset:32768
    v_cvt_pk_bf16_f32 v174, v132, v133
    v_mfma_f32_16x16x32_bf16 v[44:47], a[244:247], v[168:171], v[44:47]
    ds_read_b64_tr_b16 a[242:243], v241 offset:36864
    v_cvt_pk_bf16_f32 v175, v134, v135
    v_mfma_f32_16x16x32_bf16 v[144:147], a[224:227], a[192:195], 0
    ds_read_b64_tr_b16 a[244:245], v241 offset:40960
    v_mfma_f32_16x16x32_bf16 v[144:147], a[228:231], a[196:199], v[144:147]
    s_waitcnt lgkmcnt(10)
    ds_read_b64_tr_b16 a[246:247], v241 offset:45056
    ds_read_b128 a[224:227], v234 offset:49152
    v_mfma_f32_16x16x32_bf16 v[120:123], a[208:211], a[144:147], 0
    s_waitcnt lgkmcnt(11)
    ds_read_b128 a[228:231], v235 offset:49152
    v_mfma_f32_16x16x32_bf16 v[120:123], a[212:215], a[156:159], v[120:123]
    s_waitcnt lgkmcnt(11)
    v_exp_f32 v136, v136
    v_mfma_f32_16x16x32_bf16 v[120:123], a[216:219], a[168:171], v[120:123]
    s_waitcnt lgkmcnt(10)
    v_exp_f32 v137, v137
    v_mfma_f32_16x16x32_bf16 v[120:123], a[220:223], a[180:183], v[120:123]
    v_exp_f32 v138, v138
    v_mfma_f32_16x16x32_bf16 v[124:127], a[208:211], a[148:151], 0
    v_exp_f32 v139, v139
    v_mfma_f32_16x16x32_bf16 v[124:127], a[212:215], a[160:163], v[124:127]
    v_cvt_pk_bf16_f32 v178, v136, v137
    v_cvt_pk_bf16_f32 v179, v138, v139
    v_mfma_f32_16x16x32_bf16 v[124:127], a[216:219], a[172:175], v[124:127]
    v_exp_f32 v140, v140
    v_mfma_f32_16x16x32_bf16 v[124:127], a[220:223], a[184:187], v[124:127]
    v_exp_f32 v141, v141
    v_mfma_f32_16x16x32_bf16 v[128:131], a[208:211], a[152:155], 0
    ds_read_b128 a[208:211], v228 offset:61440
    v_cvt_pk_bf16_f32 v182, v140, v141
    v_mfma_f32_16x16x32_bf16 v[128:131], a[212:215], a[164:167], v[128:131]
    ds_read_b128 a[212:215], v229 offset:61440
    v_mfma_f32_16x16x32_bf16 v[128:131], a[216:219], a[176:179], v[128:131]
    ds_read_b128 a[216:219], v230 offset:61440
    v_mfma_f32_16x16x32_bf16 v[128:131], a[220:223], a[188:191], v[128:131]
    ds_read_b128 a[220:223], v231 offset:61440
    v_mfma_f32_16x16x32_bf16 v[112:115], a[248:251], v[156:159], v[112:115]
    v_exp_f32 v142, v142
    v_mfma_f32_16x16x32_bf16 v[112:115], a[248:251], v[168:171], v[112:115]
    s_waitcnt lgkmcnt(12)
    v_exp_f32 v143, v143
    v_mfma_f32_16x16x32_bf16 v[48:51], a[232:235], v[148:151], v[48:51]
    s_waitcnt lgkmcnt(10)
    v_cvt_pk_bf16_f32 v183, v142, v143
    v_mfma_f32_16x16x32_bf16 v[48:51], a[236:239], v[160:163], v[48:51]
    v_exp_f32 v120, v120
    v_mfma_f32_16x16x32_bf16 v[52:55], a[232:235], v[152:155], v[52:55]
    v_exp_f32 v121, v121
    v_mfma_f32_16x16x32_bf16 v[52:55], a[236:239], v[164:167], v[52:55]
    v_exp_f32 v122, v122
    v_mfma_f32_16x16x32_bf16 v[56:59], a[232:235], v[156:159], v[56:59]
    ds_read_b64_tr_b16 a[232:233], v242 offset:32768
    v_cvt_pk_bf16_f32 v184, v120, v121
    v_mfma_f32_16x16x32_bf16 v[56:59], a[236:239], v[168:171], v[56:59]
    s_waitcnt lgkmcnt(9)
    ds_read_b64_tr_b16 a[234:235], v242 offset:36864
    ds_read_b64_tr_b16 a[236:237], v242 offset:40960
    v_mfma_f32_16x16x32_bf16 v[60:63], a[240:243], v[148:151], v[60:63]
    s_waitcnt lgkmcnt(9)
    ds_read_b64_tr_b16 a[238:239], v242 offset:45056
    v_mfma_f32_16x16x32_bf16 v[60:63], a[244:247], v[160:163], v[60:63]
    v_exp_f32 v123, v123
    v_mfma_f32_16x16x32_bf16 v[64:67], a[240:243], v[152:155], v[64:67]
    v_cvt_pk_bf16_f32 v185, v122, v123
    v_mfma_f32_16x16x32_bf16 v[64:67], a[244:247], v[164:167], v[64:67]
    v_exp_f32 v124, v124
    v_mfma_f32_16x16x32_bf16 v[68:71], a[240:243], v[156:159], v[68:71]
    ds_read_b64_tr_b16 a[240:241], v243 offset:32768
    v_mfma_f32_16x16x32_bf16 v[68:71], a[244:247], v[168:171], v[68:71]
    s_waitcnt lgkmcnt(10)
    ds_read_b64_tr_b16 a[242:243], v243 offset:36864
    ds_read_b64_tr_b16 a[244:245], v243 offset:40960
    v_mfma_f32_16x16x32_bf16 v[144:147], a[224:227], a[200:203], v[144:147]
    s_waitcnt lgkmcnt(11)
    ds_read_b64_tr_b16 a[246:247], v243 offset:45056
    v_mfma_f32_16x16x32_bf16 v[144:147], a[228:231], a[204:207], v[144:147]
    s_waitcnt lgkmcnt(11)
    v_exp_f32 v125, v125
    v_mfma_f32_16x16x32_bf16 v[132:135], a[208:211], a[144:147], 0
    s_waitcnt lgkmcnt(10)
    v_exp_f32 v126, v126
    v_mfma_f32_16x16x32_bf16 v[132:135], a[212:215], a[156:159], v[132:135]
    s_waitcnt lgkmcnt(9)
    v_exp_f32 v127, v127
    v_mfma_f32_16x16x32_bf16 v[132:135], a[216:219], a[168:171], v[132:135]
    s_waitcnt lgkmcnt(8)
    v_exp_f32 v144, v144
    v_mfma_f32_16x16x32_bf16 v[132:135], a[220:223], a[180:183], v[132:135]
    v_exp_f32 v145, v145
    v_mfma_f32_16x16x32_bf16 v[136:139], a[208:211], a[148:151], 0
    v_exp_f32 v146, v146
    v_mfma_f32_16x16x32_bf16 v[136:139], a[212:215], a[160:163], v[136:139]
    v_exp_f32 v147, v147
    v_mfma_f32_16x16x32_bf16 v[136:139], a[216:219], a[172:175], v[136:139]
    v_cvt_pk_bf16_f32 v204, v144, v145
    v_cvt_pk_bf16_f32 v205, v146, v147
    v_mfma_f32_16x16x32_bf16 v[136:139], a[220:223], a[184:187], v[136:139]
    ds_write_b64 v246, v[204:205] offset:2048
    v_mfma_f32_16x16x32_bf16 v[140:143], a[208:211], a[152:155], 0
    v_exp_f32 v132, v132
    v_mfma_f32_16x16x32_bf16 v[140:143], a[212:215], a[164:167], v[140:143]
    v_exp_f32 v133, v133
    v_mfma_f32_16x16x32_bf16 v[140:143], a[216:219], a[176:179], v[140:143]
    v_exp_f32 v134, v134
    v_mfma_f32_16x16x32_bf16 v[140:143], a[220:223], a[188:191], v[140:143]
    s_waitcnt vmcnt(16) lgkmcnt(0)
    v_exp_f32 v135, v135
    v_cvt_pk_bf16_f32 v186, v132, v133
    v_cvt_pk_bf16_f32 v187, v134, v135
    s_barrier
    v_mfma_f32_16x16x32_bf16 v[72:75], a[232:235], v[148:151], v[72:75]
    v_exp_f32 v136, v136
    v_mfma_f32_16x16x32_bf16 v[72:75], a[236:239], v[160:163], v[72:75]
    s_add_u32 m0, s41, 98304
    v_exp_f32 v137, v137
    v_mfma_f32_16x16x32_bf16 v[76:79], a[232:235], v[152:155], v[76:79]
    buffer_load_dwordx4 v249, s[32:35], s43 offen offset:0 lds
    v_cvt_pk_bf16_f32 v188, v124, v125
    v_mfma_f32_16x16x32_bf16 v[76:79], a[236:239], v[164:167], v[76:79]
    v_exp_f32 v138, v138
    v_mfma_f32_16x16x32_bf16 v[80:83], a[232:235], v[156:159], v[80:83]
    ds_read_b64_tr_b16 a[232:233], v236 offset:49152
    v_cvt_pk_bf16_f32 v189, v126, v127
    v_mfma_f32_16x16x32_bf16 v[80:83], a[236:239], v[168:171], v[80:83]
    s_add_u32 s47, s43, s45
    ds_read_b64_tr_b16 a[234:235], v236 offset:53248
    ds_read_b64_tr_b16 a[236:237], v236 offset:57344
    v_mfma_f32_16x16x32_bf16 v[84:87], a[240:243], v[148:151], v[84:87]
    ds_read_b64_tr_b16 a[238:239], v236 offset:61440
    v_cvt_pk_bf16_f32 v190, v136, v137
    v_mfma_f32_16x16x32_bf16 v[84:87], a[244:247], v[160:163], v[84:87]
    buffer_load_dwordx4 v250, s[32:35], s47 offen offset:1024 lds
    v_mfma_f32_16x16x32_bf16 v[88:91], a[240:243], v[152:155], v[88:91]
    v_exp_f32 v139, v139
    v_mfma_f32_16x16x32_bf16 v[88:91], a[244:247], v[164:167], v[88:91]
    s_add_u32 s48, s47, s45
    v_cvt_pk_bf16_f32 v191, v138, v139
    v_mfma_f32_16x16x32_bf16 v[92:95], a[240:243], v[156:159], v[92:95]
    v_exp_f32 v128, v128
    v_mfma_f32_16x16x32_bf16 v[92:95], a[244:247], v[168:171], v[92:95]
    v_exp_f32 v129, v129
    v_mfma_f32_16x16x32_bf16 v[116:119], a[248:251], v[196:199], v[116:119]
    ds_read_b128 v[196:199], v244 offset:18432
    v_cvt_pk_bf16_f32 v192, v128, v129
    v_mfma_f32_16x16x32_bf16 v[116:119], a[248:251], v[200:203], v[116:119]
    s_waitcnt lgkmcnt(3)
    ds_read_b128 v[200:203], v244 offset:19456
    buffer_load_dwordx4 v249, s[32:35], s48 offen offset:2048 lds
    v_mfma_f32_16x16x32_bf16 v[0:3], a[232:235], v[172:175], v[0:3]
    s_waitcnt lgkmcnt(2)
    v_exp_f32 v130, v130
    v_mfma_f32_16x16x32_bf16 v[0:3], a[236:239], v[184:187], v[0:3]
    s_add_u32 s49, s48, s45
    v_exp_f32 v131, v131
    v_mfma_f32_16x16x32_bf16 v[4:7], a[232:235], v[176:179], v[4:7]
    s_add_u32 s43, s43, s44
    v_exp_f32 v140, v140
    v_mfma_f32_16x16x32_bf16 v[4:7], a[236:239], v[188:191], v[4:7]
    v_exp_f32 v141, v141
    v_mfma_f32_16x16x32_bf16 v[8:11], a[232:235], v[180:183], v[8:11]
    v_exp_f32 v142, v142
    v_exp_f32 v143, v143
    v_cvt_pk_bf16_f32 v193, v130, v131
    v_cvt_pk_bf16_f32 v194, v140, v141
    v_cvt_pk_bf16_f32 v195, v142, v143
    buffer_load_dwordx4 v250, s[32:35], s49 offen offset:3072 lds
    ds_read_b64_tr_b16 a[240:241], v237 offset:49152
    v_mfma_f32_16x16x32_bf16 v[8:11], a[236:239], v[192:195], v[8:11]
    s_waitcnt lgkmcnt(2)
    ds_read_b64_tr_b16 a[242:243], v237 offset:53248
    ds_read_b64_tr_b16 a[244:245], v237 offset:57344
    v_mfma_f32_16x16x32_bf16 v[96:99], a[232:235], v[196:199], v[96:99]
    s_waitcnt lgkmcnt(3)
    ds_read_b64_tr_b16 a[246:247], v237 offset:61440
    ds_read_b64_tr_b16 a[232:233], v238 offset:49152
    v_mfma_f32_16x16x32_bf16 v[96:99], a[236:239], v[200:203], v[96:99]
    ds_read_b64_tr_b16 a[234:235], v238 offset:53248
    v_mfma_f32_16x16x32_bf16 v[104:107], a[248:251], v[172:175], v[104:107]
    ds_read_b64_tr_b16 a[236:237], v238 offset:57344
    v_mfma_f32_16x16x32_bf16 v[104:107], a[248:251], v[184:187], v[104:107]
    ds_read_b64_tr_b16 a[238:239], v238 offset:61440
    v_mfma_f32_16x16x32_bf16 v[108:111], a[248:251], v[176:179], v[108:111]
    v_mfma_f32_16x16x32_bf16 v[108:111], a[248:251], v[188:191], v[108:111]
    v_mfma_f32_16x16x32_bf16 v[112:115], a[248:251], v[180:183], v[112:115]
    v_mfma_f32_16x16x32_bf16 v[112:115], a[248:251], v[192:195], v[112:115]
    v_mfma_f32_16x16x32_bf16 v[116:119], a[248:251], v[196:199], v[116:119]
    v_mfma_f32_16x16x32_bf16 v[116:119], a[248:251], v[200:203], v[116:119]
    s_waitcnt lgkmcnt(6)
    v_mfma_f32_16x16x32_bf16 v[12:15], a[240:243], v[172:175], v[12:15]
    s_waitcnt lgkmcnt(4)
    v_mfma_f32_16x16x32_bf16 v[12:15], a[244:247], v[184:187], v[12:15]
    v_mfma_f32_16x16x32_bf16 v[16:19], a[240:243], v[176:179], v[16:19]
    v_mfma_f32_16x16x32_bf16 v[16:19], a[244:247], v[188:191], v[16:19]
    v_max3_f32 v204, v104, v108, v112
    v_min3_f32 v205, v104, v108, v112
    v_mfma_f32_16x16x32_bf16 v[20:23], a[240:243], v[180:183], v[20:23]
    v_max_f32 v204, v204, v116
    v_min_f32 v205, v205, v116
    v_mfma_f32_16x16x32_bf16 v[20:23], a[244:247], v[192:195], v[20:23]
    v_cmp_nle_f32 s[64:65], v204, s62
    v_cmp_nge_f32 s[82:83], v205, s61
    v_mfma_f32_16x16x32_bf16 v[100:103], a[240:243], v[196:199], v[100:103]
    ds_read_b64_tr_b16 a[240:241], v239 offset:49152
    v_mfma_f32_16x16x32_bf16 v[100:103], a[244:247], v[200:203], v[100:103]
    ds_read_b64_tr_b16 a[242:243], v239 offset:53248
    s_cmp_eq_u32 s89, 0
    s_cselect_b64 s[66:67], vcc, 0
    s_cmp_lg_u64 s[66:67], 0
    s_cbranch_scc1 L_ispin
L_ispin_ret:
    s_or_b64 s[64:65], s[64:65], s[82:83]
    s_cbranch_scc1 L_slow
    s_waitcnt lgkmcnt(4)
    v_mfma_f32_16x16x32_bf16 v[24:27], a[232:235], v[172:175], v[24:27]
    s_waitcnt lgkmcnt(2)
    ds_read_b64_tr_b16 a[244:245], v239 offset:57344
    ds_read_b64_tr_b16 a[246:247], v239 offset:61440
    v_mfma_f32_16x16x32_bf16 v[24:27], a[236:239], v[184:187], v[24:27]
    s_cmp_eq_u32 s37, 3
    v_rcp_f32 v204, v104
    v_mfma_f32_16x16x32_bf16 v[28:31], a[232:235], v[176:179], v[28:31]
    s_cselect_b32 s95, 0x40000000, 0
    v_rcp_f32 v205, v108
    v_mfma_f32_16x16x32_bf16 v[28:31], a[236:239], v[188:191], v[28:31]
    s_cmp_eq_u32 s37, 1
    v_rcp_f32 v206, v112
    v_mfma_f32_16x16x32_bf16 v[32:35], a[232:235], v[180:183], v[32:35]
    s_cselect_b32 s46, 4096, 0
    ds_read_b64_tr_b16 a[232:233], v240 offset:49152
    ds_read_b64_tr_b16 a[234:235], v240 offset:53248
    v_mfma_f32_16x16x32_bf16 v[32:35], a[236:239], v[192:195], v[32:35]
    s_waitcnt lgkmcnt(4)
    ds_read_b64_tr_b16 a[236:237], v240 offset:57344
    ds_read_b64_tr_b16 a[238:239], v240 offset:61440
    v_mfma_f32_16x16x32_bf16 v[36:39], a[240:243], v[172:175], v[36:39]
    s_waitcnt lgkmcnt(4)
    v_rcp_f32 v207, v116
    v_mfma_f32_16x16x32_bf16 v[36:39], a[244:247], v[184:187], v[36:39]
    s_add_u32 s55, s46, 24576
    buffer_load_dwordx4 v[104:107], v251, s[8:11], s95 offen offset:0 sc1
    buffer_load_dwordx4 v[108:111], v252, s[8:11], s95 offen offset:0 sc1
    v_mfma_f32_16x16x32_bf16 v[40:43], a[240:243], v[176:179], v[40:43]
    s_cmp_eq_u32 s37, 2
    buffer_load_dwordx4 v[112:115], v253, s[8:11], s95 offen offset:0 sc1
    v_mul_f32 v0, v204, v0
    v_mfma_f32_16x16x32_bf16 v[40:43], a[244:247], v[188:191], v[40:43]
    s_cselect_b32 s55, 0, s55
    v_mul_f32 v1, v204, v1
    v_mul_f32 v2, v204, v2
    v_mfma_f32_16x16x32_bf16 v[44:47], a[240:243], v[180:183], v[44:47]
    s_add_u32 s37, s37, 1
    ds_read_b64_tr_b16 a[240:241], v241 offset:49152
    ds_read_b64_tr_b16 a[242:243], v241 offset:53248
    v_mfma_f32_16x16x32_bf16 v[44:47], a[244:247], v[192:195], v[44:47]
    s_waitcnt lgkmcnt(4)
    ds_read_b64_tr_b16 a[244:245], v241 offset:57344
    ds_read_b64_tr_b16 a[246:247], v241 offset:61440
    v_mfma_f32_16x16x32_bf16 v[48:51], a[232:235], v[172:175], v[48:51]
    s_waitcnt lgkmcnt(4)
    buffer_load_dwordx4 v[116:119], v251, s[8:11], s95 offen offset:1024 sc1
    v_mul_f32 v3, v204, v3
    v_mfma_f32_16x16x32_bf16 v[48:51], a[236:239], v[184:187], v[48:51]
    s_add_u32 s40, s40, 0x20000
    buffer_load_dwordx4 v[120:123], v252, s[8:11], s95 offen offset:1024 sc1
    v_mul_f32 v12, v204, v12
    v_mfma_f32_16x16x32_bf16 v[52:55], a[232:235], v[176:179], v[52:55]
    s_mov_b32 s89, 0x1000
    v_mul_f32 v13, v204, v13
    v_mul_f32 v14, v204, v14
    v_mfma_f32_16x16x32_bf16 v[52:55], a[236:239], v[188:191], v[52:55]
    s_add_u32 s58, s58, 256
    v_mul_f32 v15, v204, v15
    v_mul_f32 v4, v205, v4
    v_mfma_f32_16x16x32_bf16 v[56:59], a[232:235], v[180:183], v[56:59]
    ds_read_b64_tr_b16 a[232:233], v242 offset:49152
    v_mul_f32 v5, v205, v5
    v_mfma_f32_16x16x32_bf16 v[56:59], a[236:239], v[192:195], v[56:59]
    s_waitcnt lgkmcnt(3)
    ds_read_b64_tr_b16 a[234:235], v242 offset:53248
    ds_read_b64_tr_b16 a[236:237], v242 offset:57344
    v_mfma_f32_16x16x32_bf16 v[60:63], a[240:243], v[172:175], v[60:63]
    s_waitcnt lgkmcnt(3)
    ds_read_b64_tr_b16 a[238:239], v242 offset:61440
    buffer_load_dwordx4 v[124:127], v253, s[8:11], s95 offen offset:1024 sc1
    v_mfma_f32_16x16x32_bf16 v[60:63], a[244:247], v[184:187], v[60:63]
    buffer_load_dwordx4 v[128:131], v251, s[8:11], s95 offen offset:2048 sc1
    v_mul_f32 v6, v205, v6
    v_mfma_f32_16x16x32_bf16 v[64:67], a[240:243], v[176:179], v[64:67]
    v_mul_f32 v7, v205, v7
    v_mul_f32 v16, v205, v16
    v_mfma_f32_16x16x32_bf16 v[64:67], a[244:247], v[188:191], v[64:67]
    v_mul_f32 v17, v205, v17
    v_mul_f32 v18, v205, v18
    v_mfma_f32_16x16x32_bf16 v[68:71], a[240:243], v[180:183], v[68:71]
    ds_read_b64_tr_b16 a[240:241], v243 offset:49152
    v_mul_f32 v19, v205, v19
    v_mfma_f32_16x16x32_bf16 v[68:71], a[244:247], v[192:195], v[68:71]
    s_waitcnt lgkmcnt(3)
    ds_read_b64_tr_b16 a[242:243], v243 offset:53248
    ds_read_b64_tr_b16 a[244:245], v243 offset:57344
    v_mfma_f32_16x16x32_bf16 v[72:75], a[232:235], v[172:175], v[72:75]
    s_waitcnt lgkmcnt(3)
    ds_read_b64_tr_b16 a[246:247], v243 offset:61440
    buffer_load_dwordx4 v[132:135], v252, s[8:11], s95 offen offset:2048 sc1
    v_mfma_f32_16x16x32_bf16 v[72:75], a[236:239], v[184:187], v[72:75]
    buffer_load_dwordx4 v[136:139], v253, s[8:11], s95 offen offset:2048 sc1
    v_mul_f32 v8, v206, v8
    v_mfma_f32_16x16x32_bf16 v[76:79], a[232:235], v[176:179], v[76:79]
    v_mul_f32 v9, v206, v9
    v_mul_f32 v10, v206, v10
    v_mfma_f32_16x16x32_bf16 v[76:79], a[236:239], v[188:191], v[76:79]
    v_mul_f32 v11, v206, v11
    v_mul_f32 v20, v206, v20
    v_mfma_f32_16x16x32_bf16 v[80:83], a[232:235], v[180:183], v[80:83]
    buffer_load_dwordx4 v[140:143], v251, s[8:11], s95 offen offset:3072 sc1
    v_mul_f32 v21, v206, v21
    v_mfma_f32_16x16x32_bf16 v[80:83], a[236:239], v[192:195], v[80:83]
    s_waitcnt lgkmcnt(2)
    v_mul_f32 v22, v206, v22
    v_mul_f32 v23, v206, v23
    v_mfma_f32_16x16x32_bf16 v[84:87], a[240:243], v[172:175], v[84:87]
    s_waitcnt lgkmcnt(0)
    v_mul_f32 v24, v204, v24
    v_mul_f32 v25, v204, v25
    v_mfma_f32_16x16x32_bf16 v[84:87], a[244:247], v[184:187], v[84:87]
    v_mul_f32 v26, v204, v26
    v_mul_f32 v27, v204, v27
    v_mfma_f32_16x16x32_bf16 v[88:91], a[240:243], v[176:179], v[88:91]
    v_mul_f32 v36, v204, v36
    v_mul_f32 v37, v204, v37
    v_mfma_f32_16x16x32_bf16 v[88:91], a[244:247], v[188:191], v[88:91]
    v_mul_f32 v38, v204, v38
    v_mul_f32 v39, v204, v39
    v_mfma_f32_16x16x32_bf16 v[92:95], a[240:243], v[180:183], v[92:95]
    v_mul_f32 v28, v205, v28
    v_mul_f32 v29, v205, v29
    v_mfma_f32_16x16x32_bf16 v[92:95], a[244:247], v[192:195], v[92:95]
    v_mul_f32 v30, v205, v30
    v_mul_f32 v31, v205, v31
    v_mul_f32 v40, v205, v40
    v_mul_f32 v41, v205, v41
    v_mul_f32 v42, v205, v42
    v_mul_f32 v43, v205, v43
    v_mul_f32 v32, v206, v32
    v_mul_f32 v33, v206, v33
    v_mul_f32 v34, v206, v34
    v_mul_f32 v35, v206, v35
    v_mul_f32 v44, v206, v44
    v_mul_f32 v45, v206, v45
    v_mul_f32 v46, v206, v46
    v_mul_f32 v47, v206, v47
    buffer_load_dwordx4 v[144:147], v252, s[8:11], s95 offen offset:3072 sc1
    v_cvt_pk_bf16_f32 v0, v0, v1
    v_cvt_pk_bf16_f32 v2, v2, v3
    v_cvt_pk_bf16_f32 v12, v12, v13
    v_cvt_pk_bf16_f32 v14, v14, v15
    v_cvt_pk_bf16_f32 v4, v4, v5
    v_cvt_pk_bf16_f32 v6, v6, v7
    v_cvt_pk_bf16_f32 v16, v16, v17
    v_cvt_pk_bf16_f32 v18, v18, v19
    v_cvt_pk_bf16_f32 v8, v8, v9
    v_cvt_pk_bf16_f32 v10, v10, v11
    v_cvt_pk_bf16_f32 v20, v20, v21
    v_cvt_pk_bf16_f32 v22, v22, v23
    v_mul_f32 v96, v207, v96
    v_mul_f32 v97, v207, v97
    v_mul_f32 v98, v207, v98
    v_mul_f32 v99, v207, v99
    v_mul_f32 v100, v207, v100
    v_mul_f32 v101, v207, v101
    v_mul_f32 v102, v207, v102
    v_mul_f32 v103, v207, v103
    v_cvt_pk_bf16_f32 v24, v24, v25
    v_cvt_pk_bf16_f32 v26, v26, v27
    v_cvt_pk_bf16_f32 v36, v36, v37
    v_cvt_pk_bf16_f32 v38, v38, v39
    v_cvt_pk_bf16_f32 v28, v28, v29
    v_cvt_pk_bf16_f32 v30, v30, v31
    v_cvt_pk_bf16_f32 v40, v40, v41
    v_cvt_pk_bf16_f32 v42, v42, v43
    v_cvt_pk_bf16_f32 v32, v32, v33
    v_cvt_pk_bf16_f32 v34, v34, v35
    v_cvt_pk_bf16_f32 v44, v44, v45
    v_cvt_pk_bf16_f32 v46, v46, v47
    buffer_load_dwordx4 v[148:151], v253, s[8:11], s95 offen offset:3072 sc1
    v_accvgpr_write_b32 a144, v0
    v_accvgpr_write_b32 a145, v2
    v_accvgpr_write_b32 a146, v12
    v_accvgpr_write_b32 a147, v14
    v_accvgpr_write_b32 a148, v4
    v_accvgpr_write_b32 a149, v6
    v_accvgpr_write_b32 a150, v16
    v_accvgpr_write_b32 a151, v18
    v_accvgpr_write_b32 a152, v8
    v_accvgpr_write_b32 a153, v10
    v_accvgpr_write_b32 a154, v20
    v_accvgpr_write_b32 a155, v22
    v_cvt_pk_bf16_f32 v208, v96, v97
    v_cvt_pk_bf16_f32 v209, v98, v99
    v_cvt_pk_bf16_f32 v210, v100, v101
    v_cvt_pk_bf16_f32 v211, v102, v103
    v_accvgpr_write_b32 a156, v24
    v_accvgpr_write_b32 a157, v26
    v_accvgpr_write_b32 a158, v36
    v_accvgpr_write_b32 a159, v38
    v_accvgpr_write_b32 a160, v28
    v_accvgpr_write_b32 a161, v30
    v_accvgpr_write_b32 a162, v40
    v_accvgpr_write_b32 a163, v42
    v_accvgpr_write_b32 a164, v32
    v_accvgpr_write_b32 a165, v34
    v_accvgpr_write_b32 a166, v44
    v_accvgpr_write_b32 a167, v46
    v_xor_b32 v236, v254, v236
    v_xor_b32 v237, v255, v237
    v_xor_b32 v238, v254, v238
    v_xor_b32 v239, v255, v239
    v_xor_b32 v240, v254, v240
    v_xor_b32 v241, v255, v241
    v_xor_b32 v242, v254, v242
    v_xor_b32 v243, v255, v243
L_head_end:
    s_cmp_lt_u32 s37, 4
    s_cbranch_scc1 L_head
    v_pk_mul_f32 v[48:49], v[48:49], v[204:205] op_sel_hi:[1,0]
    v_pk_mul_f32 v[50:51], v[50:51], v[204:205] op_sel_hi:[1,0]
    v_pk_mul_f32 v[60:61], v[60:61], v[204:205] op_sel_hi:[1,0]
    v_pk_mul_f32 v[62:63], v[62:63], v[204:205] op_sel_hi:[1,0]
    v_cvt_pk_bf16_f32 v48, v48, v49
    v_accvgpr_write_b32 a168, v48
    v_cvt_pk_bf16_f32 v50, v50, v51
    v_accvgpr_write_b32 a169, v50
    v_cvt_pk_bf16_f32 v60, v60, v61
    v_accvgpr_write_b32 a170, v60
    v_cvt_pk_bf16_f32 v62, v62, v63
    v_accvgpr_write_b32 a171, v62
    v_pk_mul_f32 v[52:53], v[52:53], v[204:205] op_sel:[0,1] op_sel_hi:[1,1]
    v_pk_mul_f32 v[54:55], v[54:55], v[204:205] op_sel:[0,1] op_sel_hi:[1,1]
    v_pk_mul_f32 v[64:65], v[64:65], v[204:205] op_sel:[0,1] op_sel_hi:[1,1]
    v_pk_mul_f32 v[66:67], v[66:67], v[204:205] op_sel:[0,1] op_sel_hi:[1,1]
    v_cvt_pk_bf16_f32 v52, v52, v53
    v_accvgpr_write_b32 a172, v52
    v_cvt_pk_bf16_f32 v54, v54, v55
    v_accvgpr_write_b32 a173, v54
    v_cvt_pk_bf16_f32 v64, v64, v65
    v_accvgpr_write_b32 a174, v64
    v_cvt_pk_bf16_f32 v66, v66, v67
    v_accvgpr_write_b32 a175, v66
    v_pk_mul_f32 v[56:57], v[56:57], v[206:207] op_sel_hi:[1,0]
    v_pk_mul_f32 v[58:59], v[58:59], v[206:207] op_sel_hi:[1,0]
    v_pk_mul_f32 v[68:69], v[68:69], v[206:207] op_sel_hi:[1,0]
    v_pk_mul_f32 v[70:71], v[70:71], v[206:207] op_sel_hi:[1,0]
    v_cvt_pk_bf16_f32 v56, v56, v57
    v_accvgpr_write_b32 a176, v56
    v_cvt_pk_bf16_f32 v58, v58, v59
    v_accvgpr_write_b32 a177, v58
    v_cvt_pk_bf16_f32 v68, v68, v69
    v_accvgpr_write_b32 a178, v68
    v_cvt_pk_bf16_f32 v70, v70, v71
    v_accvgpr_write_b32 a179, v70
    v_pk_mul_f32 v[72:73], v[72:73], v[204:205] op_sel_hi:[1,0]
    v_pk_mul_f32 v[74:75], v[74:75], v[204:205] op_sel_hi:[1,0]
    v_pk_mul_f32 v[84:85], v[84:85], v[204:205] op_sel_hi:[1,0]
    v_pk_mul_f32 v[86:87], v[86:87], v[204:205] op_sel_hi:[1,0]
    v_cvt_pk_bf16_f32 v72, v72, v73
    v_accvgpr_write_b32 a180, v72
    v_cvt_pk_bf16_f32 v74, v74, v75
    v_accvgpr_write_b32 a181, v74
    v_cvt_pk_bf16_f32 v84, v84, v85
    v_accvgpr_write_b32 a182, v84
    v_cvt_pk_bf16_f32 v86, v86, v87
    v_accvgpr_write_b32 a183, v86
    v_pk_mul_f32 v[76:77], v[76:77], v[204:205] op_sel:[0,1] op_sel_hi:[1,1]
    v_pk_mul_f32 v[78:79], v[78:79], v[204:205] op_sel:[0,1] op_sel_hi:[1,1]
    v_pk_mul_f32 v[88:89], v[88:89], v[204:205] op_sel:[0,1] op_sel_hi:[1,1]
    v_pk_mul_f32 v[90:91], v[90:91], v[204:205] op_sel:[0,1] op_sel_hi:[1,1]
    v_cvt_pk_bf16_f32 v76, v76, v77
    v_accvgpr_write_b32 a184, v76
    v_cvt_pk_bf16_f32 v78, v78, v79
    v_accvgpr_write_b32 a185, v78
    v_cvt_pk_bf16_f32 v88, v88, v89
    v_accvgpr_write_b32 a186, v88
    v_cvt_pk_bf16_f32 v90, v90, v91
    v_accvgpr_write_b32 a187, v90
    v_pk_mul_f32 v[80:81], v[80:81], v[206:207] op_sel_hi:[1,0]
    v_pk_mul_f32 v[82:83], v[82:83], v[206:207] op_sel_hi:[1,0]
    v_pk_mul_f32 v[92:93], v[92:93], v[206:207] op_sel_hi:[1,0]
    v_pk_mul_f32 v[94:95], v[94:95], v[206:207] op_sel_hi:[1,0]
    v_cvt_pk_bf16_f32 v80, v80, v81
    v_accvgpr_write_b32 a188, v80
    v_cvt_pk_bf16_f32 v82, v82, v83
    v_accvgpr_write_b32 a189, v82
    v_cvt_pk_bf16_f32 v92, v92, v93
    v_accvgpr_write_b32 a190, v92
    v_cvt_pk_bf16_f32 v94, v94, v95
    v_accvgpr_write_b32 a191, v94
    ds_write_b128 v245, v[208:211] offset:4096
    v_mov_b64 v[160:161], 0
    v_mov_b64 v[162:163], 0
    v_mov_b64 v[164:165], 0
    v_mov_b64 v[166:167], 0
    v_mov_b64 v[168:169], 0
    v_mov_b64 v[170:171], 0
    v_mov_b64 v[172:173], 0
    v_mov_b64 v[174:175], 0
    v_mov_b64 v[176:177], 0
    v_mov_b64 v[178:179], 0
    v_mov_b64 v[180:181], 0
    v_mov_b64 v[182:183], 0
    v_mov_b64 v[184:185], 0
    v_mov_b64 v[186:187], 0
    v_mov_b64 v[188:189], 0
    v_mov_b64 v[190:191], 0
    v_mov_b64 v[192:193], 0
    v_mov_b64 v[194:195], 0
    v_mov_b64 v[196:197], 0
    v_mov_b64 v[198:199], 0
    v_mov_b64 v[200:201], 0
    v_mov_b64 v[202:203], 0
    v_mov_b64 v[204:205], 0
    v_mov_b64 v[206:207], 0
    v_mov_b64 v[208:209], 0
    v_mov_b64 v[210:211], 0
    v_mov_b64 v[212:213], 0
    v_mov_b64 v[214:215], 0
    v_mov_b64 v[216:217], 0
    v_mov_b64 v[218:219], 0
    v_mov_b64 v[220:221], 0
    v_mov_b64 v[222:223], 0
    v_mov_b64 v[224:225], 0
    v_mov_b64 v[226:227], 0
    v_mov_b64 v[228:229], 0
    v_mov_b64 v[230:231], 0
    v_mov_b64 v[232:233], 0
    v_mov_b64 v[234:235], 0
    v_mov_b64 v[236:237], 0
    s_waitcnt vmcnt(3)
    v_xor_b32 v136, 0, v245
    v_xor_b32 v137, 1024, v245
    v_xor_b32 v138, 2048, v245
    v_xor_b32 v139, 3072, v245
    v_subrev_u32 v156, 131072, v244
    v_lshrrev_b32 v238, 4, v244
    v_and_b32 v238, 63, v238
    v_lshrrev_b32 v239, 4, v238
    v_lshlrev_b32 v239, 1, v239
    v_and_b32 v157, 7, v238
    v_xor_b32 v157, v157, v239
    v_lshlrev_b32 v157, 4, v157
    v_lshrrev_b32 v238, 3, v238
    v_lshl_add_u32 v157, v238, 10, v157
    v_lshrrev_b32 v238, 6, v156
    v_lshrrev_b32 v239, 1, v238
    v_and_b32 v239, 3, v239
    v_lshrrev_b32 v240, 4, v156
    v_and_b32 v240, 3, v240
    v_lshlrev_b32 v240, 3, v240
    v_lshl_add_u32 v240, v238, 7, v240
    s_xor_b32 s80, s36, 0
    v_xor_b32 v241, s80, v239
    v_lshl_add_u32 v241, v241, 5, v240
    s_xor_b32 s81, s36, 0
    s_lshl_b32 s81, s81, 12
    v_add_u32 v104, s81, v241
    v_add_u32 v120, 0x10000, v104
    s_xor_b32 s81, s36, 1
    s_lshl_b32 s81, s81, 12
    v_add_u32 v105, s81, v241
    v_add_u32 v121, 0x10000, v105
    s_xor_b32 s81, s36, 2
    s_lshl_b32 s81, s81, 12
    v_add_u32 v106, s81, v241
    v_add_u32 v122, 0x10000, v106
    s_xor_b32 s81, s36, 3
    s_lshl_b32 s81, s81, 12
    v_add_u32 v107, s81, v241
    v_add_u32 v123, 0x10000, v107
    s_xor_b32 s80, s36, 1
    v_xor_b32 v241, s80, v239
    v_lshl_add_u32 v241, v241, 5, v240
    s_xor_b32 s81, s36, 0
    s_lshl_b32 s81, s81, 12
    v_add_u32 v108, s81, v241
    v_add_u32 v124, 0x10000, v108
    s_xor_b32 s81, s36, 1
    s_lshl_b32 s81, s81, 12
    v_add_u32 v109, s81, v241
    v_add_u32 v125, 0x10000, v109
    s_xor_b32 s81, s36, 2
    s_lshl_b32 s81, s81, 12
    v_add_u32 v110, s81, v241
    v_add_u32 v126, 0x10000, v110
    s_xor_b32 s81, s36, 3
    s_lshl_b32 s81, s81, 12
    v_add_u32 v111, s81, v241
    v_add_u32 v127, 0x10000, v111
    s_xor_b32 s80, s36, 2
    v_xor_b32 v241, s80, v239
    v_lshl_add_u32 v241, v241, 5, v240
    s_xor_b32 s81, s36, 0
    s_lshl_b32 s81, s81, 12
    v_add_u32 v112, s81, v241
    v_add_u32 v128, 0x10000, v112
    s_xor_b32 s81, s36, 1
    s_lshl_b32 s81, s81, 12
    v_add_u32 v113, s81, v241
    v_add_u32 v129, 0x10000, v113
    s_xor_b32 s81, s36, 2
    s_lshl_b32 s81, s81, 12
    v_add_u32 v114, s81, v241
    v_add_u32 v130, 0x10000, v114
    s_xor_b32 s81, s36, 3
    s_lshl_b32 s81, s81, 12
    v_add_u32 v115, s81, v241
    v_add_u32 v131, 0x10000, v115
    s_xor_b32 s80, s36, 3
    v_xor_b32 v241, s80, v239
    v_lshl_add_u32 v241, v241, 5, v240
    s_xor_b32 s81, s36, 0
    s_lshl_b32 s81, s81, 12
    v_add_u32 v116, s81, v241
    v_add_u32 v132, 0x10000, v116
    s_xor_b32 s81, s36, 1
    s_lshl_b32 s81, s81, 12
    v_add_u32 v117, s81, v241
    v_add_u32 v133, 0x10000, v117
    s_xor_b32 s81, s36, 2
    s_lshl_b32 s81, s81, 12
    v_add_u32 v118, s81, v241
    v_add_u32 v134, 0x10000, v118
    s_xor_b32 s81, s36, 3
    s_lshl_b32 s81, s81, 12
    v_add_u32 v119, s81, v241
    v_add_u32 v135, 0x10000, v119
    v_lshrrev_b32 v242, 1, v156
    v_sub_u32 v248, v245, v244
    v_add_u32 v248, v248, v156
    s_lshl_b32 s80, s39, 2
    v_mov_b32 v247, s80
    v_mov_b32 v246, 0x1000
    v_cmp_eq_u32 vcc, 0, v248
    s_nop 1
    v_cndmask_b32 v246, v246, v247, vcc
    s_lshl_b32 s80, s39, 7
    v_mov_b32 v245, s80
    v_mov_b32 v247, 1
    v_and_b32 v248, 0xf0, v156
    v_lshlrev_b32 v248, 6, v248
    v_lshrrev_b32 v238, 8, v156
    v_lshl_add_u32 v248, v238, 3, v248
    s_mov_b32 s56, 0
    s_lshl_b32 s59, s36, 15
    s_mov_b32 s45, 7168
    s_waitcnt lgkmcnt(0)
    s_barrier
    s_waitcnt vmcnt(2)
    ds_read_b128 v[140:143], v136 offset:24576
    s_waitcnt vmcnt(1)
    ds_read_b128 v[144:147], v137 offset:24576
    s_waitcnt vmcnt(0)
    ds_read_b128 v[148:151], v138 offset:24576
    ds_read_b128 v[152:155], v139 offset:24576
    ds_read_b64_tr_b16 a[208:209], v104 offset:0
    ds_read_b64_tr_b16 a[210:211], v104 offset:2048
    ds_read_b64_tr_b16 a[212:213], v105 offset:0
    ds_read_b64_tr_b16 a[214:215], v105 offset:2048
    ds_read_b64_tr_b16 a[216:217], v106 offset:0
    ds_read_b64_tr_b16 a[218:219], v106 offset:2048
    ds_read_b64_tr_b16 a[220:221], v107 offset:0
    ds_read_b64_tr_b16 a[222:223], v107 offset:2048
L_pass:
    s_waitcnt lgkmcnt(6)
    v_mfma_f32_16x16x32_bf16 v[0:3], a[208:211], a[0:3], 0
    s_add_u32 s46, s39, s56
    s_add_u32 s46, s46, 1
    ds_read_b64_tr_b16 a[224:225], v120 offset:0
    s_waitcnt lgkmcnt(5)
    v_mfma_f32_16x16x32_bf16 v[0:3], a[212:215], a[12:15], v[0:3]
    s_and_b32 s46, s46, 7
    s_lshl_b32 s46, s46, 3
    ds_read_b64_tr_b16 a[226:227], v120 offset:2048
    s_waitcnt lgkmcnt(4)
    v_mfma_f32_16x16x32_bf16 v[0:3], a[216:219], a[24:27], v[0:3]
    s_add_u32 s46, s46, s39
    s_lshl_b32 s46, s46, 2
    ds_read_b64_tr_b16 a[228:229], v121 offset:0
    s_waitcnt lgkmcnt(3)
    v_mfma_f32_16x16x32_bf16 v[0:3], a[220:223], a[36:39], v[0:3]
    s_add_u32 s46, s46, s36
    s_mul_i32 s46, s46, 7168
    ds_read_b64_tr_b16 a[230:231], v121 offset:2048
    v_mfma_f32_16x16x32_bf16 v[4:7], a[208:211], a[4:7], 0
    s_cmp_lt_u32 s56, 7
    s_cselect_b32 s68, s46, 0x40000000
    ds_read_b64_tr_b16 a[232:233], v122 offset:0
    v_mfma_f32_16x16x32_bf16 v[4:7], a[212:215], a[16:19], v[4:7]
    s_add_u32 s46, s39, s56
    s_and_b32 s46, s46, 7
    ds_read_b64_tr_b16 a[234:235], v122 offset:2048
    v_mfma_f32_16x16x32_bf16 v[4:7], a[216:219], a[28:31], v[4:7]
    s_lshl_b32 s46, s46, 7
    s_cmp_ge_u32 s56, 1
    ds_read_b64_tr_b16 a[236:237], v123 offset:0
    v_mfma_f32_16x16x32_bf16 v[4:7], a[220:223], a[40:43], v[4:7]
    s_cselect_b32 s69, s46, 0x1000
    s_add_u32 s46, s39, 9
    ds_read_b64_tr_b16 a[238:239], v123 offset:2048
    v_mfma_f32_16x16x32_bf16 v[8:11], a[208:211], a[8:11], 0
    s_sub_u32 s46, s46, s56
    s_and_b32 s46, s46, 7
    s_waitcnt vmcnt(14)
    v_lshlrev_b32 v238, 16, v212
    v_mfma_f32_16x16x32_bf16 v[8:11], a[212:215], a[20:23], v[8:11]
    s_lshl_b32 s57, s46, 2
    s_lshl_b32 s76, s39, 3
    buffer_load_dword v244, v245, s[0:3], s57 offen sc1
    v_mfma_f32_16x16x32_bf16 v[8:11], a[216:219], a[32:35], v[8:11]
    s_add_u32 s76, s76, s46
    s_lshl_b32 s76, s76, 2
    v_and_b32 v239, 0xffff0000, v212
    v_mfma_f32_16x16x32_bf16 v[8:11], a[220:223], a[44:47], v[8:11]
    s_add_u32 s76, s76, s36
    s_mul_i32 s76, s76, 7168
    v_lshlrev_b32 v240, 16, v213
    v_mfma_f32_16x16x32_bf16 v[48:51], a[208:211], v[140:143], 0
    s_cmp_ge_u32 s56, 2
    s_cselect_b32 s76, s76, 0x40000000
    ds_read_b128 v[140:143], v136 offset:28672
    v_mfma_f32_16x16x32_bf16 v[48:51], a[212:215], v[144:147], v[48:51]
    s_cselect_b32 s79, 1, 0
    s_add_u32 s77, s39, s56
    ds_read_b128 v[144:147], v137 offset:28672
    v_mfma_f32_16x16x32_bf16 v[48:51], a[216:219], v[148:151], v[48:51]
    s_add_u32 s77, s77, 2
    s_and_b32 s77, s77, 7
    ds_read_b128 v[148:151], v138 offset:28672
    v_mfma_f32_16x16x32_bf16 v[48:51], a[220:223], v[152:155], v[48:51]
    s_waitcnt lgkmcnt(9)
    s_lshl_b32 s77, s77, 7
    ds_read_b128 v[152:155], v139 offset:28672
    v_mfma_f32_16x16x32_bf16 v[0:3], a[224:227], a[48:51], v[0:3]
    s_waitcnt lgkmcnt(8)
    s_add_u32 s77, s77, s59
    ds_read_b64_tr_b16 a[208:209], v108 offset:0
    v_mfma_f32_16x16x32_bf16 v[0:3], a[228:231], a[60:63], v[0:3]
    s_waitcnt lgkmcnt(7)
    s_cmp_lt_u32 s56, 7
    ds_read_b64_tr_b16 a[210:211], v108 offset:2048
    v_mfma_f32_16x16x32_bf16 v[0:3], a[232:235], a[72:75], v[0:3]
    s_waitcnt lgkmcnt(6)
    s_cselect_b32 s77, s77, 0x40000000
    ds_read_b64_tr_b16 a[212:213], v109 offset:0
    v_mfma_f32_16x16x32_bf16 v[0:3], a[236:239], a[84:87], v[0:3]
    s_add_u32 s100, s39, s56
    s_add_u32 s100, s100, 3
    ds_read_b64_tr_b16 a[214:215], v109 offset:2048
    v_mfma_f32_16x16x32_bf16 v[4:7], a[224:227], a[52:55], v[4:7]
    s_and_b32 s100, s100, 7
    s_lshl_b32 s100, s100, 7
    ds_read_b64_tr_b16 a[216:217], v110 offset:0
    v_mfma_f32_16x16x32_bf16 v[4:7], a[228:231], a[64:67], v[4:7]
    s_add_u32 s100, s100, s59
    s_cmp_lt_u32 s56, 6
    ds_read_b64_tr_b16 a[218:219], v110 offset:2048
    v_mfma_f32_16x16x32_bf16 v[4:7], a[232:235], a[76:79], v[4:7]
    s_cselect_b32 s100, s100, 0x40000000
    s_add_u32 s46, s77, 262144
    ds_read_b64_tr_b16 a[220:221], v111 offset:0
    v_mfma_f32_16x16x32_bf16 v[4:7], a[236:239], a[88:91], v[4:7]
    s_add_u32 m0, s41, 49152
    s_add_u32 s47, s46, s45
    buffer_load_dwordx4 v157, s[16:19], s46 offen offset:0 lds
    v_mfma_f32_16x16x32_bf16 v[8:11], a[224:227], a[56:59], v[8:11]
    s_add_u32 s48, s47, s45
    buffer_load_dwordx4 v157, s[16:19], s47 offen offset:1024 lds
    buffer_load_dwordx4 v157, s[16:19], s48 offen offset:2048 lds
    v_mfma_f32_16x16x32_bf16 v[8:11], a[228:231], a[68:71], v[8:11]
    s_add_u32 s49, s48, s45
    buffer_load_dwordx4 v157, s[16:19], s49 offen offset:3072 lds
    v_and_b32 v241, 0xffff0000, v213
    v_mfma_f32_16x16x32_bf16 v[8:11], a[232:235], a[80:83], v[8:11]
    ds_read_b64_tr_b16 a[222:223], v111 offset:2048
    v_add_f32 v160, v160, v238
    v_mfma_f32_16x16x32_bf16 v[8:11], a[236:239], a[92:95], v[8:11]
    s_waitcnt lgkmcnt(11)
    s_add_u32 s46, s77, 393216
    v_add_f32 v161, v161, v239
    v_mfma_f32_16x16x32_bf16 v[48:51], a[224:227], v[140:143], v[48:51]
    s_waitcnt lgkmcnt(10)
    s_add_u32 m0, s41, 114688
    ds_read_b64_tr_b16 a[224:225], v124 offset:0
    v_mfma_f32_16x16x32_bf16 v[48:51], a[228:231], v[144:147], v[48:51]
    s_waitcnt lgkmcnt(10)
    buffer_load_dwordx4 v157, s[16:19], s46 offen offset:0 lds
    v_add_f32 v162, v162, v240
    v_mfma_f32_16x16x32_bf16 v[48:51], a[232:235], v[148:151], v[48:51]
    s_waitcnt lgkmcnt(9)
    ds_read_b64_tr_b16 a[226:227], v124 offset:2048
    v_add_f32 v163, v163, v241
    v_mfma_f32_16x16x32_bf16 v[48:51], a[236:239], v[152:155], v[48:51]
    s_waitcnt lgkmcnt(8)
    s_add_u32 s47, s46, s45
    ds_read_b64_tr_b16 a[228:229], v125 offset:0
    v_mfma_f32_16x16x32_bf16 v[12:15], a[208:211], a[0:3], 0
    s_waitcnt lgkmcnt(7)
    buffer_load_dwordx4 v157, s[16:19], s47 offen offset:1024 lds
    v_lshlrev_b32 v238, 16, v214
    v_mfma_f32_16x16x32_bf16 v[12:15], a[212:215], a[12:15], v[12:15]
    s_waitcnt lgkmcnt(5)
    ds_read_b64_tr_b16 a[230:231], v125 offset:2048
    v_and_b32 v239, 0xffff0000, v214
    v_mfma_f32_16x16x32_bf16 v[12:15], a[216:219], a[24:27], v[12:15]
    s_waitcnt lgkmcnt(4)
    ds_read_b64_tr_b16 a[232:233], v126 offset:0
    v_lshlrev_b32 v240, 16, v215
    v_mfma_f32_16x16x32_bf16 v[12:15], a[220:223], a[36:39], v[12:15]
    s_add_u32 s48, s47, s45
    ds_read_b64_tr_b16 a[234:235], v126 offset:2048
    v_and_b32 v241, 0xffff0000, v215
    v_mfma_f32_16x16x32_bf16 v[16:19], a[208:211], a[4:7], 0
    ds_read_b64_tr_b16 a[236:237], v127 offset:0
    v_add_f32 v164, v164, v238
    v_mfma_f32_16x16x32_bf16 v[16:19], a[212:215], a[16:19], v[16:19]
    ds_read_b64_tr_b16 a[238:239], v127 offset:2048
    v_add_f32 v165, v165, v239
    v_mfma_f32_16x16x32_bf16 v[16:19], a[216:219], a[28:31], v[16:19]
    buffer_load_dwordx4 v157, s[16:19], s48 offen offset:2048 lds
    v_add_f32 v166, v166, v240
    v_mfma_f32_16x16x32_bf16 v[16:19], a[220:223], a[40:43], v[16:19]
    s_add_u32 s49, s48, s45
    buffer_load_dwordx4 v157, s[16:19], s49 offen offset:3072 lds
    v_add_f32 v167, v167, v241
    v_mfma_f32_16x16x32_bf16 v[20:23], a[208:211], a[8:11], 0
    ds_read_b64_tr_b16 a[208:209], v112 offset:0
    s_waitcnt vmcnt(22)
    v_lshlrev_b32 v238, 16, v216
    v_mfma_f32_16x16x32_bf16 v[20:23], a[212:215], a[20:23], v[20:23]
    ds_read_b64_tr_b16 a[210:211], v112 offset:2048
    v_and_b32 v239, 0xffff0000, v216
    v_mfma_f32_16x16x32_bf16 v[20:23], a[216:219], a[32:35], v[20:23]
    ds_read_b64_tr_b16 a[212:213], v113 offset:0
    v_lshlrev_b32 v240, 16, v217
    v_mfma_f32_16x16x32_bf16 v[20:23], a[220:223], a[44:47], v[20:23]
    s_waitcnt lgkmcnt(9)
    ds_read_b64_tr_b16 a[214:215], v113 offset:2048
    v_and_b32 v241, 0xffff0000, v217
    v_mfma_f32_16x16x32_bf16 v[12:15], a[224:227], a[48:51], v[12:15]
    s_waitcnt lgkmcnt(8)
    ds_read_b64_tr_b16 a[216:217], v114 offset:0
    v_add_f32 v168, v168, v238
    v_mfma_f32_16x16x32_bf16 v[12:15], a[228:231], a[60:63], v[12:15]
    s_waitcnt lgkmcnt(7)
    ds_read_b64_tr_b16 a[218:219], v114 offset:2048
    v_add_f32 v169, v169, v239
    v_mfma_f32_16x16x32_bf16 v[12:15], a[232:235], a[72:75], v[12:15]
    s_waitcnt lgkmcnt(6)
    ds_read_b64_tr_b16 a[220:221], v115 offset:0
    v_add_f32 v170, v170, v240
    v_mfma_f32_16x16x32_bf16 v[12:15], a[236:239], a[84:87], v[12:15]
    ds_read_b64_tr_b16 a[222:223], v115 offset:2048
    v_add_f32 v171, v171, v241
    v_mfma_f32_16x16x32_bf16 v[16:19], a[224:227], a[52:55], v[16:19]
    ds_read_b128 v[140:143], v136 offset:0
    v_lshlrev_b32 v238, 16, v218
    v_mfma_f32_16x16x32_bf16 v[16:19], a[228:231], a[64:67], v[16:19]
    ds_read_b128 v[144:147], v137 offset:0
    v_and_b32 v239, 0xffff0000, v218
    v_mfma_f32_16x16x32_bf16 v[16:19], a[232:235], a[76:79], v[16:19]
    ds_read_b128 v[148:151], v138 offset:0
    v_lshlrev_b32 v240, 16, v219
    v_mfma_f32_16x16x32_bf16 v[16:19], a[236:239], a[88:91], v[16:19]
    ds_read_b128 v[152:155], v139 offset:0
    v_and_b32 v241, 0xffff0000, v219
    v_mfma_f32_16x16x32_bf16 v[20:23], a[224:227], a[56:59], v[20:23]
    ds_read_b64_tr_b16 a[224:225], v128 offset:0
    v_add_f32 v172, v172, v238
    v_mfma_f32_16x16x32_bf16 v[20:23], a[228:231], a[68:71], v[20:23]
    ds_read_b64_tr_b16 a[226:227], v128 offset:2048
    v_add_f32 v173, v173, v239
    v_mfma_f32_16x16x32_bf16 v[20:23], a[232:235], a[80:83], v[20:23]
    v_add_f32 v174, v174, v240
    v_add_f32 v175, v175, v241
    v_mfma_f32_16x16x32_bf16 v[20:23], a[236:239], a[92:95], v[20:23]
    s_waitcnt lgkmcnt(12)
    ds_read_b64_tr_b16 a[228:229], v129 offset:0
    s_waitcnt vmcnt(21)
    v_lshlrev_b32 v238, 16, v220
    v_mfma_f32_16x16x32_bf16 v[24:27], a[208:211], a[0:3], 0
    s_waitcnt lgkmcnt(11)
    ds_read_b64_tr_b16 a[230:231], v129 offset:2048
    v_and_b32 v239, 0xffff0000, v220
    v_mfma_f32_16x16x32_bf16 v[24:27], a[212:215], a[12:15], v[24:27]
    s_waitcnt lgkmcnt(10)
    ds_read_b64_tr_b16 a[232:233], v130 offset:0
    v_lshlrev_b32 v240, 16, v221
    v_mfma_f32_16x16x32_bf16 v[24:27], a[216:219], a[24:27], v[24:27]
    s_waitcnt lgkmcnt(9)
    ds_read_b64_tr_b16 a[234:235], v130 offset:2048
    v_and_b32 v241, 0xffff0000, v221
    v_mfma_f32_16x16x32_bf16 v[24:27], a[220:223], a[36:39], v[24:27]
    ds_read_b64_tr_b16 a[236:237], v131 offset:0
    v_add_f32 v176, v176, v238
    v_mfma_f32_16x16x32_bf16 v[28:31], a[208:211], a[4:7], 0
    ds_read_b64_tr_b16 a[238:239], v131 offset:2048
    v_add_f32 v177, v177, v239
    v_mfma_f32_16x16x32_bf16 v[28:31], a[212:215], a[16:19], v[28:31]
    v_add_f32 v178, v178, v240
    v_add_f32 v179, v179, v241
    v_mfma_f32_16x16x32_bf16 v[28:31], a[216:219], a[28:31], v[28:31]
    v_lshlrev_b32 v238, 16, v222
    v_and_b32 v239, 0xffff0000, v222
    v_mfma_f32_16x16x32_bf16 v[28:31], a[220:223], a[40:43], v[28:31]
    v_lshlrev_b32 v240, 16, v223
    v_and_b32 v241, 0xffff0000, v223
    v_mfma_f32_16x16x32_bf16 v[32:35], a[208:211], a[8:11], 0
    ds_read_b64_tr_b16 a[208:209], v116 offset:0
    v_add_f32 v180, v180, v238
    v_mfma_f32_16x16x32_bf16 v[32:35], a[212:215], a[20:23], v[32:35]
    ds_read_b64_tr_b16 a[210:211], v116 offset:2048
    s_waitcnt vmcnt(8)
    v_cmp_le_u32 vcc, s79, v244
    v_mfma_f32_16x16x32_bf16 v[32:35], a[216:219], a[32:35], v[32:35]
    v_add_f32 v181, v181, v239
    v_add_f32 v182, v182, v240
    v_mfma_f32_16x16x32_bf16 v[32:35], a[220:223], a[44:47], v[32:35]
    s_waitcnt lgkmcnt(8)
    ds_read_b64_tr_b16 a[212:213], v117 offset:0
    v_add_f32 v183, v183, v241
    v_mfma_f32_16x16x32_bf16 v[24:27], a[224:227], a[48:51], v[24:27]
    s_waitcnt lgkmcnt(7)
    ds_read_b64_tr_b16 a[214:215], v117 offset:2048
    v_lshlrev_b32 v238, 16, v224
    v_mfma_f32_16x16x32_bf16 v[24:27], a[228:231], a[60:63], v[24:27]
    s_waitcnt lgkmcnt(6)
    ds_read_b64_tr_b16 a[216:217], v118 offset:0
    v_and_b32 v239, 0xffff0000, v224
    v_mfma_f32_16x16x32_bf16 v[24:27], a[232:235], a[72:75], v[24:27]
    s_waitcnt lgkmcnt(5)
    ds_read_b64_tr_b16 a[218:219], v118 offset:2048
    v_lshlrev_b32 v240, 16, v225
    v_mfma_f32_16x16x32_bf16 v[24:27], a[236:239], a[84:87], v[24:27]
    ds_read_b64_tr_b16 a[220:221], v119 offset:0
    v_and_b32 v241, 0xffff0000, v225
    v_mfma_f32_16x16x32_bf16 v[28:31], a[224:227], a[52:55], v[28:31]
    ds_read_b64_tr_b16 a[222:223], v119 offset:2048
    v_add_f32 v184, v184, v238
    v_mfma_f32_16x16x32_bf16 v[28:31], a[228:231], a[64:67], v[28:31]
    v_add_f32 v185, v185, v239
    v_add_f32 v186, v186, v240
    v_mfma_f32_16x16x32_bf16 v[28:31], a[232:235], a[76:79], v[28:31]
    v_add_f32 v187, v187, v241
    v_lshlrev_b32 v238, 16, v226
    v_mfma_f32_16x16x32_bf16 v[28:31], a[236:239], a[88:91], v[28:31]
    v_and_b32 v239, 0xffff0000, v226
    v_lshlrev_b32 v240, 16, v227
    v_mfma_f32_16x16x32_bf16 v[32:35], a[224:227], a[56:59], v[32:35]
    ds_read_b64_tr_b16 a[224:225], v132 offset:0
    v_and_b32 v241, 0xffff0000, v227
    v_mfma_f32_16x16x32_bf16 v[32:35], a[228:231], a[68:71], v[32:35]
    ds_read_b64_tr_b16 a[226:227], v132 offset:2048
    v_add_f32 v188, v188, v238
    v_mfma_f32_16x16x32_bf16 v[32:35], a[232:235], a[80:83], v[32:35]
    ds_read_b64_tr_b16 a[228:229], v133 offset:0
    v_add_f32 v189, v189, v239
    v_mfma_f32_16x16x32_bf16 v[32:35], a[236:239], a[92:95], v[32:35]
    s_waitcnt lgkmcnt(9)
    ds_read_b64_tr_b16 a[230:231], v133 offset:2048
    v_add_f32 v190, v190, v240
    v_mfma_f32_16x16x32_bf16 v[36:39], a[208:211], a[0:3], 0
    s_waitcnt lgkmcnt(8)
    ds_read_b64_tr_b16 a[232:233], v134 offset:0
    v_add_f32 v191, v191, v241
    v_mfma_f32_16x16x32_bf16 v[36:39], a[212:215], a[12:15], v[36:39]
    s_waitcnt lgkmcnt(7)
    ds_read_b64_tr_b16 a[234:235], v134 offset:2048
    v_lshlrev_b32 v238, 16, v228
    v_mfma_f32_16x16x32_bf16 v[36:39], a[216:219], a[24:27], v[36:39]
    s_waitcnt lgkmcnt(6)
    ds_read_b64_tr_b16 a[236:237], v135 offset:0
    v_and_b32 v239, 0xffff0000, v228
    v_mfma_f32_16x16x32_bf16 v[36:39], a[220:223], a[36:39], v[36:39]
    ds_read_b64_tr_b16 a[238:239], v135 offset:2048
    v_lshlrev_b32 v240, 16, v229
    v_mfma_f32_16x16x32_bf16 v[40:43], a[208:211], a[4:7], 0
    v_and_b32 v241, 0xffff0000, v229
    v_add_f32 v192, v192, v238
    v_mfma_f32_16x16x32_bf16 v[40:43], a[212:215], a[16:19], v[40:43]
    v_add_f32 v193, v193, v239
    v_add_f32 v194, v194, v240
    v_mfma_f32_16x16x32_bf16 v[40:43], a[216:219], a[28:31], v[40:43]
    v_add_f32 v195, v195, v241
    v_lshlrev_b32 v238, 16, v230
    v_mfma_f32_16x16x32_bf16 v[40:43], a[220:223], a[40:43], v[40:43]
    v_and_b32 v239, 0xffff0000, v230
    v_lshlrev_b32 v240, 16, v231
    v_mfma_f32_16x16x32_bf16 v[44:47], a[208:211], a[8:11], 0
    v_and_b32 v241, 0xffff0000, v231
    v_add_f32 v196, v196, v238
    v_mfma_f32_16x16x32_bf16 v[44:47], a[212:215], a[20:23], v[44:47]
    v_add_f32 v197, v197, v239
    v_add_f32 v198, v198, v240
    v_mfma_f32_16x16x32_bf16 v[44:47], a[216:219], a[32:35], v[44:47]
    v_add_f32 v199, v199, v241
    v_lshlrev_b32 v238, 16, v232
    v_mfma_f32_16x16x32_bf16 v[44:47], a[220:223], a[44:47], v[44:47]
    s_waitcnt lgkmcnt(0)
    v_and_b32 v239, 0xffff0000, v232
    v_lshlrev_b32 v240, 16, v233
    s_barrier
    v_mfma_f32_16x16x32_bf16 v[36:39], a[224:227], a[48:51], v[36:39]
    ds_read_b64_tr_b16 a[208:209], v104 offset:16384
    v_and_b32 v241, 0xffff0000, v233
    v_mfma_f32_16x16x32_bf16 v[36:39], a[228:231], a[60:63], v[36:39]
    ds_read_b64_tr_b16 a[210:211], v104 offset:18432
    v_add_f32 v200, v200, v238
    v_mfma_f32_16x16x32_bf16 v[36:39], a[232:235], a[72:75], v[36:39]
    ds_read_b64_tr_b16 a[212:213], v105 offset:16384
    v_add_f32 v201, v201, v239
    v_mfma_f32_16x16x32_bf16 v[36:39], a[236:239], a[84:87], v[36:39]
    ds_read_b64_tr_b16 a[214:215], v105 offset:18432
    v_add_f32 v202, v202, v240
    v_mfma_f32_16x16x32_bf16 v[40:43], a[224:227], a[52:55], v[40:43]
    ds_read_b64_tr_b16 a[216:217], v106 offset:16384
    v_add_f32 v203, v203, v241
    v_mfma_f32_16x16x32_bf16 v[40:43], a[228:231], a[64:67], v[40:43]
    ds_read_b64_tr_b16 a[218:219], v106 offset:18432
    v_lshlrev_b32 v238, 16, v234
    v_mfma_f32_16x16x32_bf16 v[40:43], a[232:235], a[76:79], v[40:43]
    ds_read_b64_tr_b16 a[220:221], v107 offset:16384
    v_and_b32 v239, 0xffff0000, v234
    v_mfma_f32_16x16x32_bf16 v[40:43], a[236:239], a[88:91], v[40:43]
    ds_read_b64_tr_b16 a[222:223], v107 offset:18432
    v_lshlrev_b32 v240, 16, v235
    v_mfma_f32_16x16x32_bf16 v[44:47], a[224:227], a[56:59], v[44:47]
    buffer_store_dword v247, v246, s[0:3], s69 offen offset:0 sc1
    v_mfma_f32_16x16x32_bf16 v[44:47], a[228:231], a[68:71], v[44:47]
    ds_read_b64_tr_b16 a[224:225], v120 offset:16384
    v_and_b32 v241, 0xffff0000, v235
    v_mfma_f32_16x16x32_bf16 v[44:47], a[232:235], a[80:83], v[44:47]
    ds_read_b64_tr_b16 a[226:227], v120 offset:18432
    v_add_f32 v204, v204, v238
    v_mfma_f32_16x16x32_bf16 v[44:47], a[236:239], a[92:95], v[44:47]
    ds_read_b64_tr_b16 a[228:229], v121 offset:16384
    v_add_f32 v205, v205, v239
    s_cmp_eq_u64 vcc, -1
    s_cbranch_scc0 L_spin0
L_spin0_ret:
    s_waitcnt lgkmcnt(9)
    v_mfma_f32_16x16x32_bf16 v[0:3], a[208:211], a[96:99], v[0:3]
    s_waitcnt lgkmcnt(7)
    ds_read_b64_tr_b16 a[230:231], v121 offset:18432
    v_add_f32 v206, v206, v240
    v_mfma_f32_16x16x32_bf16 v[0:3], a[212:215], a[108:111], v[0:3]
    s_waitcnt lgkmcnt(6)
    s_add_u32 s46, s100, 0
    ds_read_b64_tr_b16 a[232:233], v122 offset:16384
    v_mfma_f32_16x16x32_bf16 v[0:3], a[216:219], a[120:123], v[0:3]
    s_waitcnt lgkmcnt(5)
    s_add_u32 m0, s41, 0
    ds_read_b64_tr_b16 a[234:235], v122 offset:18432
    v_mfma_f32_16x16x32_bf16 v[0:3], a[220:223], a[132:135], v[0:3]
    buffer_load_dwordx4 v157, s[16:19], s46 offen offset:0 lds
    v_add_f32 v207, v207, v241
    v_mfma_f32_16x16x32_bf16 v[4:7], a[208:211], a[100:103], v[4:7]
    s_add_u32 s47, s46, s45
    buffer_load_dwordx4 v157, s[16:19], s47 offen offset:1024 lds
    v_lshlrev_b32 v238, 16, v236
    v_mfma_f32_16x16x32_bf16 v[4:7], a[212:215], a[112:115], v[4:7]
    ds_read_b64_tr_b16 a[236:237], v123 offset:16384
    v_and_b32 v239, 0xffff0000, v236
    v_mfma_f32_16x16x32_bf16 v[4:7], a[216:219], a[124:127], v[4:7]
    ds_read_b64_tr_b16 a[238:239], v123 offset:18432
    v_lshlrev_b32 v240, 16, v237
    v_mfma_f32_16x16x32_bf16 v[4:7], a[220:223], a[136:139], v[4:7]
    s_add_u32 s48, s47, s45
    buffer_load_dwordx4 v157, s[16:19], s48 offen offset:2048 lds
    v_and_b32 v241, 0xffff0000, v237
    v_mfma_f32_16x16x32_bf16 v[8:11], a[208:211], a[104:107], v[8:11]
    v_add_f32 v208, v208, v238
    v_add_f32 v209, v209, v239
    v_mfma_f32_16x16x32_bf16 v[8:11], a[212:215], a[116:119], v[8:11]
    v_add_f32 v210, v210, v240
    v_add_f32 v211, v211, v241
    v_mfma_f32_16x16x32_bf16 v[8:11], a[216:219], a[128:131], v[8:11]
    s_add_u32 s49, s48, s45
    buffer_load_dwordx4 v157, s[16:19], s49 offen offset:3072 lds
    v_mfma_f32_16x16x32_bf16 v[8:11], a[220:223], a[140:143], v[8:11]
    v_mfma_f32_16x16x32_bf16 v[48:51], a[208:211], v[140:143], v[48:51]
    ds_read_b128 v[140:143], v136 offset:4096
    v_mfma_f32_16x16x32_bf16 v[48:51], a[212:215], v[144:147], v[48:51]
    ds_read_b128 v[144:147], v137 offset:4096
    v_mfma_f32_16x16x32_bf16 v[48:51], a[216:219], v[148:151], v[48:51]
    ds_read_b128 v[148:151], v138 offset:4096
    v_mfma_f32_16x16x32_bf16 v[48:51], a[220:223], v[152:155], v[48:51]
    s_waitcnt lgkmcnt(9)
    s_add_u32 s46, s100, 131072
    ds_read_b128 v[152:155], v139 offset:4096
    v_mfma_f32_16x16x32_bf16 v[0:3], a[224:227], a[144:147], v[0:3]
    s_waitcnt lgkmcnt(8)
    s_add_u32 m0, s41, 65536
    ds_read_b64_tr_b16 a[208:209], v108 offset:16384
    v_mfma_f32_16x16x32_bf16 v[0:3], a[228:231], a[156:159], v[0:3]
    s_waitcnt lgkmcnt(7)
    buffer_load_dwordx4 v157, s[16:19], s46 offen offset:0 lds
    v_mfma_f32_16x16x32_bf16 v[0:3], a[232:235], a[168:171], v[0:3]
    s_waitcnt lgkmcnt(5)
    s_add_u32 s47, s46, s45
    ds_read_b64_tr_b16 a[210:211], v108 offset:18432
    v_mfma_f32_16x16x32_bf16 v[0:3], a[236:239], a[180:183], v[0:3]
    buffer_load_dwordx4 v157, s[16:19], s47 offen offset:1024 lds
    v_mfma_f32_16x16x32_bf16 v[4:7], a[224:227], a[148:151], v[4:7]
    ds_read_b64_tr_b16 a[212:213], v109 offset:16384
    v_mfma_f32_16x16x32_bf16 v[4:7], a[228:231], a[160:163], v[4:7]
    s_add_u32 s48, s47, s45
    ds_read_b64_tr_b16 a[214:215], v109 offset:18432
    v_mfma_f32_16x16x32_bf16 v[4:7], a[232:235], a[172:175], v[4:7]
    buffer_load_dwordx4 v157, s[16:19], s48 offen offset:2048 lds
    v_cvt_pk_bf16_f32 v52, v0, v1
    v_mfma_f32_16x16x32_bf16 v[4:7], a[236:239], a[184:187], v[4:7]
    ds_read_b64_tr_b16 a[216:217], v110 offset:16384
    v_cvt_pk_bf16_f32 v53, v2, v3
    v_mfma_f32_16x16x32_bf16 v[8:11], a[224:227], a[152:155], v[8:11]
    s_add_u32 s49, s48, s45
    ds_read_b64_tr_b16 a[218:219], v110 offset:18432
    v_mfma_f32_16x16x32_bf16 v[8:11], a[228:231], a[164:167], v[8:11]
    ds_read_b64_tr_b16 a[220:221], v111 offset:16384
    v_mfma_f32_16x16x32_bf16 v[8:11], a[232:235], a[176:179], v[8:11]
    ds_read_b64_tr_b16 a[222:223], v111 offset:18432
    v_cvt_pk_bf16_f32 v56, v4, v5
    v_mfma_f32_16x16x32_bf16 v[8:11], a[236:239], a[188:191], v[8:11]
    s_waitcnt lgkmcnt(11)
    buffer_load_dwordx4 v157, s[16:19], s49 offen offset:3072 lds
    v_cvt_pk_bf16_f32 v57, v6, v7
    v_mfma_f32_16x16x32_bf16 v[48:51], a[224:227], v[140:143], v[48:51]
    s_waitcnt lgkmcnt(10)
    ds_read_b64_tr_b16 a[224:225], v124 offset:16384
    v_mfma_f32_16x16x32_bf16 v[48:51], a[228:231], v[144:147], v[48:51]
    s_waitcnt lgkmcnt(10)
    buffer_load_dwordx4 v[212:215], v156, s[28:31], s76 offen offset:0 sc1
    v_cvt_pk_bf16_f32 v60, v8, v9
    v_mfma_f32_16x16x32_bf16 v[48:51], a[232:235], v[148:151], v[48:51]
    s_waitcnt lgkmcnt(9)
    ds_read_b64_tr_b16 a[226:227], v124 offset:18432
    v_cvt_pk_bf16_f32 v61, v10, v11
    v_mfma_f32_16x16x32_bf16 v[48:51], a[236:239], v[152:155], v[48:51]
    s_waitcnt lgkmcnt(8)
    ds_read_b64_tr_b16 a[228:229], v125 offset:16384
    v_mfma_f32_16x16x32_bf16 v[12:15], a[208:211], a[96:99], v[12:15]
    s_waitcnt lgkmcnt(7)
    ds_read_b64_tr_b16 a[230:231], v125 offset:18432
    v_mfma_f32_16x16x32_bf16 v[12:15], a[212:215], a[108:111], v[12:15]
    s_waitcnt lgkmcnt(6)
    ds_read_b64_tr_b16 a[232:233], v126 offset:16384
    v_cvt_pk_bf16_f32 v76, v48, v49
    v_mfma_f32_16x16x32_bf16 v[12:15], a[216:219], a[120:123], v[12:15]
    s_waitcnt lgkmcnt(5)
    ds_read_b64_tr_b16 a[234:235], v126 offset:18432
    v_cvt_pk_bf16_f32 v77, v50, v51
    v_mfma_f32_16x16x32_bf16 v[12:15], a[220:223], a[132:135], v[12:15]
    ds_read_b64_tr_b16 a[236:237], v127 offset:16384
    v_mfma_f32_16x16x32_bf16 v[16:19], a[208:211], a[100:103], v[16:19]
    ds_read_b64_tr_b16 a[238:239], v127 offset:18432
    v_mfma_f32_16x16x32_bf16 v[16:19], a[212:215], a[112:115], v[16:19]
    ds_read_b128 v[140:143], v136 offset:24576
    v_mfma_f32_16x16x32_bf16 v[16:19], a[216:219], a[124:127], v[16:19]
    ds_read_b128 v[144:147], v137 offset:24576
    v_mfma_f32_16x16x32_bf16 v[16:19], a[220:223], a[136:139], v[16:19]
    buffer_load_dwordx4 v[216:219], v156, s[28:31], s76 offen offset:1024 sc1
    v_mfma_f32_16x16x32_bf16 v[20:23], a[208:211], a[104:107], v[20:23]
    ds_read_b64_tr_b16 a[208:209], v112 offset:16384
    v_mfma_f32_16x16x32_bf16 v[20:23], a[212:215], a[116:119], v[20:23]
    ds_read_b64_tr_b16 a[210:211], v112 offset:18432
    v_mfma_f32_16x16x32_bf16 v[20:23], a[216:219], a[128:131], v[20:23]
    ds_read_b64_tr_b16 a[212:213], v113 offset:16384
    v_mfma_f32_16x16x32_bf16 v[20:23], a[220:223], a[140:143], v[20:23]
    s_waitcnt lgkmcnt(11)
    ds_read_b64_tr_b16 a[214:215], v113 offset:18432
    v_mfma_f32_16x16x32_bf16 v[12:15], a[224:227], a[144:147], v[12:15]
    s_waitcnt lgkmcnt(10)
    ds_read_b64_tr_b16 a[216:217], v114 offset:16384
    v_mfma_f32_16x16x32_bf16 v[12:15], a[228:231], a[156:159], v[12:15]
    s_waitcnt lgkmcnt(9)
    ds_read_b64_tr_b16 a[218:219], v114 offset:18432
    v_mfma_f32_16x16x32_bf16 v[12:15], a[232:235], a[168:171], v[12:15]
    s_waitcnt lgkmcnt(8)
    ds_read_b64_tr_b16 a[220:221], v115 offset:16384
    v_mfma_f32_16x16x32_bf16 v[12:15], a[236:239], a[180:183], v[12:15]
    ds_read_b64_tr_b16 a[222:223], v115 offset:18432
    v_mfma_f32_16x16x32_bf16 v[16:19], a[224:227], a[148:151], v[16:19]
    ds_read_b128 v[148:151], v138 offset:24576
    v_mfma_f32_16x16x32_bf16 v[16:19], a[228:231], a[160:163], v[16:19]
    buffer_load_dwordx4 v[220:223], v156, s[28:31], s76 offen offset:2048 sc1
    v_mfma_f32_16x16x32_bf16 v[16:19], a[232:235], a[172:175], v[16:19]
    ds_read_b128 v[152:155], v139 offset:24576
    v_mfma_f32_16x16x32_bf16 v[16:19], a[236:239], a[184:187], v[16:19]
    v_cvt_pk_bf16_f32 v54, v12, v13
    v_cvt_pk_bf16_f32 v55, v14, v15
    v_mfma_f32_16x16x32_bf16 v[20:23], a[224:227], a[152:155], v[20:23]
    ds_read_b64_tr_b16 a[224:225], v128 offset:16384
    v_mfma_f32_16x16x32_bf16 v[20:23], a[228:231], a[164:167], v[20:23]
    ds_read_b64_tr_b16 a[226:227], v128 offset:18432
    v_mfma_f32_16x16x32_bf16 v[20:23], a[232:235], a[176:179], v[20:23]
    v_mfma_f32_16x16x32_bf16 v[20:23], a[236:239], a[188:191], v[20:23]
    s_waitcnt lgkmcnt(10)
    ds_read_b64_tr_b16 a[228:229], v129 offset:16384
    v_cvt_pk_bf16_f32 v58, v16, v17
    v_mfma_f32_16x16x32_bf16 v[24:27], a[208:211], a[96:99], v[24:27]
    s_waitcnt lgkmcnt(9)
    ds_read_b64_tr_b16 a[230:231], v129 offset:18432
    v_cvt_pk_bf16_f32 v59, v18, v19
    v_mfma_f32_16x16x32_bf16 v[24:27], a[212:215], a[108:111], v[24:27]
    s_waitcnt lgkmcnt(8)
    ds_read_b64_tr_b16 a[232:233], v130 offset:16384
    v_cvt_pk_bf16_f32 v62, v20, v21
    v_mfma_f32_16x16x32_bf16 v[24:27], a[216:219], a[120:123], v[24:27]
    s_waitcnt lgkmcnt(7)
    ds_read_b64_tr_b16 a[234:235], v130 offset:18432
    v_cvt_pk_bf16_f32 v63, v22, v23
    v_mfma_f32_16x16x32_bf16 v[24:27], a[220:223], a[132:135], v[24:27]
    buffer_load_dwordx4 v[224:227], v156, s[28:31], s76 offen offset:3072 sc1
    v_mfma_f32_16x16x32_bf16 v[28:31], a[208:211], a[100:103], v[28:31]
    ds_read_b64_tr_b16 a[236:237], v131 offset:16384
    v_mfma_f32_16x16x32_bf16 v[28:31], a[212:215], a[112:115], v[28:31]
    ds_read_b64_tr_b16 a[238:239], v131 offset:18432
    v_mfma_f32_16x16x32_bf16 v[28:31], a[216:219], a[124:127], v[28:31]
    v_mfma_f32_16x16x32_bf16 v[28:31], a[220:223], a[136:139], v[28:31]
    v_mfma_f32_16x16x32_bf16 v[32:35], a[208:211], a[104:107], v[32:35]
    ds_read_b64_tr_b16 a[208:209], v116 offset:16384
    v_mfma_f32_16x16x32_bf16 v[32:35], a[212:215], a[116:119], v[32:35]
    ds_read_b64_tr_b16 a[210:211], v116 offset:18432
    v_mfma_f32_16x16x32_bf16 v[32:35], a[216:219], a[128:131], v[32:35]
    ds_read_b64_tr_b16 a[212:213], v117 offset:16384
    v_mfma_f32_16x16x32_bf16 v[32:35], a[220:223], a[140:143], v[32:35]
    s_waitcnt lgkmcnt(9)
    ds_read_b64_tr_b16 a[214:215], v117 offset:18432
    v_mfma_f32_16x16x32_bf16 v[24:27], a[224:227], a[144:147], v[24:27]
    s_waitcnt lgkmcnt(8)
    ds_read_b64_tr_b16 a[216:217], v118 offset:16384
    v_mfma_f32_16x16x32_bf16 v[24:27], a[228:231], a[156:159], v[24:27]
    s_waitcnt lgkmcnt(7)
    s_add_u32 s48, s76, 4096
    ds_read_b64_tr_b16 a[218:219], v118 offset:18432
    v_mfma_f32_16x16x32_bf16 v[24:27], a[232:235], a[168:171], v[24:27]
    s_waitcnt lgkmcnt(6)
    buffer_load_dwordx4 v[228:231], v156, s[28:31], s48 offen offset:0 sc1
    v_mfma_f32_16x16x32_bf16 v[24:27], a[236:239], a[180:183], v[24:27]
    s_add_u32 s49, s68, 4096
    ds_read_b64_tr_b16 a[220:221], v119 offset:16384
    v_mfma_f32_16x16x32_bf16 v[28:31], a[224:227], a[148:151], v[28:31]
    ds_read_b64_tr_b16 a[222:223], v119 offset:18432
    v_mfma_f32_16x16x32_bf16 v[28:31], a[228:231], a[160:163], v[28:31]
    v_mfma_f32_16x16x32_bf16 v[28:31], a[232:235], a[172:175], v[28:31]
    v_mfma_f32_16x16x32_bf16 v[28:31], a[236:239], a[184:187], v[28:31]
    v_mfma_f32_16x16x32_bf16 v[32:35], a[224:227], a[152:155], v[32:35]
    ds_read_b64_tr_b16 a[224:225], v132 offset:16384
    v_cvt_pk_bf16_f32 v64, v24, v25
    v_mfma_f32_16x16x32_bf16 v[32:35], a[228:231], a[164:167], v[32:35]
    ds_read_b64_tr_b16 a[226:227], v132 offset:18432
    v_cvt_pk_bf16_f32 v65, v26, v27
    v_mfma_f32_16x16x32_bf16 v[32:35], a[232:235], a[176:179], v[32:35]
    ds_read_b64_tr_b16 a[228:229], v133 offset:16384
    v_cvt_pk_bf16_f32 v68, v28, v29
    v_mfma_f32_16x16x32_bf16 v[32:35], a[236:239], a[188:191], v[32:35]
    s_waitcnt lgkmcnt(9)
    buffer_load_dwordx4 v[232:235], v156, s[28:31], s48 offen offset:1024 sc1
    v_cvt_pk_bf16_f32 v69, v30, v31
    v_mfma_f32_16x16x32_bf16 v[36:39], a[208:211], a[96:99], v[36:39]
    s_waitcnt lgkmcnt(7)
    ds_read_b64_tr_b16 a[230:231], v133 offset:18432
    v_mfma_f32_16x16x32_bf16 v[36:39], a[212:215], a[108:111], v[36:39]
    s_waitcnt lgkmcnt(6)
    ds_read_b64_tr_b16 a[232:233], v134 offset:16384
    v_cvt_pk_bf16_f32 v72, v32, v33
    v_mfma_f32_16x16x32_bf16 v[36:39], a[216:219], a[120:123], v[36:39]
    s_waitcnt lgkmcnt(5)
    ds_read_b64_tr_b16 a[234:235], v134 offset:18432
    v_cvt_pk_bf16_f32 v73, v34, v35
    v_mfma_f32_16x16x32_bf16 v[36:39], a[220:223], a[132:135], v[36:39]
    ds_read_b64_tr_b16 a[236:237], v135 offset:16384
    v_mfma_f32_16x16x32_bf16 v[40:43], a[208:211], a[100:103], v[40:43]
    ds_read_b64_tr_b16 a[238:239], v135 offset:18432
    v_mfma_f32_16x16x32_bf16 v[40:43], a[212:215], a[112:115], v[40:43]
    v_mfma_f32_16x16x32_bf16 v[40:43], a[216:219], a[124:127], v[40:43]
    v_mfma_f32_16x16x32_bf16 v[40:43], a[220:223], a[136:139], v[40:43]
    v_mfma_f32_16x16x32_bf16 v[44:47], a[208:211], a[104:107], v[44:47]
    v_mfma_f32_16x16x32_bf16 v[44:47], a[212:215], a[116:119], v[44:47]
    buffer_load_dwordx2 v[236:237], v242, s[28:31], s48 offen offset:2048 sc1
    v_mfma_f32_16x16x32_bf16 v[44:47], a[216:219], a[128:131], v[44:47]
    buffer_store_dwordx2 v[76:77], v242, s[28:31], s49 offen offset:2048 sc1
    v_mfma_f32_16x16x32_bf16 v[44:47], a[220:223], a[140:143], v[44:47]
    s_waitcnt lgkmcnt(0)
    s_add_u32 s49, s68, 4096
    buffer_store_dwordx4 v[52:55], v156, s[28:31], s68 offen offset:0 sc1
    s_barrier
    v_mfma_f32_16x16x32_bf16 v[36:39], a[224:227], a[144:147], v[36:39]
    s_add_u32 s56, s56, 1
    s_add_u32 s46, s39, s56
    buffer_store_dwordx4 v[56:59], v156, s[28:31], s68 offen offset:1024 sc1
    v_mfma_f32_16x16x32_bf16 v[36:39], a[228:231], a[156:159], v[36:39]
    s_add_u32 s46, s46, 1
    s_and_b32 s46, s46, 7
    buffer_store_dwordx4 v[60:63], v156, s[28:31], s68 offen offset:2048 sc1
    v_mfma_f32_16x16x32_bf16 v[36:39], a[232:235], a[168:171], v[36:39]
    s_lshl_b32 s46, s46, 3
    s_add_u32 s46, s46, s39
    ds_read_b64_tr_b16 a[208:209], v104 offset:32768
    v_mfma_f32_16x16x32_bf16 v[36:39], a[236:239], a[180:183], v[36:39]
    s_lshl_b32 s46, s46, 2
    s_add_u32 s46, s46, s36
    ds_read_b64_tr_b16 a[210:211], v104 offset:34816
    v_mfma_f32_16x16x32_bf16 v[40:43], a[224:227], a[148:151], v[40:43]
    s_mul_i32 s46, s46, 7168
    s_cmp_lt_u32 s56, 7
    ds_read_b64_tr_b16 a[212:213], v105 offset:32768
    v_mfma_f32_16x16x32_bf16 v[40:43], a[228:231], a[160:163], v[40:43]
    v_cvt_pk_bf16_f32 v66, v36, v37
    v_cvt_pk_bf16_f32 v67, v38, v39
    v_mfma_f32_16x16x32_bf16 v[40:43], a[232:235], a[172:175], v[40:43]
    buffer_store_dwordx4 v[64:67], v156, s[28:31], s68 offen offset:3072 sc1
    v_mfma_f32_16x16x32_bf16 v[40:43], a[236:239], a[184:187], v[40:43]
    s_cselect_b32 s68, s46, 0x40000000
    s_add_u32 s46, s39, s56
    ds_read_b64_tr_b16 a[214:215], v105 offset:34816
    v_mfma_f32_16x16x32_bf16 v[44:47], a[224:227], a[152:155], v[44:47]
    s_and_b32 s46, s46, 7
    s_lshl_b32 s46, s46, 7
    ds_read_b64_tr_b16 a[216:217], v106 offset:32768
    v_mfma_f32_16x16x32_bf16 v[44:47], a[228:231], a[164:167], v[44:47]
    s_cmp_ge_u32 s56, 1
    s_cselect_b32 s69, s46, 0x1000
    ds_read_b64_tr_b16 a[218:219], v106 offset:34816
    v_mfma_f32_16x16x32_bf16 v[44:47], a[232:235], a[176:179], v[44:47]
    s_add_u32 s46, s39, 9
    s_sub_u32 s46, s46, s56
    ds_read_b64_tr_b16 a[220:221], v107 offset:32768
    v_mfma_f32_16x16x32_bf16 v[44:47], a[236:239], a[188:191], v[44:47]
    s_waitcnt lgkmcnt(5)
    s_and_b32 s46, s46, 7
    ds_read_b64_tr_b16 a[222:223], v107 offset:34816
    v_mfma_f32_16x16x32_bf16 v[0:3], a[208:211], a[0:3], 0
    s_waitcnt lgkmcnt(4)
    s_lshl_b32 s57, s46, 2
    v_cvt_pk_bf16_f32 v70, v40, v41
    v_mfma_f32_16x16x32_bf16 v[0:3], a[212:215], a[12:15], v[0:3]
    s_waitcnt lgkmcnt(2)
    s_lshl_b32 s76, s39, 3
    v_cvt_pk_bf16_f32 v71, v42, v43
    v_mfma_f32_16x16x32_bf16 v[0:3], a[216:219], a[24:27], v[0:3]
    s_waitcnt lgkmcnt(0)
    s_add_u32 s76, s76, s46
    buffer_store_dwordx4 v[68:71], v156, s[28:31], s49 offen offset:0 sc1
    v_mfma_f32_16x16x32_bf16 v[0:3], a[220:223], a[36:39], v[0:3]
    s_lshl_b32 s76, s76, 2
    s_add_u32 s76, s76, s36
    v_cvt_pk_bf16_f32 v74, v44, v45
    v_mfma_f32_16x16x32_bf16 v[4:7], a[208:211], a[4:7], 0
    s_mul_i32 s76, s76, 7168
    s_cmp_ge_u32 s56, 2
    v_cvt_pk_bf16_f32 v75, v46, v47
    v_mfma_f32_16x16x32_bf16 v[4:7], a[212:215], a[16:19], v[4:7]
    s_cselect_b32 s76, s76, 0x40000000
    s_cselect_b32 s79, 1, 0
    buffer_store_dwordx4 v[72:75], v156, s[28:31], s49 offen offset:1024 sc1
    v_mfma_f32_16x16x32_bf16 v[4:7], a[216:219], a[28:31], v[4:7]
    s_add_u32 s77, s39, s56
    s_add_u32 s77, s77, 2
    buffer_load_dword v244, v245, s[0:3], s57 offen sc1
    v_mfma_f32_16x16x32_bf16 v[4:7], a[220:223], a[40:43], v[4:7]
    s_and_b32 s77, s77, 7
    s_lshl_b32 s77, s77, 7
    ds_read_b64_tr_b16 a[224:225], v120 offset:32768
    v_mfma_f32_16x16x32_bf16 v[8:11], a[208:211], a[8:11], 0
    s_add_u32 s77, s77, s59
    s_cmp_lt_u32 s56, 7
    ds_read_b64_tr_b16 a[226:227], v120 offset:34816
    v_mfma_f32_16x16x32_bf16 v[8:11], a[212:215], a[20:23], v[8:11]
    s_cselect_b32 s77, s77, 0x40000000
    s_add_u32 s100, s39, s56
    ds_read_b64_tr_b16 a[228:229], v121 offset:32768
    v_mfma_f32_16x16x32_bf16 v[8:11], a[216:219], a[32:35], v[8:11]
    s_add_u32 s100, s100, 3
    s_and_b32 s100, s100, 7
    ds_read_b64_tr_b16 a[230:231], v121 offset:34816
    v_mfma_f32_16x16x32_bf16 v[8:11], a[220:223], a[44:47], v[8:11]
    s_lshl_b32 s100, s100, 7
    s_add_u32 s100, s100, s59
    ds_read_b64_tr_b16 a[232:233], v122 offset:32768
    v_mfma_f32_16x16x32_bf16 v[48:51], a[208:211], v[140:143], 0
    s_cmp_lt_u32 s56, 6
    s_cselect_b32 s100, s100, 0x40000000
    ds_read_b64_tr_b16 a[234:235], v122 offset:34816
    v_mfma_f32_16x16x32_bf16 v[48:51], a[212:215], v[144:147], v[48:51]
    s_add_u32 s46, s77, 262144
    s_add_u32 m0, s41, 16384
    ds_read_b64_tr_b16 a[236:237], v123 offset:32768
    v_mfma_f32_16x16x32_bf16 v[48:51], a[216:219], v[148:151], v[48:51]
    s_add_u32 s47, s46, s45
    buffer_load_dwordx4 v157, s[16:19], s46 offen offset:0 lds
    buffer_load_dwordx4 v157, s[16:19], s47 offen offset:1024 lds
    v_mfma_f32_16x16x32_bf16 v[48:51], a[220:223], v[152:155], v[48:51]
    s_waitcnt lgkmcnt(5)
    s_add_u32 s48, s47, s45
    ds_read_b64_tr_b16 a[238:239], v123 offset:34816
    v_mfma_f32_16x16x32_bf16 v[0:3], a[224:227], a[48:51], v[0:3]
    s_waitcnt lgkmcnt(4)
    buffer_load_dwordx4 v157, s[16:19], s48 offen offset:2048 lds
    v_mfma_f32_16x16x32_bf16 v[0:3], a[228:231], a[60:63], v[0:3]
    s_waitcnt lgkmcnt(2)
    s_add_u32 s49, s48, s45
    ds_read_b128 v[140:143], v136 offset:28672
    v_mfma_f32_16x16x32_bf16 v[0:3], a[232:235], a[72:75], v[0:3]
    s_waitcnt lgkmcnt(1)
    buffer_load_dwordx4 v157, s[16:19], s49 offen offset:3072 lds
    s_add_u32 s46, s77, 393216
    s_add_u32 m0, s41, 81920
    v_mfma_f32_16x16x32_bf16 v[0:3], a[236:239], a[84:87], v[0:3]
    s_add_u32 s47, s46, s45
    buffer_load_dwordx4 v157, s[16:19], s46 offen offset:0 lds
    ds_read_b128 v[144:147], v137 offset:28672
    v_mfma_f32_16x16x32_bf16 v[4:7], a[224:227], a[52:55], v[4:7]
    ds_read_b128 v[148:151], v138 offset:28672
    s_waitcnt vmcnt(19)
    v_lshlrev_b32 v238, 16, v212
    v_mfma_f32_16x16x32_bf16 v[4:7], a[228:231], a[64:67], v[4:7]
    ds_read_b128 v[152:155], v139 offset:28672
    v_and_b32 v239, 0xffff0000, v212
    v_mfma_f32_16x16x32_bf16 v[4:7], a[232:235], a[76:79], v[4:7]
    buffer_load_dwordx4 v157, s[16:19], s47 offen offset:1024 lds
    v_lshlrev_b32 v240, 16, v213
    v_mfma_f32_16x16x32_bf16 v[4:7], a[236:239], a[88:91], v[4:7]
    s_add_u32 s48, s47, s45
    ds_read_b64_tr_b16 a[208:209], v108 offset:32768
    ds_read_b64_tr_b16 a[210:211], v108 offset:34816
    v_mfma_f32_16x16x32_bf16 v[8:11], a[224:227], a[56:59], v[8:11]
    ds_read_b64_tr_b16 a[212:213], v109 offset:32768
    v_and_b32 v241, 0xffff0000, v213
    v_mfma_f32_16x16x32_bf16 v[8:11], a[228:231], a[68:71], v[8:11]
    ds_read_b64_tr_b16 a[214:215], v109 offset:34816
    v_add_f32 v160, v160, v238
    v_mfma_f32_16x16x32_bf16 v[8:11], a[232:235], a[80:83], v[8:11]
    ds_read_b64_tr_b16 a[216:217], v110 offset:32768
    v_add_f32 v161, v161, v239
    v_mfma_f32_16x16x32_bf16 v[8:11], a[236:239], a[92:95], v[8:11]
    s_waitcnt lgkmcnt(8)
    ds_read_b64_tr_b16 a[218:219], v110 offset:34816
    ds_read_b64_tr_b16 a[220:221], v111 offset:32768
    v_mfma_f32_16x16x32_bf16 v[48:51], a[224:227], v[140:143], v[48:51]
    s_waitcnt lgkmcnt(9)
    ds_read_b64_tr_b16 a[222:223], v111 offset:34816
    buffer_load_dwordx4 v157, s[16:19], s48 offen offset:2048 lds
    v_mfma_f32_16x16x32_bf16 v[48:51], a[228:231], v[144:147], v[48:51]
    s_waitcnt lgkmcnt(9)
    s_add_u32 s49, s48, s45
    ds_read_b64_tr_b16 a[224:225], v124 offset:32768
    v_mfma_f32_16x16x32_bf16 v[48:51], a[232:235], v[148:151], v[48:51]
    s_waitcnt lgkmcnt(9)
    buffer_load_dwordx4 v157, s[16:19], s49 offen offset:3072 lds
    v_add_f32 v162, v162, v240
    v_mfma_f32_16x16x32_bf16 v[48:51], a[236:239], v[152:155], v[48:51]
    s_waitcnt lgkmcnt(7)
    ds_read_b64_tr_b16 a[226:227], v124 offset:34816
    v_add_f32 v163, v163, v241
    v_mfma_f32_16x16x32_bf16 v[12:15], a[208:211], a[0:3], 0
    s_waitcnt lgkmcnt(6)
    ds_read_b64_tr_b16 a[228:229], v125 offset:32768
    v_lshlrev_b32 v238, 16, v214
    v_mfma_f32_16x16x32_bf16 v[12:15], a[212:215], a[12:15], v[12:15]
    s_waitcnt lgkmcnt(5)
    ds_read_b64_tr_b16 a[230:231], v125 offset:34816
    v_and_b32 v239, 0xffff0000, v214
    v_mfma_f32_16x16x32_bf16 v[12:15], a[216:219], a[24:27], v[12:15]
    s_waitcnt lgkmcnt(4)
    ds_read_b64_tr_b16 a[232:233], v126 offset:32768
    v_lshlrev_b32 v240, 16, v215
    v_mfma_f32_16x16x32_bf16 v[12:15], a[220:223], a[36:39], v[12:15]
    ds_read_b64_tr_b16 a[234:235], v126 offset:34816
    v_and_b32 v241, 0xffff0000, v215
    v_mfma_f32_16x16x32_bf16 v[16:19], a[208:211], a[4:7], 0
    ds_read_b64_tr_b16 a[236:237], v127 offset:32768
    v_add_f32 v164, v164, v238
    v_mfma_f32_16x16x32_bf16 v[16:19], a[212:215], a[16:19], v[16:19]
    ds_read_b64_tr_b16 a[238:239], v127 offset:34816
    v_add_f32 v165, v165, v239
    v_mfma_f32_16x16x32_bf16 v[16:19], a[216:219], a[28:31], v[16:19]
    ds_read_b128 v[140:143], v136 offset:0
    v_add_f32 v166, v166, v240
    v_mfma_f32_16x16x32_bf16 v[16:19], a[220:223], a[40:43], v[16:19]
    ds_read_b128 v[144:147], v137 offset:0
    v_add_f32 v167, v167, v241
    v_mfma_f32_16x16x32_bf16 v[20:23], a[208:211], a[8:11], 0
    ds_read_b64_tr_b16 a[208:209], v112 offset:32768
    s_waitcnt vmcnt(21)
    v_lshlrev_b32 v238, 16, v216
    v_mfma_f32_16x16x32_bf16 v[20:23], a[212:215], a[20:23], v[20:23]
    ds_read_b64_tr_b16 a[210:211], v112 offset:34816
    v_and_b32 v239, 0xffff0000, v216
    v_mfma_f32_16x16x32_bf16 v[20:23], a[216:219], a[32:35], v[20:23]
    ds_read_b64_tr_b16 a[212:213], v113 offset:32768
    v_lshlrev_b32 v240, 16, v217
    v_mfma_f32_16x16x32_bf16 v[20:23], a[220:223], a[44:47], v[20:23]
    s_waitcnt lgkmcnt(11)
    ds_read_b64_tr_b16 a[214:215], v113 offset:34816
    v_and_b32 v241, 0xffff0000, v217
    v_mfma_f32_16x16x32_bf16 v[12:15], a[224:227], a[48:51], v[12:15]
    s_waitcnt lgkmcnt(10)
    ds_read_b64_tr_b16 a[216:217], v114 offset:32768
    v_add_f32 v168, v168, v238
    v_mfma_f32_16x16x32_bf16 v[12:15], a[228:231], a[60:63], v[12:15]
    s_waitcnt lgkmcnt(9)
    ds_read_b64_tr_b16 a[218:219], v114 offset:34816
    v_add_f32 v169, v169, v239
    v_mfma_f32_16x16x32_bf16 v[12:15], a[232:235], a[72:75], v[12:15]
    s_waitcnt lgkmcnt(8)
    ds_read_b64_tr_b16 a[220:221], v115 offset:32768
    v_add_f32 v170, v170, v240
    v_mfma_f32_16x16x32_bf16 v[12:15], a[236:239], a[84:87], v[12:15]
    ds_read_b64_tr_b16 a[222:223], v115 offset:34816
    v_add_f32 v171, v171, v241
    v_mfma_f32_16x16x32_bf16 v[16:19], a[224:227], a[52:55], v[16:19]
    ds_read_b128 v[148:151], v138 offset:0
    v_lshlrev_b32 v238, 16, v218
    v_mfma_f32_16x16x32_bf16 v[16:19], a[228:231], a[64:67], v[16:19]
    ds_read_b128 v[152:155], v139 offset:0
    v_and_b32 v239, 0xffff0000, v218
    v_mfma_f32_16x16x32_bf16 v[16:19], a[232:235], a[76:79], v[16:19]
    v_lshlrev_b32 v240, 16, v219
    v_and_b32 v241, 0xffff0000, v219
    v_mfma_f32_16x16x32_bf16 v[16:19], a[236:239], a[88:91], v[16:19]
    v_add_f32 v172, v172, v238
    v_add_f32 v173, v173, v239
    v_mfma_f32_16x16x32_bf16 v[20:23], a[224:227], a[56:59], v[20:23]
    ds_read_b64_tr_b16 a[224:225], v128 offset:32768
    v_add_f32 v174, v174, v240
    v_mfma_f32_16x16x32_bf16 v[20:23], a[228:231], a[68:71], v[20:23]
    ds_read_b64_tr_b16 a[226:227], v128 offset:34816
    v_add_f32 v175, v175, v241
    v_mfma_f32_16x16x32_bf16 v[20:23], a[232:235], a[80:83], v[20:23]
    s_waitcnt vmcnt(20)
    v_lshlrev_b32 v238, 16, v220
    v_and_b32 v239, 0xffff0000, v220
    v_mfma_f32_16x16x32_bf16 v[20:23], a[236:239], a[92:95], v[20:23]
    s_waitcnt lgkmcnt(10)
    ds_read_b64_tr_b16 a[228:229], v129 offset:32768
    v_lshlrev_b32 v240, 16, v221
    v_mfma_f32_16x16x32_bf16 v[24:27], a[208:211], a[0:3], 0
    s_waitcnt lgkmcnt(9)
    ds_read_b64_tr_b16 a[230:231], v129 offset:34816
    v_and_b32 v241, 0xffff0000, v221
    v_mfma_f32_16x16x32_bf16 v[24:27], a[212:215], a[12:15], v[24:27]
    s_waitcnt lgkmcnt(8)
    ds_read_b64_tr_b16 a[232:233], v130 offset:32768
    v_add_f32 v176, v176, v238
    v_mfma_f32_16x16x32_bf16 v[24:27], a[216:219], a[24:27], v[24:27]
    s_waitcnt lgkmcnt(7)
    ds_read_b64_tr_b16 a[234:235], v130 offset:34816
    v_add_f32 v177, v177, v239
    v_mfma_f32_16x16x32_bf16 v[24:27], a[220:223], a[36:39], v[24:27]
    ds_read_b64_tr_b16 a[236:237], v131 offset:32768
    v_add_f32 v178, v178, v240
    v_mfma_f32_16x16x32_bf16 v[28:31], a[208:211], a[4:7], 0
    ds_read_b64_tr_b16 a[238:239], v131 offset:34816
    v_add_f32 v179, v179, v241
    v_mfma_f32_16x16x32_bf16 v[28:31], a[212:215], a[16:19], v[28:31]
    v_lshlrev_b32 v238, 16, v222
    v_and_b32 v239, 0xffff0000, v222
    v_mfma_f32_16x16x32_bf16 v[28:31], a[216:219], a[28:31], v[28:31]
    s_waitcnt vmcnt(8)
    v_cmp_le_u32 vcc, s79, v244
    v_lshlrev_b32 v240, 16, v223
    v_mfma_f32_16x16x32_bf16 v[28:31], a[220:223], a[40:43], v[28:31]
    v_and_b32 v241, 0xffff0000, v223
    v_add_f32 v180, v180, v238
    v_mfma_f32_16x16x32_bf16 v[32:35], a[208:211], a[8:11], 0
    ds_read_b64_tr_b16 a[208:209], v116 offset:32768
    v_add_f32 v181, v181, v239
    v_mfma_f32_16x16x32_bf16 v[32:35], a[212:215], a[20:23], v[32:35]
    ds_read_b64_tr_b16 a[210:211], v116 offset:34816
    v_add_f32 v182, v182, v240
    v_mfma_f32_16x16x32_bf16 v[32:35], a[216:219], a[32:35], v[32:35]
    ds_read_b64_tr_b16 a[212:213], v117 offset:32768
    v_add_f32 v183, v183, v241
    v_mfma_f32_16x16x32_bf16 v[32:35], a[220:223], a[44:47], v[32:35]
    s_waitcnt lgkmcnt(9)
    ds_read_b64_tr_b16 a[214:215], v117 offset:34816
    v_lshlrev_b32 v238, 16, v224
    v_mfma_f32_16x16x32_bf16 v[24:27], a[224:227], a[48:51], v[24:27]
    s_waitcnt lgkmcnt(8)
    ds_read_b64_tr_b16 a[216:217], v118 offset:32768
    v_and_b32 v239, 0xffff0000, v224
    v_mfma_f32_16x16x32_bf16 v[24:27], a[228:231], a[60:63], v[24:27]
    s_waitcnt lgkmcnt(7)
    ds_read_b64_tr_b16 a[218:219], v118 offset:34816
    v_lshlrev_b32 v240, 16, v225
    v_mfma_f32_16x16x32_bf16 v[24:27], a[232:235], a[72:75], v[24:27]
    s_waitcnt lgkmcnt(6)
    ds_read_b64_tr_b16 a[220:221], v119 offset:32768
    v_and_b32 v241, 0xffff0000, v225
    v_mfma_f32_16x16x32_bf16 v[24:27], a[236:239], a[84:87], v[24:27]
    ds_read_b64_tr_b16 a[222:223], v119 offset:34816
    v_add_f32 v184, v184, v238
    v_mfma_f32_16x16x32_bf16 v[28:31], a[224:227], a[52:55], v[28:31]
    v_add_f32 v185, v185, v239
    v_add_f32 v186, v186, v240
    v_mfma_f32_16x16x32_bf16 v[28:31], a[228:231], a[64:67], v[28:31]
    v_add_f32 v187, v187, v241
    v_lshlrev_b32 v238, 16, v226
    v_mfma_f32_16x16x32_bf16 v[28:31], a[232:235], a[76:79], v[28:31]
    v_and_b32 v239, 0xffff0000, v226
    v_lshlrev_b32 v240, 16, v227
    v_mfma_f32_16x16x32_bf16 v[28:31], a[236:239], a[88:91], v[28:31]
    v_and_b32 v241, 0xffff0000, v227
    v_add_f32 v188, v188, v238
    v_mfma_f32_16x16x32_bf16 v[32:35], a[224:227], a[56:59], v[32:35]
    ds_read_b64_tr_b16 a[224:225], v132 offset:32768
    v_add_f32 v189, v189, v239
    v_mfma_f32_16x16x32_bf16 v[32:35], a[228:231], a[68:71], v[32:35]
    ds_read_b64_tr_b16 a[226:227], v132 offset:34816
    v_add_f32 v190, v190, v240
    v_mfma_f32_16x16x32_bf16 v[32:35], a[232:235], a[80:83], v[32:35]
    ds_read_b64_tr_b16 a[228:229], v133 offset:32768
    v_add_f32 v191, v191, v241
    v_mfma_f32_16x16x32_bf16 v[32:35], a[236:239], a[92:95], v[32:35]
    s_waitcnt lgkmcnt(9)
    ds_read_b64_tr_b16 a[230:231], v133 offset:34816
    v_lshlrev_b32 v238, 16, v228
    v_mfma_f32_16x16x32_bf16 v[36:39], a[208:211], a[0:3], 0
    s_waitcnt lgkmcnt(8)
    ds_read_b64_tr_b16 a[232:233], v134 offset:32768
    v_and_b32 v239, 0xffff0000, v228
    v_mfma_f32_16x16x32_bf16 v[36:39], a[212:215], a[12:15], v[36:39]
    s_waitcnt lgkmcnt(7)
    ds_read_b64_tr_b16 a[234:235], v134 offset:34816
    v_lshlrev_b32 v240, 16, v229
    v_mfma_f32_16x16x32_bf16 v[36:39], a[216:219], a[24:27], v[36:39]
    s_waitcnt lgkmcnt(6)
    ds_read_b64_tr_b16 a[236:237], v135 offset:32768
    ds_read_b64_tr_b16 a[238:239], v135 offset:34816
    v_mfma_f32_16x16x32_bf16 v[36:39], a[220:223], a[36:39], v[36:39]
    v_and_b32 v241, 0xffff0000, v229
    v_add_f32 v192, v192, v238
    v_mfma_f32_16x16x32_bf16 v[40:43], a[208:211], a[4:7], 0
    v_add_f32 v193, v193, v239
    v_add_f32 v194, v194, v240
    v_mfma_f32_16x16x32_bf16 v[40:43], a[212:215], a[16:19], v[40:43]
    v_add_f32 v195, v195, v241
    v_lshlrev_b32 v238, 16, v230
    v_mfma_f32_16x16x32_bf16 v[40:43], a[216:219], a[28:31], v[40:43]
    v_and_b32 v239, 0xffff0000, v230
    v_lshlrev_b32 v240, 16, v231
    v_mfma_f32_16x16x32_bf16 v[40:43], a[220:223], a[40:43], v[40:43]
    v_and_b32 v241, 0xffff0000, v231
    v_add_f32 v196, v196, v238
    v_mfma_f32_16x16x32_bf16 v[44:47], a[208:211], a[8:11], 0
    v_add_f32 v197, v197, v239
    v_add_f32 v198, v198, v240
    v_mfma_f32_16x16x32_bf16 v[44:47], a[212:215], a[20:23], v[44:47]
    v_add_f32 v199, v199, v241
    v_lshlrev_b32 v238, 16, v232
    v_mfma_f32_16x16x32_bf16 v[44:47], a[216:219], a[32:35], v[44:47]
    v_and_b32 v239, 0xffff0000, v232
    v_lshlrev_b32 v240, 16, v233
    v_mfma_f32_16x16x32_bf16 v[44:47], a[220:223], a[44:47], v[44:47]
    s_waitcnt lgkmcnt(0)
    v_and_b32 v241, 0xffff0000, v233
    v_add_f32 v200, v200, v238
    s_barrier
    v_mfma_f32_16x16x32_bf16 v[36:39], a[224:227], a[48:51], v[36:39]
    ds_read_b64_tr_b16 a[208:209], v104 offset:49152
    v_add_f32 v201, v201, v239
    v_mfma_f32_16x16x32_bf16 v[36:39], a[228:231], a[60:63], v[36:39]
    ds_read_b64_tr_b16 a[210:211], v104 offset:51200
    v_add_f32 v202, v202, v240
    v_mfma_f32_16x16x32_bf16 v[36:39], a[232:235], a[72:75], v[36:39]
    ds_read_b64_tr_b16 a[212:213], v105 offset:49152
    v_add_f32 v203, v203, v241
    v_mfma_f32_16x16x32_bf16 v[36:39], a[236:239], a[84:87], v[36:39]
    ds_read_b64_tr_b16 a[214:215], v105 offset:51200
    v_lshlrev_b32 v238, 16, v234
    v_mfma_f32_16x16x32_bf16 v[40:43], a[224:227], a[52:55], v[40:43]
    ds_read_b64_tr_b16 a[216:217], v106 offset:49152
    v_and_b32 v239, 0xffff0000, v234
    v_mfma_f32_16x16x32_bf16 v[40:43], a[228:231], a[64:67], v[40:43]
    ds_read_b64_tr_b16 a[218:219], v106 offset:51200
    v_lshlrev_b32 v240, 16, v235
    v_mfma_f32_16x16x32_bf16 v[40:43], a[232:235], a[76:79], v[40:43]
    ds_read_b64_tr_b16 a[220:221], v107 offset:49152
    v_and_b32 v241, 0xffff0000, v235
    v_mfma_f32_16x16x32_bf16 v[40:43], a[236:239], a[88:91], v[40:43]
    ds_read_b64_tr_b16 a[222:223], v107 offset:51200
    v_add_f32 v204, v204, v238
    v_mfma_f32_16x16x32_bf16 v[44:47], a[224:227], a[56:59], v[44:47]
    buffer_store_dword v247, v246, s[0:3], s69 offen offset:0 sc1
    v_mfma_f32_16x16x32_bf16 v[44:47], a[228:231], a[68:71], v[44:47]
    ds_read_b64_tr_b16 a[224:225], v120 offset:49152
    v_add_f32 v205, v205, v239
    v_mfma_f32_16x16x32_bf16 v[44:47], a[232:235], a[80:83], v[44:47]
    ds_read_b64_tr_b16 a[226:227], v120 offset:51200
    v_add_f32 v206, v206, v240
    v_mfma_f32_16x16x32_bf16 v[44:47], a[236:239], a[92:95], v[44:47]
    ds_read_b64_tr_b16 a[228:229], v121 offset:49152
    v_add_f32 v207, v207, v241
    s_cmp_eq_u64 vcc, -1
    s_cbranch_scc0 L_spin1
L_spin1_ret:
    s_waitcnt lgkmcnt(9)
    v_mfma_f32_16x16x32_bf16 v[0:3], a[208:211], a[96:99], v[0:3]
    s_waitcnt lgkmcnt(7)
    ds_read_b64_tr_b16 a[230:231], v121 offset:51200
    v_lshlrev_b32 v238, 16, v236
    v_mfma_f32_16x16x32_bf16 v[0:3], a[212:215], a[108:111], v[0:3]
    s_waitcnt lgkmcnt(6)
    s_add_u32 s46, s100, 0
    ds_read_b64_tr_b16 a[232:233], v122 offset:49152
    v_mfma_f32_16x16x32_bf16 v[0:3], a[216:219], a[120:123], v[0:3]
    s_waitcnt lgkmcnt(5)
    s_add_u32 m0, s41, 32768
    ds_read_b64_tr_b16 a[234:235], v122 offset:51200
    v_mfma_f32_16x16x32_bf16 v[0:3], a[220:223], a[132:135], v[0:3]
    buffer_load_dwordx4 v157, s[16:19], s46 offen offset:0 lds
    v_and_b32 v239, 0xffff0000, v236
    v_mfma_f32_16x16x32_bf16 v[4:7], a[208:211], a[100:103], v[4:7]
    s_add_u32 s47, s46, s45
    buffer_load_dwordx4 v157, s[16:19], s47 offen offset:1024 lds
    v_lshlrev_b32 v240, 16, v237
    v_mfma_f32_16x16x32_bf16 v[4:7], a[212:215], a[112:115], v[4:7]
    ds_read_b64_tr_b16 a[236:237], v123 offset:49152
    v_and_b32 v241, 0xffff0000, v237
    v_mfma_f32_16x16x32_bf16 v[4:7], a[216:219], a[124:127], v[4:7]
    ds_read_b64_tr_b16 a[238:239], v123 offset:51200
    v_add_f32 v208, v208, v238
    v_mfma_f32_16x16x32_bf16 v[4:7], a[220:223], a[136:139], v[4:7]
    s_add_u32 s48, s47, s45
    buffer_load_dwordx4 v157, s[16:19], s48 offen offset:2048 lds
    v_add_f32 v209, v209, v239
    v_mfma_f32_16x16x32_bf16 v[8:11], a[208:211], a[104:107], v[8:11]
    v_add_f32 v210, v210, v240
    v_add_f32 v211, v211, v241
    v_mfma_f32_16x16x32_bf16 v[8:11], a[212:215], a[116:119], v[8:11]
    v_mfma_f32_16x16x32_bf16 v[8:11], a[216:219], a[128:131], v[8:11]
    s_add_u32 s49, s48, s45
    buffer_load_dwordx4 v157, s[16:19], s49 offen offset:3072 lds
    v_mfma_f32_16x16x32_bf16 v[8:11], a[220:223], a[140:143], v[8:11]
    v_mfma_f32_16x16x32_bf16 v[48:51], a[208:211], v[140:143], v[48:51]
    ds_read_b128 v[140:143], v136 offset:4096
    v_mfma_f32_16x16x32_bf16 v[48:51], a[212:215], v[144:147], v[48:51]
    ds_read_b128 v[144:147], v137 offset:4096
    v_mfma_f32_16x16x32_bf16 v[48:51], a[216:219], v[148:151], v[48:51]
    ds_read_b128 v[148:151], v138 offset:4096
    v_mfma_f32_16x16x32_bf16 v[48:51], a[220:223], v[152:155], v[48:51]
    s_waitcnt lgkmcnt(9)
    s_add_u32 s46, s100, 131072
    ds_read_b128 v[152:155], v139 offset:4096
    v_mfma_f32_16x16x32_bf16 v[0:3], a[224:227], a[144:147], v[0:3]
    s_waitcnt lgkmcnt(8)
    s_add_u32 m0, s41, 98304
    ds_read_b64_tr_b16 a[208:209], v108 offset:49152
    v_mfma_f32_16x16x32_bf16 v[0:3], a[228:231], a[156:159], v[0:3]
    s_waitcnt lgkmcnt(7)
    buffer_load_dwordx4 v157, s[16:19], s46 offen offset:0 lds
    v_mfma_f32_16x16x32_bf16 v[0:3], a[232:235], a[168:171], v[0:3]
    s_waitcnt lgkmcnt(5)
    s_add_u32 s47, s46, s45
    ds_read_b64_tr_b16 a[210:211], v108 offset:51200
    v_mfma_f32_16x16x32_bf16 v[0:3], a[236:239], a[180:183], v[0:3]
    buffer_load_dwordx4 v157, s[16:19], s47 offen offset:1024 lds
    v_mfma_f32_16x16x32_bf16 v[4:7], a[224:227], a[148:151], v[4:7]
    ds_read_b64_tr_b16 a[212:213], v109 offset:49152
    v_mfma_f32_16x16x32_bf16 v[4:7], a[228:231], a[160:163], v[4:7]
    s_add_u32 s48, s47, s45
    ds_read_b64_tr_b16 a[214:215], v109 offset:51200
    v_mfma_f32_16x16x32_bf16 v[4:7], a[232:235], a[172:175], v[4:7]
    buffer_load_dwordx4 v157, s[16:19], s48 offen offset:2048 lds
    v_cvt_pk_bf16_f32 v52, v0, v1
    v_mfma_f32_16x16x32_bf16 v[4:7], a[236:239], a[184:187], v[4:7]
    ds_read_b64_tr_b16 a[216:217], v110 offset:49152
    v_cvt_pk_bf16_f32 v53, v2, v3
    v_mfma_f32_16x16x32_bf16 v[8:11], a[224:227], a[152:155], v[8:11]
    s_add_u32 s49, s48, s45
    ds_read_b64_tr_b16 a[218:219], v110 offset:51200
    ds_read_b64_tr_b16 a[220:221], v111 offset:49152
    v_mfma_f32_16x16x32_bf16 v[8:11], a[228:231], a[164:167], v[8:11]
    ds_read_b64_tr_b16 a[222:223], v111 offset:51200
    v_cvt_pk_bf16_f32 v56, v4, v5
    v_mfma_f32_16x16x32_bf16 v[8:11], a[232:235], a[176:179], v[8:11]
    buffer_load_dwordx4 v157, s[16:19], s49 offen offset:3072 lds
    v_cvt_pk_bf16_f32 v57, v6, v7
    v_mfma_f32_16x16x32_bf16 v[8:11], a[236:239], a[188:191], v[8:11]
    s_waitcnt lgkmcnt(11)
    v_mfma_f32_16x16x32_bf16 v[48:51], a[224:227], v[140:143], v[48:51]
    s_waitcnt lgkmcnt(10)
    ds_read_b64_tr_b16 a[224:225], v124 offset:49152
    v_mfma_f32_16x16x32_bf16 v[48:51], a[228:231], v[144:147], v[48:51]
    s_waitcnt lgkmcnt(10)
    buffer_load_dwordx4 v[212:215], v156, s[28:31], s76 offen offset:0 sc1
    v_mfma_f32_16x16x32_bf16 v[48:51], a[232:235], v[148:151], v[48:51]
    s_waitcnt lgkmcnt(9)
    ds_read_b64_tr_b16 a[226:227], v124 offset:51200
    v_cvt_pk_bf16_f32 v60, v8, v9
    v_mfma_f32_16x16x32_bf16 v[48:51], a[236:239], v[152:155], v[48:51]
    s_waitcnt lgkmcnt(8)
    ds_read_b64_tr_b16 a[228:229], v125 offset:49152
    v_cvt_pk_bf16_f32 v61, v10, v11
    v_mfma_f32_16x16x32_bf16 v[12:15], a[208:211], a[96:99], v[12:15]
    s_waitcnt lgkmcnt(7)
    ds_read_b64_tr_b16 a[230:231], v125 offset:51200
    v_mfma_f32_16x16x32_bf16 v[12:15], a[212:215], a[108:111], v[12:15]
    s_waitcnt lgkmcnt(6)
    ds_read_b64_tr_b16 a[232:233], v126 offset:49152
    v_cvt_pk_bf16_f32 v76, v48, v49
    v_mfma_f32_16x16x32_bf16 v[12:15], a[216:219], a[120:123], v[12:15]
    s_waitcnt lgkmcnt(5)
    ds_read_b64_tr_b16 a[234:235], v126 offset:51200
    v_cvt_pk_bf16_f32 v77, v50, v51
    v_mfma_f32_16x16x32_bf16 v[12:15], a[220:223], a[132:135], v[12:15]
    ds_read_b64_tr_b16 a[236:237], v127 offset:49152
    v_mfma_f32_16x16x32_bf16 v[16:19], a[208:211], a[100:103], v[16:19]
    ds_read_b64_tr_b16 a[238:239], v127 offset:51200
    v_mfma_f32_16x16x32_bf16 v[16:19], a[212:215], a[112:115], v[16:19]
    ds_read_b128 v[140:143], v136 offset:24576
    v_mfma_f32_16x16x32_bf16 v[16:19], a[216:219], a[124:127], v[16:19]
    ds_read_b128 v[144:147], v137 offset:24576
    v_mfma_f32_16x16x32_bf16 v[16:19], a[220:223], a[136:139], v[16:19]
    buffer_load_dwordx4 v[216:219], v156, s[28:31], s76 offen offset:1024 sc1
    v_mfma_f32_16x16x32_bf16 v[20:23], a[208:211], a[104:107], v[20:23]
    ds_read_b64_tr_b16 a[208:209], v112 offset:49152
    v_mfma_f32_16x16x32_bf16 v[20:23], a[212:215], a[116:119], v[20:23]
    ds_read_b64_tr_b16 a[210:211], v112 offset:51200
    v_mfma_f32_16x16x32_bf16 v[20:23], a[216:219], a[128:131], v[20:23]
    ds_read_b64_tr_b16 a[212:213], v113 offset:49152
    v_mfma_f32_16x16x32_bf16 v[20:23], a[220:223], a[140:143], v[20:23]
    s_waitcnt lgkmcnt(11)
    ds_read_b64_tr_b16 a[214:215], v113 offset:51200
    v_mfma_f32_16x16x32_bf16 v[12:15], a[224:227], a[144:147], v[12:15]
    s_waitcnt lgkmcnt(10)
    ds_read_b64_tr_b16 a[216:217], v114 offset:49152
    v_mfma_f32_16x16x32_bf16 v[12:15], a[228:231], a[156:159], v[12:15]
    s_waitcnt lgkmcnt(9)
    ds_read_b64_tr_b16 a[218:219], v114 offset:51200
    v_mfma_f32_16x16x32_bf16 v[12:15], a[232:235], a[168:171], v[12:15]
    s_waitcnt lgkmcnt(8)
    ds_read_b64_tr_b16 a[220:221], v115 offset:49152
    v_mfma_f32_16x16x32_bf16 v[12:15], a[236:239], a[180:183], v[12:15]
    ds_read_b64_tr_b16 a[222:223], v115 offset:51200
    v_mfma_f32_16x16x32_bf16 v[16:19], a[224:227], a[148:151], v[16:19]
    ds_read_b128 v[148:151], v138 offset:24576
    v_mfma_f32_16x16x32_bf16 v[16:19], a[228:231], a[160:163], v[16:19]
    buffer_load_dwordx4 v[220:223], v156, s[28:31], s76 offen offset:2048 sc1
    v_mfma_f32_16x16x32_bf16 v[16:19], a[232:235], a[172:175], v[16:19]
    ds_read_b128 v[152:155], v139 offset:24576
    v_mfma_f32_16x16x32_bf16 v[16:19], a[236:239], a[184:187], v[16:19]
    v_cvt_pk_bf16_f32 v54, v12, v13
    v_cvt_pk_bf16_f32 v55, v14, v15
    v_mfma_f32_16x16x32_bf16 v[20:23], a[224:227], a[152:155], v[20:23]
    ds_read_b64_tr_b16 a[224:225], v128 offset:49152
    v_mfma_f32_16x16x32_bf16 v[20:23], a[228:231], a[164:167], v[20:23]
    ds_read_b64_tr_b16 a[226:227], v128 offset:51200
    v_mfma_f32_16x16x32_bf16 v[20:23], a[232:235], a[176:179], v[20:23]
    v_mfma_f32_16x16x32_bf16 v[20:23], a[236:239], a[188:191], v[20:23]
    s_waitcnt lgkmcnt(10)
    ds_read_b64_tr_b16 a[228:229], v129 offset:49152
    v_cvt_pk_bf16_f32 v58, v16, v17
    v_mfma_f32_16x16x32_bf16 v[24:27], a[208:211], a[96:99], v[24:27]
    s_waitcnt lgkmcnt(9)
    ds_read_b64_tr_b16 a[230:231], v129 offset:51200
    v_cvt_pk_bf16_f32 v59, v18, v19
    v_mfma_f32_16x16x32_bf16 v[24:27], a[212:215], a[108:111], v[24:27]
    s_waitcnt lgkmcnt(8)
    ds_read_b64_tr_b16 a[232:233], v130 offset:49152
    v_cvt_pk_bf16_f32 v62, v20, v21
    v_mfma_f32_16x16x32_bf16 v[24:27], a[216:219], a[120:123], v[24:27]
    s_waitcnt lgkmcnt(7)
    ds_read_b64_tr_b16 a[234:235], v130 offset:51200
    v_cvt_pk_bf16_f32 v63, v22, v23
    v_mfma_f32_16x16x32_bf16 v[24:27], a[220:223], a[132:135], v[24:27]
    buffer_load_dwordx4 v[224:227], v156, s[28:31], s76 offen offset:3072 sc1
    v_mfma_f32_16x16x32_bf16 v[28:31], a[208:211], a[100:103], v[28:31]
    ds_read_b64_tr_b16 a[236:237], v131 offset:49152
    v_mfma_f32_16x16x32_bf16 v[28:31], a[212:215], a[112:115], v[28:31]
    ds_read_b64_tr_b16 a[238:239], v131 offset:51200
    v_mfma_f32_16x16x32_bf16 v[28:31], a[216:219], a[124:127], v[28:31]
    v_mfma_f32_16x16x32_bf16 v[28:31], a[220:223], a[136:139], v[28:31]
    v_mfma_f32_16x16x32_bf16 v[32:35], a[208:211], a[104:107], v[32:35]
    ds_read_b64_tr_b16 a[208:209], v116 offset:49152
    v_mfma_f32_16x16x32_bf16 v[32:35], a[212:215], a[116:119], v[32:35]
    ds_read_b64_tr_b16 a[210:211], v116 offset:51200
    v_mfma_f32_16x16x32_bf16 v[32:35], a[216:219], a[128:131], v[32:35]
    ds_read_b64_tr_b16 a[212:213], v117 offset:49152
    v_mfma_f32_16x16x32_bf16 v[32:35], a[220:223], a[140:143], v[32:35]
    s_waitcnt lgkmcnt(9)
    ds_read_b64_tr_b16 a[214:215], v117 offset:51200
    v_mfma_f32_16x16x32_bf16 v[24:27], a[224:227], a[144:147], v[24:27]
    s_waitcnt lgkmcnt(8)
    ds_read_b64_tr_b16 a[216:217], v118 offset:49152
    v_mfma_f32_16x16x32_bf16 v[24:27], a[228:231], a[156:159], v[24:27]
    s_waitcnt lgkmcnt(7)
    s_add_u32 s48, s76, 4096
    ds_read_b64_tr_b16 a[218:219], v118 offset:51200
    v_mfma_f32_16x16x32_bf16 v[24:27], a[232:235], a[168:171], v[24:27]
    s_waitcnt lgkmcnt(6)
    buffer_load_dwordx4 v[228:231], v156, s[28:31], s48 offen offset:0 sc1
    v_mfma_f32_16x16x32_bf16 v[24:27], a[236:239], a[180:183], v[24:27]
    s_add_u32 s49, s68, 4096
    ds_read_b64_tr_b16 a[220:221], v119 offset:49152
    v_mfma_f32_16x16x32_bf16 v[28:31], a[224:227], a[148:151], v[28:31]
    ds_read_b64_tr_b16 a[222:223], v119 offset:51200
    v_mfma_f32_16x16x32_bf16 v[28:31], a[228:231], a[160:163], v[28:31]
    v_mfma_f32_16x16x32_bf16 v[28:31], a[232:235], a[172:175], v[28:31]
    v_mfma_f32_16x16x32_bf16 v[28:31], a[236:239], a[184:187], v[28:31]
    v_mfma_f32_16x16x32_bf16 v[32:35], a[224:227], a[152:155], v[32:35]
    ds_read_b64_tr_b16 a[224:225], v132 offset:49152
    v_cvt_pk_bf16_f32 v64, v24, v25
    v_mfma_f32_16x16x32_bf16 v[32:35], a[228:231], a[164:167], v[32:35]
    ds_read_b64_tr_b16 a[226:227], v132 offset:51200
    v_cvt_pk_bf16_f32 v65, v26, v27
    v_mfma_f32_16x16x32_bf16 v[32:35], a[232:235], a[176:179], v[32:35]
    ds_read_b64_tr_b16 a[228:229], v133 offset:49152
    v_cvt_pk_bf16_f32 v68, v28, v29
    v_mfma_f32_16x16x32_bf16 v[32:35], a[236:239], a[188:191], v[32:35]
    s_waitcnt lgkmcnt(9)
    buffer_load_dwordx4 v[232:235], v156, s[28:31], s48 offen offset:1024 sc1
    v_cvt_pk_bf16_f32 v69, v30, v31
    v_mfma_f32_16x16x32_bf16 v[36:39], a[208:211], a[96:99], v[36:39]
    s_waitcnt lgkmcnt(7)
    ds_read_b64_tr_b16 a[230:231], v133 offset:51200
    v_mfma_f32_16x16x32_bf16 v[36:39], a[212:215], a[108:111], v[36:39]
    s_waitcnt lgkmcnt(6)
    ds_read_b64_tr_b16 a[232:233], v134 offset:49152
    ds_read_b64_tr_b16 a[234:235], v134 offset:51200
    v_mfma_f32_16x16x32_bf16 v[36:39], a[216:219], a[120:123], v[36:39]
    s_waitcnt lgkmcnt(6)
    ds_read_b64_tr_b16 a[236:237], v135 offset:49152
    ds_read_b64_tr_b16 a[238:239], v135 offset:51200
    v_mfma_f32_16x16x32_bf16 v[36:39], a[220:223], a[132:135], v[36:39]
    v_cvt_pk_bf16_f32 v72, v32, v33
    v_cvt_pk_bf16_f32 v73, v34, v35
    v_mfma_f32_16x16x32_bf16 v[40:43], a[208:211], a[100:103], v[40:43]
    v_mfma_f32_16x16x32_bf16 v[40:43], a[212:215], a[112:115], v[40:43]
    v_mfma_f32_16x16x32_bf16 v[40:43], a[216:219], a[124:127], v[40:43]
    v_mfma_f32_16x16x32_bf16 v[40:43], a[220:223], a[136:139], v[40:43]
    v_mfma_f32_16x16x32_bf16 v[44:47], a[208:211], a[104:107], v[44:47]
    v_mfma_f32_16x16x32_bf16 v[44:47], a[212:215], a[116:119], v[44:47]
    buffer_load_dwordx2 v[236:237], v242, s[28:31], s48 offen offset:2048 sc1
    v_mfma_f32_16x16x32_bf16 v[44:47], a[216:219], a[128:131], v[44:47]
    buffer_store_dwordx2 v[76:77], v242, s[28:31], s49 offen offset:2048 sc1
    v_mfma_f32_16x16x32_bf16 v[44:47], a[220:223], a[140:143], v[44:47]
    s_waitcnt lgkmcnt(0)
    s_add_u32 s49, s68, 4096
    buffer_store_dwordx4 v[52:55], v156, s[28:31], s68 offen offset:0 sc1
    s_barrier
    v_mfma_f32_16x16x32_bf16 v[36:39], a[224:227], a[144:147], v[36:39]
    s_add_u32 s46, s39, 8
    s_sub_u32 s46, s46, s56
    buffer_store_dwordx4 v[56:59], v156, s[28:31], s68 offen offset:1024 sc1
    v_mfma_f32_16x16x32_bf16 v[36:39], a[228:231], a[156:159], v[36:39]
    s_and_b32 s46, s46, 7
    s_lshl_b32 s57, s46, 2
    buffer_store_dwordx4 v[60:63], v156, s[28:31], s68 offen offset:2048 sc1
    v_mfma_f32_16x16x32_bf16 v[36:39], a[232:235], a[168:171], v[36:39]
    s_lshl_b32 s76, s39, 3
    s_add_u32 s76, s76, s46
    ds_read_b64_tr_b16 a[208:209], v104 offset:0
    v_mfma_f32_16x16x32_bf16 v[36:39], a[236:239], a[180:183], v[36:39]
    s_lshl_b32 s76, s76, 2
    s_add_u32 s76, s76, s36
    ds_read_b64_tr_b16 a[210:211], v104 offset:2048
    v_mfma_f32_16x16x32_bf16 v[40:43], a[224:227], a[148:151], v[40:43]
    s_mul_i32 s76, s76, 7168
    s_cmp_ge_u32 s56, 1
    ds_read_b64_tr_b16 a[212:213], v105 offset:0
    v_mfma_f32_16x16x32_bf16 v[40:43], a[228:231], a[160:163], v[40:43]
    s_cselect_b32 s76, s76, 0x40000000
    v_cvt_pk_bf16_f32 v66, v36, v37
    v_cvt_pk_bf16_f32 v67, v38, v39
    v_mfma_f32_16x16x32_bf16 v[40:43], a[232:235], a[172:175], v[40:43]
    s_cselect_b32 s79, 1, 0
    buffer_store_dwordx4 v[64:67], v156, s[28:31], s68 offen offset:3072 sc1
    v_mfma_f32_16x16x32_bf16 v[40:43], a[236:239], a[184:187], v[40:43]
    s_add_u32 s56, s56, 1
    ds_read_b64_tr_b16 a[214:215], v105 offset:2048
    ds_read_b64_tr_b16 a[216:217], v106 offset:0
    v_mfma_f32_16x16x32_bf16 v[44:47], a[224:227], a[152:155], v[44:47]
    ds_read_b64_tr_b16 a[218:219], v106 offset:2048
    v_mfma_f32_16x16x32_bf16 v[44:47], a[228:231], a[164:167], v[44:47]
    ds_read_b64_tr_b16 a[220:221], v107 offset:0
    v_mfma_f32_16x16x32_bf16 v[44:47], a[232:235], a[176:179], v[44:47]
    v_cvt_pk_bf16_f32 v70, v40, v41
    v_cvt_pk_bf16_f32 v71, v42, v43
    v_mfma_f32_16x16x32_bf16 v[44:47], a[236:239], a[188:191], v[44:47]
    buffer_store_dwordx4 v[68:71], v156, s[28:31], s49 offen offset:0 sc1
    ds_read_b64_tr_b16 a[222:223], v107 offset:2048
    s_nop 5
    v_cvt_pk_bf16_f32 v74, v44, v45
    v_cvt_pk_bf16_f32 v75, v46, v47
    buffer_store_dwordx4 v[72:75], v156, s[28:31], s49 offen offset:1024 sc1
    buffer_load_dword v244, v245, s[0:3], s57 offen sc1
    s_cmp_lt_u32 s56, 8
    s_cbranch_scc1 L_pass
    s_waitcnt vmcnt(0)
    v_cmp_le_u32 vcc, s79, v244
    s_nop 3
    s_cmp_eq_u64 vcc, -1
    s_cbranch_scc0 L_spin2
L_spin2_ret:
    buffer_load_dwordx4 v[80:83], v156, s[28:31], s76 offen offset:0 sc1
    buffer_load_dwordx4 v[84:87], v156, s[28:31], s76 offen offset:1024 sc1
    buffer_load_dwordx4 v[88:91], v156, s[28:31], s76 offen offset:2048 sc1
    s_mul_i32 s68, s36, 49152
    buffer_load_dwordx4 v[92:95], v156, s[28:31], s76 offen offset:3072 sc1
    s_sub_u32 s69, 196608, s68
    s_lshl_b32 s80, s39, 7
    s_add_u32 s68, s68, s80
    s_add_u32 s48, s76, 4096
    buffer_load_dwordx4 v[96:99], v156, s[28:31], s48 offen offset:0 sc1
    buffer_load_dwordx4 v[100:103], v156, s[28:31], s48 offen offset:1024 sc1
    buffer_load_dwordx2 v[158:159], v242, s[28:31], s48 offen offset:2048 sc1
    v_lshlrev_b32 v238, 16, v212
    v_and_b32 v239, 0xffff0000, v212
    v_add_f32 v160, v160, v238
    v_add_f32 v161, v161, v239
    v_lshlrev_b32 v240, 16, v213
    v_and_b32 v241, 0xffff0000, v213
    v_add_f32 v162, v162, v240
    v_add_f32 v163, v163, v241
    v_lshlrev_b32 v238, 16, v214
    v_and_b32 v239, 0xffff0000, v214
    v_add_f32 v164, v164, v238
    v_add_f32 v165, v165, v239
    v_lshlrev_b32 v240, 16, v215
    v_and_b32 v241, 0xffff0000, v215
    v_add_f32 v166, v166, v240
    v_add_f32 v167, v167, v241
    v_lshlrev_b32 v238, 16, v216
    v_and_b32 v239, 0xffff0000, v216
    v_add_f32 v168, v168, v238
    v_add_f32 v169, v169, v239
    v_lshlrev_b32 v240, 16, v217
    v_and_b32 v241, 0xffff0000, v217
    v_add_f32 v170, v170, v240
    v_add_f32 v171, v171, v241
    v_lshlrev_b32 v238, 16, v218
    v_and_b32 v239, 0xffff0000, v218
    v_add_f32 v172, v172, v238
    v_add_f32 v173, v173, v239
    v_lshlrev_b32 v240, 16, v219
    v_and_b32 v241, 0xffff0000, v219
    v_add_f32 v174, v174, v240
    v_add_f32 v175, v175, v241
    v_lshlrev_b32 v238, 16, v220
    v_and_b32 v239, 0xffff0000, v220
    v_add_f32 v176, v176, v238
    v_add_f32 v177, v177, v239
    v_lshlrev_b32 v240, 16, v221
    v_and_b32 v241, 0xffff0000, v221
    v_add_f32 v178, v178, v240
    v_add_f32 v179, v179, v241
    v_lshlrev_b32 v238, 16, v222
    v_and_b32 v239, 0xffff0000, v222
    v_add_f32 v180, v180, v238
    v_add_f32 v181, v181, v239
    v_lshlrev_b32 v240, 16, v223
    v_and_b32 v241, 0xffff0000, v223
    v_add_f32 v182, v182, v240
    v_add_f32 v183, v183, v241
    v_lshlrev_b32 v238, 16, v224
    v_and_b32 v239, 0xffff0000, v224
    v_add_f32 v184, v184, v238
    v_add_f32 v185, v185, v239
    v_lshlrev_b32 v240, 16, v225
    v_and_b32 v241, 0xffff0000, v225
    v_add_f32 v186, v186, v240
    v_add_f32 v187, v187, v241
    v_lshlrev_b32 v238, 16, v226
    v_and_b32 v239, 0xffff0000, v226
    v_add_f32 v188, v188, v238
    v_add_f32 v189, v189, v239
    v_lshlrev_b32 v240, 16, v227
    v_and_b32 v241, 0xffff0000, v227
    v_add_f32 v190, v190, v240
    v_add_f32 v191, v191, v241
    v_lshlrev_b32 v238, 16, v228
    v_and_b32 v239, 0xffff0000, v228
    v_add_f32 v192, v192, v238
    v_add_f32 v193, v193, v239
    v_lshlrev_b32 v240, 16, v229
    v_and_b32 v241, 0xffff0000, v229
    s_xor_b32 s80, s36, 0
    v_add_f32 v194, v194, v240
    v_add_f32 v195, v195, v241
    v_lshlrev_b32 v238, 16, v230
    v_and_b32 v239, 0xffff0000, v230
    s_lshl_b32 s80, s80, 5
    v_add_f32 v196, v196, v238
    v_add_f32 v197, v197, v239
    v_lshlrev_b32 v240, 16, v231
    v_and_b32 v241, 0xffff0000, v231
    s_add_u32 s80, s80, s68
    v_add_f32 v198, v198, v240
    v_add_f32 v199, v199, v241
    v_lshlrev_b32 v238, 16, v232
    v_and_b32 v239, 0xffff0000, v232
    s_xor_b32 s81, s36, 1
    v_add_f32 v200, v200, v238
    v_add_f32 v201, v201, v239
    v_lshlrev_b32 v240, 16, v233
    v_and_b32 v241, 0xffff0000, v233
    s_lshl_b32 s81, s81, 5
    v_add_f32 v202, v202, v240
    v_add_f32 v203, v203, v241
    v_lshlrev_b32 v238, 16, v234
    v_and_b32 v239, 0xffff0000, v234
    s_add_u32 s81, s81, s68
    v_add_f32 v204, v204, v238
    v_add_f32 v205, v205, v239
    v_lshlrev_b32 v240, 16, v235
    v_and_b32 v241, 0xffff0000, v235
    s_xor_b32 s82, s36, 0
    v_add_f32 v206, v206, v240
    v_add_f32 v207, v207, v241
    v_lshlrev_b32 v238, 16, v236
    v_and_b32 v239, 0xffff0000, v236
    s_lshl_b32 s82, s82, 5
    v_add_f32 v208, v208, v238
    v_add_f32 v209, v209, v239
    v_lshlrev_b32 v240, 16, v237
    v_and_b32 v241, 0xffff0000, v237
    s_add_u32 s82, s82, s68
    v_add_f32 v210, v210, v240
    v_add_f32 v211, v211, v241
    v_add_f32 v0, v0, v160
    v_add_f32 v1, v1, v161
    s_add_u32 s82, s82, 16384
    v_add_f32 v2, v2, v162
    v_add_f32 v3, v3, v163
    s_xor_b32 s83, s36, 1
    s_lshl_b32 s83, s83, 5
    s_add_u32 s83, s83, s68
    v_add_f32 v12, v12, v164
    v_add_f32 v13, v13, v165
    s_add_u32 s83, s83, 16384
    v_add_f32 v14, v14, v166
    v_add_f32 v15, v15, v167
    v_add_f32 v4, v4, v168
    v_add_f32 v5, v5, v169
    v_add_f32 v6, v6, v170
    v_add_f32 v7, v7, v171
    v_add_f32 v16, v16, v172
    v_add_f32 v17, v17, v173
    v_add_f32 v18, v18, v174
    v_add_f32 v19, v19, v175
    v_add_f32 v8, v8, v176
    v_add_f32 v9, v9, v177
    v_add_f32 v10, v10, v178
    v_add_f32 v11, v11, v179
    v_add_f32 v20, v20, v180
    v_add_f32 v21, v21, v181
    v_add_f32 v22, v22, v182
    v_add_f32 v23, v23, v183
    v_add_f32 v24, v24, v184
    v_add_f32 v25, v25, v185
    v_add_f32 v26, v26, v186
    v_add_f32 v27, v27, v187
    v_add_f32 v36, v36, v188
    v_add_f32 v37, v37, v189
    v_add_f32 v38, v38, v190
    v_add_f32 v39, v39, v191
    v_add_f32 v28, v28, v192
    v_add_f32 v29, v29, v193
    v_add_f32 v30, v30, v194
    v_add_f32 v31, v31, v195
    v_add_f32 v40, v40, v196
    v_add_f32 v41, v41, v197
    v_add_f32 v42, v42, v198
    v_add_f32 v43, v43, v199
    v_add_f32 v32, v32, v200
    v_add_f32 v33, v33, v201
    v_add_f32 v34, v34, v202
    v_add_f32 v35, v35, v203
    v_add_f32 v44, v44, v204
    v_add_f32 v45, v45, v205
    v_add_f32 v46, v46, v206
    v_add_f32 v47, v47, v207
    v_add_f32 v48, v48, v208
    v_add_f32 v49, v49, v209
    v_add_f32 v50, v50, v210
    v_add_f32 v51, v51, v211
    s_waitcnt vmcnt(6)
    v_lshlrev_b32 v238, 16, v80
    v_and_b32 v239, 0xffff0000, v80
    v_add_f32 v0, v0, v238
    v_add_f32 v1, v1, v239
    v_lshlrev_b32 v240, 16, v81
    v_and_b32 v241, 0xffff0000, v81
    v_add_f32 v2, v2, v240
    v_add_f32 v3, v3, v241
    v_cvt_pk_bf16_f32 v0, v0, v1
    v_cvt_pk_bf16_f32 v1, v2, v3
    v_lshlrev_b32 v238, 16, v82
    v_and_b32 v239, 0xffff0000, v82
    buffer_store_dwordx2 v[0:1], v248, s[72:75], s80 offen offset:0 nt
    v_add_f32 v12, v12, v238
    v_add_f32 v13, v13, v239
    v_lshlrev_b32 v240, 16, v83
    v_and_b32 v241, 0xffff0000, v83
    s_xor_b32 s80, s36, 0
    v_add_f32 v14, v14, v240
    v_add_f32 v15, v15, v241
    v_cvt_pk_bf16_f32 v12, v12, v13
    s_lshl_b32 s80, s80, 5
    v_cvt_pk_bf16_f32 v13, v14, v15
    s_add_u32 s80, s80, s68
    s_waitcnt vmcnt(6)
    v_lshlrev_b32 v238, 16, v84
    v_and_b32 v239, 0xffff0000, v84
    buffer_store_dwordx2 v[12:13], v248, s[72:75], s81 offen offset:0 nt
    s_add_u32 s80, s80, 32768
    v_add_f32 v4, v4, v238
    v_add_f32 v5, v5, v239
    v_lshlrev_b32 v240, 16, v85
    v_and_b32 v241, 0xffff0000, v85
    s_xor_b32 s81, s36, 1
    v_add_f32 v6, v6, v240
    v_add_f32 v7, v7, v241
    v_cvt_pk_bf16_f32 v4, v4, v5
    s_lshl_b32 s81, s81, 5
    v_lshlrev_b32 v238, 16, v86
    v_and_b32 v239, 0xffff0000, v86
    v_cvt_pk_bf16_f32 v5, v6, v7
    s_add_u32 s81, s81, s68
    v_add_f32 v16, v16, v238
    v_add_f32 v17, v17, v239
    v_lshlrev_b32 v240, 16, v87
    v_and_b32 v241, 0xffff0000, v87
    buffer_store_dwordx2 v[4:5], v248, s[72:75], s82 offen offset:0 nt
    s_add_u32 s81, s81, 32768
    v_add_f32 v18, v18, v240
    v_add_f32 v19, v19, v241
    v_cvt_pk_bf16_f32 v16, v16, v17
    s_xor_b32 s82, s36, 2
    s_waitcnt vmcnt(7)
    v_lshlrev_b32 v238, 16, v88
    v_and_b32 v239, 0xffff0000, v88
    v_cvt_pk_bf16_f32 v17, v18, v19
    s_lshl_b32 s82, s82, 5
    v_add_f32 v8, v8, v238
    v_add_f32 v9, v9, v239
    v_lshlrev_b32 v240, 16, v89
    v_and_b32 v241, 0xffff0000, v89
    buffer_store_dwordx2 v[16:17], v248, s[72:75], s83 offen offset:0 nt
    s_add_u32 s82, s82, s68
    v_add_f32 v10, v10, v240
    v_add_f32 v11, v11, v241
    v_cvt_pk_bf16_f32 v8, v8, v9
    s_xor_b32 s83, s36, 3
    v_cvt_pk_bf16_f32 v9, v10, v11
    s_lshl_b32 s83, s83, 5
    v_lshlrev_b32 v238, 16, v90
    v_and_b32 v239, 0xffff0000, v90
    buffer_store_dwordx2 v[8:9], v248, s[72:75], s80 offen offset:0 nt
    s_add_u32 s83, s83, s68
    v_add_f32 v20, v20, v238
    v_add_f32 v21, v21, v239
    v_lshlrev_b32 v240, 16, v91
    v_and_b32 v241, 0xffff0000, v91
    s_xor_b32 s80, s36, 2
    v_add_f32 v22, v22, v240
    v_add_f32 v23, v23, v241
    v_cvt_pk_bf16_f32 v20, v20, v21
    s_lshl_b32 s80, s80, 5
    v_cvt_pk_bf16_f32 v21, v22, v23
    s_add_u32 s80, s80, s68
    s_waitcnt vmcnt(8)
    v_lshlrev_b32 v238, 16, v92
    v_and_b32 v239, 0xffff0000, v92
    buffer_store_dwordx2 v[20:21], v248, s[72:75], s81 offen offset:0 nt
    s_add_u32 s80, s80, 16384
    v_add_f32 v24, v24, v238
    v_add_f32 v25, v25, v239
    v_lshlrev_b32 v240, 16, v93
    v_and_b32 v241, 0xffff0000, v93
    s_xor_b32 s81, s36, 3
    v_add_f32 v26, v26, v240
    v_add_f32 v27, v27, v241
    v_cvt_pk_bf16_f32 v24, v24, v25
    s_lshl_b32 s81, s81, 5
    v_lshlrev_b32 v238, 16, v94
    v_and_b32 v239, 0xffff0000, v94
    v_cvt_pk_bf16_f32 v25, v26, v27
    s_add_u32 s81, s81, s68
    v_add_f32 v36, v36, v238
    v_add_f32 v37, v37, v239
    v_lshlrev_b32 v240, 16, v95
    v_and_b32 v241, 0xffff0000, v95
    buffer_store_dwordx2 v[24:25], v248, s[72:75], s82 offen offset:0 nt
    s_add_u32 s81, s81, 16384
    v_add_f32 v38, v38, v240
    v_add_f32 v39, v39, v241
    s_waitcnt vmcnt(9)
    v_lshlrev_b32 v238, 16, v96
    v_and_b32 v239, 0xffff0000, v96
    s_xor_b32 s82, s36, 2
    v_add_f32 v28, v28, v238
    v_add_f32 v29, v29, v239
    v_lshlrev_b32 v240, 16, v97
    v_and_b32 v241, 0xffff0000, v97
    v_cvt_pk_bf16_f32 v36, v36, v37
    s_lshl_b32 s82, s82, 5
    v_add_f32 v30, v30, v240
    v_add_f32 v31, v31, v241
    v_lshlrev_b32 v238, 16, v98
    v_and_b32 v239, 0xffff0000, v98
    v_cvt_pk_bf16_f32 v37, v38, v39
    s_add_u32 s82, s82, s68
    v_add_f32 v40, v40, v238
    v_add_f32 v41, v41, v239
    v_lshlrev_b32 v240, 16, v99
    v_and_b32 v241, 0xffff0000, v99
    buffer_store_dwordx2 v[36:37], v248, s[72:75], s83 offen offset:0 nt
    s_add_u32 s82, s82, 32768
    v_add_f32 v42, v42, v240
    v_add_f32 v43, v43, v241
    s_waitcnt vmcnt(9)
    v_lshlrev_b32 v238, 16, v100
    v_and_b32 v239, 0xffff0000, v100
    s_xor_b32 s83, s36, 3
    v_add_f32 v32, v32, v238
    v_add_f32 v33, v33, v239
    v_lshlrev_b32 v240, 16, v101
    v_and_b32 v241, 0xffff0000, v101
    v_cvt_pk_bf16_f32 v28, v28, v29
    s_lshl_b32 s83, s83, 5
    v_add_f32 v34, v34, v240
    v_add_f32 v35, v35, v241
    v_lshlrev_b32 v238, 16, v102
    v_and_b32 v239, 0xffff0000, v102
    v_cvt_pk_bf16_f32 v29, v30, v31
    s_add_u32 s83, s83, s68
    v_add_f32 v44, v44, v238
    v_add_f32 v45, v45, v239
    v_lshlrev_b32 v240, 16, v103
    v_and_b32 v241, 0xffff0000, v103
    buffer_store_dwordx2 v[28:29], v248, s[72:75], s80 offen offset:0 nt
    v_cvt_pk_bf16_f32 v40, v40, v41
    s_add_u32 s83, s83, 32768
    v_add_f32 v46, v46, v240
    v_add_f32 v47, v47, v241
    s_waitcnt vmcnt(9)
    v_lshlrev_b32 v238, 16, v158
    v_and_b32 v239, 0xffff0000, v158
    v_cvt_pk_bf16_f32 v41, v42, v43
    v_cvt_pk_bf16_f32 v32, v32, v33
    s_xor_b32 s80, s36, 0
    v_add_f32 v48, v48, v238
    v_add_f32 v49, v49, v239
    v_lshlrev_b32 v240, 16, v159
    v_and_b32 v241, 0xffff0000, v159
    buffer_store_dwordx2 v[40:41], v248, s[72:75], s81 offen offset:0 nt
    v_cvt_pk_bf16_f32 v33, v34, v35
    v_cvt_pk_bf16_f32 v44, v44, v45
    s_lshl_b32 s80, s80, 5
    v_add_f32 v50, v50, v240
    v_add_f32 v51, v51, v241
    buffer_store_dwordx2 v[32:33], v248, s[72:75], s82 offen offset:0 nt
    v_cvt_pk_bf16_f32 v45, v46, v47
    v_cvt_pk_bf16_f32 v48, v48, v49
    s_add_u32 s80, s80, s68
    buffer_store_dwordx2 v[44:45], v248, s[72:75], s83 offen offset:0 nt
    v_cvt_pk_bf16_f32 v49, v50, v51
    s_add_u32 s80, s80, s69
    buffer_store_dwordx2 v[48:49], v248, s[72:75], s80 offen offset:0 nt
L_exit:
    s_endpgm
L_slow:
    s_waitcnt vmcnt(0) lgkmcnt(0)
    s_nop 15
    v_mbcnt_lo_u32_b32 v198, -1, 0
    v_mbcnt_hi_u32_b32 v198, -1, v198
    v_and_b32 v199, 15, v198
    v_lshrrev_b32 v200, 4, v198
    v_lshlrev_b32 v201, 8, v199
    v_lshl_add_u32 v201, v200, 4, v201
    s_xor_b32 s80, s36, 0
    s_lshl_b32 s80, s80, 6
    v_add_u32 v208, s80, v201
    s_xor_b32 s80, s36, 1
    s_lshl_b32 s80, s80, 6
    v_add_u32 v209, s80, v201
    s_xor_b32 s80, s36, 2
    s_lshl_b32 s80, s80, 6
    v_add_u32 v210, s80, v201
    s_xor_b32 s80, s36, 3
    s_lshl_b32 s80, s80, 6
    v_add_u32 v211, s80, v201
    v_lshlrev_b32 v196, 10, v200
    v_lshl_add_u32 v196, v199, 1, v196
    v_add_u32 v197, 0x1000, v196
    s_sub_u32 s82, s40, s41
    v_mov_b32 v204, 0xff800000
    v_mov_b32 v205, 0xff800000
    v_mov_b32 v206, 0xff800000
    v_mov_b32 v207, 0xff800000
    s_mov_b32 s83, s82
    s_add_u32 s81, s82, 0x20000
L_slow_max:
    buffer_load_dwordx4 a[208:211], v208, s[20:23], s83 offen
    buffer_load_dwordx4 a[212:215], v209, s[20:23], s83 offen
    buffer_load_dwordx4 a[216:219], v210, s[20:23], s83 offen
    buffer_load_dwordx4 a[220:223], v211, s[20:23], s83 offen
    s_waitcnt vmcnt(0)
    v_mfma_f32_16x16x32_bf16 v[132:135], a[208:211], a[144:147], 0
    v_mfma_f32_16x16x32_bf16 v[132:135], a[212:215], a[156:159], v[132:135]
    v_mfma_f32_16x16x32_bf16 v[132:135], a[216:219], a[168:171], v[132:135]
    v_mfma_f32_16x16x32_bf16 v[132:135], a[220:223], a[180:183], v[132:135]
    v_mfma_f32_16x16x32_bf16 v[136:139], a[208:211], a[148:151], 0
    v_mfma_f32_16x16x32_bf16 v[136:139], a[212:215], a[160:163], v[136:139]
    v_mfma_f32_16x16x32_bf16 v[136:139], a[216:219], a[172:175], v[136:139]
    v_mfma_f32_16x16x32_bf16 v[136:139], a[220:223], a[184:187], v[136:139]
    v_mfma_f32_16x16x32_bf16 v[140:143], a[208:211], a[152:155], 0
    v_mfma_f32_16x16x32_bf16 v[140:143], a[212:215], a[164:167], v[140:143]
    v_mfma_f32_16x16x32_bf16 v[140:143], a[216:219], a[176:179], v[140:143]
    v_mfma_f32_16x16x32_bf16 v[140:143], a[220:223], a[188:191], v[140:143]
    v_mfma_f32_16x16x32_bf16 v[144:147], a[208:211], a[192:195], 0
    v_mfma_f32_16x16x32_bf16 v[144:147], a[212:215], a[196:199], v[144:147]
    v_mfma_f32_16x16x32_bf16 v[144:147], a[216:219], a[200:203], v[144:147]
    v_mfma_f32_16x16x32_bf16 v[144:147], a[220:223], a[204:207], v[144:147]
    s_nop 15
    v_max3_f32 v204, v204, v132, v133
    v_max3_f32 v204, v204, v134, v135
    v_max3_f32 v205, v205, v136, v137
    v_max3_f32 v205, v205, v138, v139
    v_max3_f32 v206, v206, v140, v141
    v_max3_f32 v206, v206, v142, v143
    v_max3_f32 v207, v207, v144, v145
    v_max3_f32 v207, v207, v146, v147
    s_add_u32 s83, s83, 0x1000
    s_cmp_lt_u32 s83, s81
    s_cbranch_scc1 L_slow_max
    v_xor_b32 v202, 16, v198
    v_lshlrev_b32 v202, 2, v202
    ds_bpermute_b32 v203, v202, v204
    s_waitcnt lgkmcnt(0)
    v_max_f32 v204, v204, v203
    ds_bpermute_b32 v203, v202, v205
    s_waitcnt lgkmcnt(0)
    v_max_f32 v205, v205, v203
    ds_bpermute_b32 v203, v202, v206
    s_waitcnt lgkmcnt(0)
    v_max_f32 v206, v206, v203
    ds_bpermute_b32 v203, v202, v207
    s_waitcnt lgkmcnt(0)
    v_max_f32 v207, v207, v203
    v_xor_b32 v202, 32, v198
    v_lshlrev_b32 v202, 2, v202
    ds_bpermute_b32 v203, v202, v204
    s_waitcnt lgkmcnt(0)
    v_max_f32 v204, v204, v203
    ds_bpermute_b32 v203, v202, v205
    s_waitcnt lgkmcnt(0)
    v_max_f32 v205, v205, v203
    ds_bpermute_b32 v203, v202, v206
    s_waitcnt lgkmcnt(0)
    v_max_f32 v206, v206, v203
    ds_bpermute_b32 v203, v202, v207
    s_waitcnt lgkmcnt(0)
    v_max_f32 v207, v207, v203
    v_sub_f32 v204, 0, v204
    v_sub_f32 v205, 0, v205
    v_sub_f32 v206, 0, v206
    v_sub_f32 v207, 0, v207
    v_mov_b32 v0, 0
    v_mov_b32 v1, 0
    v_mov_b32 v2, 0
    v_mov_b32 v3, 0
    v_mov_b32 v4, 0
    v_mov_b32 v5, 0
    v_mov_b32 v6, 0
    v_mov_b32 v7, 0
    v_mov_b32 v8, 0
    v_mov_b32 v9, 0
    v_mov_b32 v10, 0
    v_mov_b32 v11, 0
    v_mov_b32 v12, 0
    v_mov_b32 v13, 0
    v_mov_b32 v14, 0
    v_mov_b32 v15, 0
    v_mov_b32 v16, 0
    v_mov_b32 v17, 0
    v_mov_b32 v18, 0
    v_mov_b32 v19, 0
    v_mov_b32 v20, 0
    v_mov_b32 v21, 0
    v_mov_b32 v22, 0
    v_mov_b32 v23, 0
    v_mov_b32 v24, 0
    v_mov_b32 v25, 0
    v_mov_b32 v26, 0
    v_mov_b32 v27, 0
    v_mov_b32 v28, 0
    v_mov_b32 v29, 0
    v_mov_b32 v30, 0
    v_mov_b32 v31, 0
    v_mov_b32 v32, 0
    v_mov_b32 v33, 0
    v_mov_b32 v34, 0
    v_mov_b32 v35, 0
    v_mov_b32 v36, 0
    v_mov_b32 v37, 0
    v_mov_b32 v38, 0
    v_mov_b32 v39, 0
    v_mov_b32 v40, 0
    v_mov_b32 v41, 0
    v_mov_b32 v42, 0
    v_mov_b32 v43, 0
    v_mov_b32 v44, 0
    v_mov_b32 v45, 0
    v_mov_b32 v46, 0
    v_mov_b32 v47, 0
    v_mov_b32 v48, 0
    v_mov_b32 v49, 0
    v_mov_b32 v50, 0
    v_mov_b32 v51, 0
    v_mov_b32 v52, 0
    v_mov_b32 v53, 0
    v_mov_b32 v54, 0
    v_mov_b32 v55, 0
    v_mov_b32 v56, 0
    v_mov_b32 v57, 0
    v_mov_b32 v58, 0
    v_mov_b32 v59, 0
    v_mov_b32 v60, 0
    v_mov_b32 v61, 0
    v_mov_b32 v62, 0
    v_mov_b32 v63, 0
    v_mov_b32 v64, 0
    v_mov_b32 v65, 0
    v_mov_b32 v66, 0
    v_mov_b32 v67, 0
    v_mov_b32 v68, 0
    v_mov_b32 v69, 0
    v_mov_b32 v70, 0
    v_mov_b32 v71, 0
    v_mov_b32 v72, 0
    v_mov_b32 v73, 0
    v_mov_b32 v74, 0
    v_mov_b32 v75, 0
    v_mov_b32 v76, 0
    v_mov_b32 v77, 0
    v_mov_b32 v78, 0
    v_mov_b32 v79, 0
    v_mov_b32 v80, 0
    v_mov_b32 v81, 0
    v_mov_b32 v82, 0
    v_mov_b32 v83, 0
    v_mov_b32 v84, 0
    v_mov_b32 v85, 0
    v_mov_b32 v86, 0
    v_mov_b32 v87, 0
    v_mov_b32 v88, 0
    v_mov_b32 v89, 0
    v_mov_b32 v90, 0
    v_mov_b32 v91, 0
    v_mov_b32 v92, 0
    v_mov_b32 v93, 0
    v_mov_b32 v94, 0
    v_mov_b32 v95, 0
    v_mov_b32 v96, 0
    v_mov_b32 v97, 0
    v_mov_b32 v98, 0
    v_mov_b32 v99, 0
    v_mov_b32 v100, 0
    v_mov_b32 v101, 0
    v_mov_b32 v102, 0
    v_mov_b32 v103, 0
    v_mov_b32 v104, 0
    v_mov_b32 v105, 0
    v_mov_b32 v106, 0
    v_mov_b32 v107, 0
    v_mov_b32 v108, 0
    v_mov_b32 v109, 0
    v_mov_b32 v110, 0
    v_mov_b32 v111, 0
    v_mov_b32 v112, 0
    v_mov_b32 v113, 0
    v_mov_b32 v114, 0
    v_mov_b32 v115, 0
    v_mov_b32 v116, 0
    v_mov_b32 v117, 0
    v_mov_b32 v118, 0
    v_mov_b32 v119, 0
    s_mov_b32 s83, s82
L_slow_pv:
    s_add_u32 s80, s83, 0
    buffer_load_dwordx4 a[208:211], v208, s[20:23], s80 offen
    buffer_load_dwordx4 a[212:215], v209, s[20:23], s80 offen
    buffer_load_dwordx4 a[216:219], v210, s[20:23], s80 offen
    buffer_load_dwordx4 a[220:223], v211, s[20:23], s80 offen
    s_waitcnt vmcnt(0)
    v_mov_b32 v132, v204
    v_mov_b32 v133, v204
    v_mov_b32 v134, v204
    v_mov_b32 v135, v204
    v_mov_b32 v136, v205
    v_mov_b32 v137, v205
    v_mov_b32 v138, v205
    v_mov_b32 v139, v205
    v_mov_b32 v140, v206
    v_mov_b32 v141, v206
    v_mov_b32 v142, v206
    v_mov_b32 v143, v206
    v_mov_b32 v144, v207
    v_mov_b32 v145, v207
    v_mov_b32 v146, v207
    v_mov_b32 v147, v207
    s_nop 1
    v_mfma_f32_16x16x32_bf16 v[132:135], a[208:211], a[144:147], v[132:135]
    v_mfma_f32_16x16x32_bf16 v[132:135], a[212:215], a[156:159], v[132:135]
    v_mfma_f32_16x16x32_bf16 v[132:135], a[216:219], a[168:171], v[132:135]
    v_mfma_f32_16x16x32_bf16 v[132:135], a[220:223], a[180:183], v[132:135]
    v_mfma_f32_16x16x32_bf16 v[136:139], a[208:211], a[148:151], v[136:139]
    v_mfma_f32_16x16x32_bf16 v[136:139], a[212:215], a[160:163], v[136:139]
    v_mfma_f32_16x16x32_bf16 v[136:139], a[216:219], a[172:175], v[136:139]
    v_mfma_f32_16x16x32_bf16 v[136:139], a[220:223], a[184:187], v[136:139]
    v_mfma_f32_16x16x32_bf16 v[140:143], a[208:211], a[152:155], v[140:143]
    v_mfma_f32_16x16x32_bf16 v[140:143], a[212:215], a[164:167], v[140:143]
    v_mfma_f32_16x16x32_bf16 v[140:143], a[216:219], a[176:179], v[140:143]
    v_mfma_f32_16x16x32_bf16 v[140:143], a[220:223], a[188:191], v[140:143]
    v_mfma_f32_16x16x32_bf16 v[144:147], a[208:211], a[192:195], v[144:147]
    v_mfma_f32_16x16x32_bf16 v[144:147], a[212:215], a[196:199], v[144:147]
    v_mfma_f32_16x16x32_bf16 v[144:147], a[216:219], a[200:203], v[144:147]
    v_mfma_f32_16x16x32_bf16 v[144:147], a[220:223], a[204:207], v[144:147]
    s_nop 15
    v_exp_f32 v132, v132
    v_exp_f32 v133, v133
    v_exp_f32 v134, v134
    v_exp_f32 v135, v135
    v_exp_f32 v136, v136
    v_exp_f32 v137, v137
    v_exp_f32 v138, v138
    v_exp_f32 v139, v139
    v_exp_f32 v140, v140
    v_exp_f32 v141, v141
    v_exp_f32 v142, v142
    v_exp_f32 v143, v143
    v_exp_f32 v144, v144
    v_exp_f32 v145, v145
    v_exp_f32 v146, v146
    v_exp_f32 v147, v147
    s_nop 1
    v_cvt_pk_bf16_f32 v148, v132, v133
    v_cvt_pk_bf16_f32 v149, v134, v135
    v_cvt_pk_bf16_f32 v152, v136, v137
    v_cvt_pk_bf16_f32 v153, v138, v139
    v_cvt_pk_bf16_f32 v156, v140, v141
    v_cvt_pk_bf16_f32 v157, v142, v143
    v_cvt_pk_bf16_f32 v160, v144, v145
    v_cvt_pk_bf16_f32 v161, v146, v147
    s_add_u32 s80, s83, 4096
    buffer_load_dwordx4 a[208:211], v208, s[20:23], s80 offen
    buffer_load_dwordx4 a[212:215], v209, s[20:23], s80 offen
    buffer_load_dwordx4 a[216:219], v210, s[20:23], s80 offen
    buffer_load_dwordx4 a[220:223], v211, s[20:23], s80 offen
    s_waitcnt vmcnt(0)
    v_mov_b32 v132, v204
    v_mov_b32 v133, v204
    v_mov_b32 v134, v204
    v_mov_b32 v135, v204
    v_mov_b32 v136, v205
    v_mov_b32 v137, v205
    v_mov_b32 v138, v205
    v_mov_b32 v139, v205
    v_mov_b32 v140, v206
    v_mov_b32 v141, v206
    v_mov_b32 v142, v206
    v_mov_b32 v143, v206
    v_mov_b32 v144, v207
    v_mov_b32 v145, v207
    v_mov_b32 v146, v207
    v_mov_b32 v147, v207
    s_nop 1
    v_mfma_f32_16x16x32_bf16 v[132:135], a[208:211], a[144:147], v[132:135]
    v_mfma_f32_16x16x32_bf16 v[132:135], a[212:215], a[156:159], v[132:135]
    v_mfma_f32_16x16x32_bf16 v[132:135], a[216:219], a[168:171], v[132:135]
    v_mfma_f32_16x16x32_bf16 v[132:135], a[220:223], a[180:183], v[132:135]
    v_mfma_f32_16x16x32_bf16 v[136:139], a[208:211], a[148:151], v[136:139]
    v_mfma_f32_16x16x32_bf16 v[136:139], a[212:215], a[160:163], v[136:139]
    v_mfma_f32_16x16x32_bf16 v[136:139], a[216:219], a[172:175], v[136:139]
    v_mfma_f32_16x16x32_bf16 v[136:139], a[220:223], a[184:187], v[136:139]
    v_mfma_f32_16x16x32_bf16 v[140:143], a[208:211], a[152:155], v[140:143]
    v_mfma_f32_16x16x32_bf16 v[140:143], a[212:215], a[164:167], v[140:143]
    v_mfma_f32_16x16x32_bf16 v[140:143], a[216:219], a[176:179], v[140:143]
    v_mfma_f32_16x16x32_bf16 v[140:143], a[220:223], a[188:191], v[140:143]
    v_mfma_f32_16x16x32_bf16 v[144:147], a[208:211], a[192:195], v[144:147]
    v_mfma_f32_16x16x32_bf16 v[144:147], a[212:215], a[196:199], v[144:147]
    v_mfma_f32_16x16x32_bf16 v[144:147], a[216:219], a[200:203], v[144:147]
    v_mfma_f32_16x16x32_bf16 v[144:147], a[220:223], a[204:207], v[144:147]
    s_nop 15
    v_exp_f32 v132, v132
    v_exp_f32 v133, v133
    v_exp_f32 v134, v134
    v_exp_f32 v135, v135
    v_exp_f32 v136, v136
    v_exp_f32 v137, v137
    v_exp_f32 v138, v138
    v_exp_f32 v139, v139
    v_exp_f32 v140, v140
    v_exp_f32 v141, v141
    v_exp_f32 v142, v142
    v_exp_f32 v143, v143
    v_exp_f32 v144, v144
    v_exp_f32 v145, v145
    v_exp_f32 v146, v146
    v_exp_f32 v147, v147
    s_nop 1
    v_cvt_pk_bf16_f32 v150, v132, v133
    v_cvt_pk_bf16_f32 v151, v134, v135
    v_cvt_pk_bf16_f32 v154, v136, v137
    v_cvt_pk_bf16_f32 v155, v138, v139
    v_cvt_pk_bf16_f32 v158, v140, v141
    v_cvt_pk_bf16_f32 v159, v142, v143
    v_cvt_pk_bf16_f32 v162, v144, v145
    v_cvt_pk_bf16_f32 v163, v146, v147
    s_nop 3
    v_mfma_f32_16x16x32_bf16 v[104:107], a[248:251], v[148:151], v[104:107]
    v_mfma_f32_16x16x32_bf16 v[108:111], a[248:251], v[152:155], v[108:111]
    v_mfma_f32_16x16x32_bf16 v[112:115], a[248:251], v[156:159], v[112:115]
    v_mfma_f32_16x16x32_bf16 v[116:119], a[248:251], v[160:163], v[116:119]
    s_lshl_b32 s80, s36, 1
    s_xor_b32 s80, s80, 0
    s_lshl_b32 s80, s80, 5
    s_add_u32 s80, s80, s83
    buffer_load_ushort v120, v196, s[24:27], s80 offen offset:0
    buffer_load_ushort v121, v196, s[24:27], s80 offen offset:256
    buffer_load_ushort v122, v196, s[24:27], s80 offen offset:512
    buffer_load_ushort v123, v196, s[24:27], s80 offen offset:768
    buffer_load_ushort v124, v197, s[24:27], s80 offen offset:0
    buffer_load_ushort v125, v197, s[24:27], s80 offen offset:256
    buffer_load_ushort v126, v197, s[24:27], s80 offen offset:512
    buffer_load_ushort v127, v197, s[24:27], s80 offen offset:768
    s_waitcnt vmcnt(0)
    v_lshl_or_b32 v128, v121, 16, v120
    v_lshl_or_b32 v129, v123, 16, v122
    v_lshl_or_b32 v130, v125, 16, v124
    v_lshl_or_b32 v131, v127, 16, v126
    s_nop 1
    v_mfma_f32_16x16x32_bf16 v[0:3], v[128:131], v[148:151], v[0:3]
    v_mfma_f32_16x16x32_bf16 v[4:7], v[128:131], v[152:155], v[4:7]
    v_mfma_f32_16x16x32_bf16 v[8:11], v[128:131], v[156:159], v[8:11]
    v_mfma_f32_16x16x32_bf16 v[96:99], v[128:131], v[160:163], v[96:99]
    s_nop 7
    s_lshl_b32 s80, s36, 1
    s_xor_b32 s80, s80, 1
    s_lshl_b32 s80, s80, 5
    s_add_u32 s80, s80, s83
    buffer_load_ushort v120, v196, s[24:27], s80 offen offset:0
    buffer_load_ushort v121, v196, s[24:27], s80 offen offset:256
    buffer_load_ushort v122, v196, s[24:27], s80 offen offset:512
    buffer_load_ushort v123, v196, s[24:27], s80 offen offset:768
    buffer_load_ushort v124, v197, s[24:27], s80 offen offset:0
    buffer_load_ushort v125, v197, s[24:27], s80 offen offset:256
    buffer_load_ushort v126, v197, s[24:27], s80 offen offset:512
    buffer_load_ushort v127, v197, s[24:27], s80 offen offset:768
    s_waitcnt vmcnt(0)
    v_lshl_or_b32 v128, v121, 16, v120
    v_lshl_or_b32 v129, v123, 16, v122
    v_lshl_or_b32 v130, v125, 16, v124
    v_lshl_or_b32 v131, v127, 16, v126
    s_nop 1
    v_mfma_f32_16x16x32_bf16 v[12:15], v[128:131], v[148:151], v[12:15]
    v_mfma_f32_16x16x32_bf16 v[16:19], v[128:131], v[152:155], v[16:19]
    v_mfma_f32_16x16x32_bf16 v[20:23], v[128:131], v[156:159], v[20:23]
    v_mfma_f32_16x16x32_bf16 v[100:103], v[128:131], v[160:163], v[100:103]
    s_nop 7
    s_lshl_b32 s80, s36, 1
    s_xor_b32 s80, s80, 2
    s_lshl_b32 s80, s80, 5
    s_add_u32 s80, s80, s83
    buffer_load_ushort v120, v196, s[24:27], s80 offen offset:0
    buffer_load_ushort v121, v196, s[24:27], s80 offen offset:256
    buffer_load_ushort v122, v196, s[24:27], s80 offen offset:512
    buffer_load_ushort v123, v196, s[24:27], s80 offen offset:768
    buffer_load_ushort v124, v197, s[24:27], s80 offen offset:0
    buffer_load_ushort v125, v197, s[24:27], s80 offen offset:256
    buffer_load_ushort v126, v197, s[24:27], s80 offen offset:512
    buffer_load_ushort v127, v197, s[24:27], s80 offen offset:768
    s_waitcnt vmcnt(0)
    v_lshl_or_b32 v128, v121, 16, v120
    v_lshl_or_b32 v129, v123, 16, v122
    v_lshl_or_b32 v130, v125, 16, v124
    v_lshl_or_b32 v131, v127, 16, v126
    s_nop 1
    v_mfma_f32_16x16x32_bf16 v[24:27], v[128:131], v[148:151], v[24:27]
    v_mfma_f32_16x16x32_bf16 v[28:31], v[128:131], v[152:155], v[28:31]
    v_mfma_f32_16x16x32_bf16 v[32:35], v[128:131], v[156:159], v[32:35]
    s_nop 7
    s_lshl_b32 s80, s36, 1
    s_xor_b32 s80, s80, 3
    s_lshl_b32 s80, s80, 5
    s_add_u32 s80, s80, s83
    buffer_load_ushort v120, v196, s[24:27], s80 offen offset:0
    buffer_load_ushort v121, v196, s[24:27], s80 offen offset:256
    buffer_load_ushort v122, v196, s[24:27], s80 offen offset:512
    buffer_load_ushort v123, v196, s[24:27], s80 offen offset:768
    buffer_load_ushort v124, v197, s[24:27], s80 offen offset:0
    buffer_load_ushort v125, v197, s[24:27], s80 offen offset:256
    buffer_load_ushort v126, v197, s[24:27], s80 offen offset:512
    buffer_load_ushort v127, v197, s[24:27], s80 offen offset:768
    s_waitcnt vmcnt(0)
    v_lshl_or_b32 v128, v121, 16, v120
    v_lshl_or_b32 v129, v123, 16, v122
    v_lshl_or_b32 v130, v125, 16, v124
    v_lshl_or_b32 v131, v127, 16, v126
    s_nop 1
    v_mfma_f32_16x16x32_bf16 v[36:39], v[128:131], v[148:151], v[36:39]
    v_mfma_f32_16x16x32_bf16 v[40:43], v[128:131], v[152:155], v[40:43]
    v_mfma_f32_16x16x32_bf16 v[44:47], v[128:131], v[156:159], v[44:47]
    s_nop 7
    s_lshl_b32 s80, s36, 1
    s_xor_b32 s80, s80, 4
    s_lshl_b32 s80, s80, 5
    s_add_u32 s80, s80, s83
    buffer_load_ushort v120, v196, s[24:27], s80 offen offset:0
    buffer_load_ushort v121, v196, s[24:27], s80 offen offset:256
    buffer_load_ushort v122, v196, s[24:27], s80 offen offset:512
    buffer_load_ushort v123, v196, s[24:27], s80 offen offset:768
    buffer_load_ushort v124, v197, s[24:27], s80 offen offset:0
    buffer_load_ushort v125, v197, s[24:27], s80 offen offset:256
    buffer_load_ushort v126, v197, s[24:27], s80 offen offset:512
    buffer_load_ushort v127, v197, s[24:27], s80 offen offset:768
    s_waitcnt vmcnt(0)
    v_lshl_or_b32 v128, v121, 16, v120
    v_lshl_or_b32 v129, v123, 16, v122
    v_lshl_or_b32 v130, v125, 16, v124
    v_lshl_or_b32 v131, v127, 16, v126
    s_nop 1
    v_mfma_f32_16x16x32_bf16 v[48:51], v[128:131], v[148:151], v[48:51]
    v_mfma_f32_16x16x32_bf16 v[52:55], v[128:131], v[152:155], v[52:55]
    v_mfma_f32_16x16x32_bf16 v[56:59], v[128:131], v[156:159], v[56:59]
    s_nop 7
    s_lshl_b32 s80, s36, 1
    s_xor_b32 s80, s80, 5
    s_lshl_b32 s80, s80, 5
    s_add_u32 s80, s80, s83
    buffer_load_ushort v120, v196, s[24:27], s80 offen offset:0
    buffer_load_ushort v121, v196, s[24:27], s80 offen offset:256
    buffer_load_ushort v122, v196, s[24:27], s80 offen offset:512
    buffer_load_ushort v123, v196, s[24:27], s80 offen offset:768
    buffer_load_ushort v124, v197, s[24:27], s80 offen offset:0
    buffer_load_ushort v125, v197, s[24:27], s80 offen offset:256
    buffer_load_ushort v126, v197, s[24:27], s80 offen offset:512
    buffer_load_ushort v127, v197, s[24:27], s80 offen offset:768
    s_waitcnt vmcnt(0)
    v_lshl_or_b32 v128, v121, 16, v120
    v_lshl_or_b32 v129, v123, 16, v122
    v_lshl_or_b32 v130, v125, 16, v124
    v_lshl_or_b32 v131, v127, 16, v126
    s_nop 1
    v_mfma_f32_16x16x32_bf16 v[60:63], v[128:131], v[148:151], v[60:63]
    v_mfma_f32_16x16x32_bf16 v[64:67], v[128:131], v[152:155], v[64:67]
    v_mfma_f32_16x16x32_bf16 v[68:71], v[128:131], v[156:159], v[68:71]
    s_nop 7
    s_lshl_b32 s80, s36, 1
    s_xor_b32 s80, s80, 6
    s_lshl_b32 s80, s80, 5
    s_add_u32 s80, s80, s83
    buffer_load_ushort v120, v196, s[24:27], s80 offen offset:0
    buffer_load_ushort v121, v196, s[24:27], s80 offen offset:256
    buffer_load_ushort v122, v196, s[24:27], s80 offen offset:512
    buffer_load_ushort v123, v196, s[24:27], s80 offen offset:768
    buffer_load_ushort v124, v197, s[24:27], s80 offen offset:0
    buffer_load_ushort v125, v197, s[24:27], s80 offen offset:256
    buffer_load_ushort v126, v197, s[24:27], s80 offen offset:512
    buffer_load_ushort v127, v197, s[24:27], s80 offen offset:768
    s_waitcnt vmcnt(0)
    v_lshl_or_b32 v128, v121, 16, v120
    v_lshl_or_b32 v129, v123, 16, v122
    v_lshl_or_b32 v130, v125, 16, v124
    v_lshl_or_b32 v131, v127, 16, v126
    s_nop 1
    v_mfma_f32_16x16x32_bf16 v[72:75], v[128:131], v[148:151], v[72:75]
    v_mfma_f32_16x16x32_bf16 v[76:79], v[128:131], v[152:155], v[76:79]
    v_mfma_f32_16x16x32_bf16 v[80:83], v[128:131], v[156:159], v[80:83]
    s_nop 7
    s_lshl_b32 s80, s36, 1
    s_xor_b32 s80, s80, 7
    s_lshl_b32 s80, s80, 5
    s_add_u32 s80, s80, s83
    buffer_load_ushort v120, v196, s[24:27], s80 offen offset:0
    buffer_load_ushort v121, v196, s[24:27], s80 offen offset:256
    buffer_load_ushort v122, v196, s[24:27], s80 offen offset:512
    buffer_load_ushort v123, v196, s[24:27], s80 offen offset:768
    buffer_load_ushort v124, v197, s[24:27], s80 offen offset:0
    buffer_load_ushort v125, v197, s[24:27], s80 offen offset:256
    buffer_load_ushort v126, v197, s[24:27], s80 offen offset:512
    buffer_load_ushort v127, v197, s[24:27], s80 offen offset:768
    s_waitcnt vmcnt(0)
    v_lshl_or_b32 v128, v121, 16, v120
    v_lshl_or_b32 v129, v123, 16, v122
    v_lshl_or_b32 v130, v125, 16, v124
    v_lshl_or_b32 v131, v127, 16, v126
    s_nop 1
    v_mfma_f32_16x16x32_bf16 v[84:87], v[128:131], v[148:151], v[84:87]
    v_mfma_f32_16x16x32_bf16 v[88:91], v[128:131], v[152:155], v[88:91]
    v_mfma_f32_16x16x32_bf16 v[92:95], v[128:131], v[156:159], v[92:95]
    s_nop 7
    s_add_u32 s83, s83, 0x2000
    s_cmp_lt_u32 s83, s81
    s_cbranch_scc1 L_slow_pv
    s_nop 15
    s_branch L_slow_ret
L_slow_ret:
    v_rcp_f32 v204, v104
    v_rcp_f32 v205, v108
    v_rcp_f32 v206, v112
    v_rcp_f32 v207, v116
    s_cmp_eq_u32 s37, 3
    s_cselect_b32 s95, 0x40000000, 0
    buffer_load_dwordx4 v[104:107], v251, s[8:11], s95 offen offset:0 sc1
    buffer_load_dwordx4 v[108:111], v252, s[8:11], s95 offen offset:0 sc1
    buffer_load_dwordx4 v[112:115], v253, s[8:11], s95 offen offset:0 sc1
    buffer_load_dwordx4 v[116:119], v251, s[8:11], s95 offen offset:1024 sc1
    buffer_load_dwordx4 v[120:123], v252, s[8:11], s95 offen offset:1024 sc1
    buffer_load_dwordx4 v[124:127], v253, s[8:11], s95 offen offset:1024 sc1
    buffer_load_dwordx4 v[128:131], v251, s[8:11], s95 offen offset:2048 sc1
    buffer_load_dwordx4 v[132:135], v252, s[8:11], s95 offen offset:2048 sc1
    buffer_load_dwordx4 v[136:139], v253, s[8:11], s95 offen offset:2048 sc1
    buffer_load_dwordx4 v[140:143], v251, s[8:11], s95 offen offset:3072 sc1
    buffer_load_dwordx4 v[144:147], v252, s[8:11], s95 offen offset:3072 sc1
    buffer_load_dwordx4 v[148:151], v253, s[8:11], s95 offen offset:3072 sc1
    v_pk_mul_f32 v[0:1], v[0:1], v[204:205] op_sel_hi:[1,0]
    v_pk_mul_f32 v[2:3], v[2:3], v[204:205] op_sel_hi:[1,0]
    v_pk_mul_f32 v[12:13], v[12:13], v[204:205] op_sel_hi:[1,0]
    v_pk_mul_f32 v[14:15], v[14:15], v[204:205] op_sel_hi:[1,0]
    v_cvt_pk_bf16_f32 v0, v0, v1
    v_accvgpr_write_b32 a144, v0
    v_cvt_pk_bf16_f32 v2, v2, v3
    v_accvgpr_write_b32 a145, v2
    v_cvt_pk_bf16_f32 v12, v12, v13
    v_accvgpr_write_b32 a146, v12
    v_cvt_pk_bf16_f32 v14, v14, v15
    v_accvgpr_write_b32 a147, v14
    v_pk_mul_f32 v[4:5], v[4:5], v[204:205] op_sel:[0,1] op_sel_hi:[1,1]
    v_pk_mul_f32 v[6:7], v[6:7], v[204:205] op_sel:[0,1] op_sel_hi:[1,1]
    v_pk_mul_f32 v[16:17], v[16:17], v[204:205] op_sel:[0,1] op_sel_hi:[1,1]
    v_pk_mul_f32 v[18:19], v[18:19], v[204:205] op_sel:[0,1] op_sel_hi:[1,1]
    v_cvt_pk_bf16_f32 v4, v4, v5
    v_accvgpr_write_b32 a148, v4
    v_cvt_pk_bf16_f32 v6, v6, v7
    v_accvgpr_write_b32 a149, v6
    v_cvt_pk_bf16_f32 v16, v16, v17
    v_accvgpr_write_b32 a150, v16
    v_cvt_pk_bf16_f32 v18, v18, v19
    v_accvgpr_write_b32 a151, v18
    v_pk_mul_f32 v[8:9], v[8:9], v[206:207] op_sel_hi:[1,0]
    v_pk_mul_f32 v[10:11], v[10:11], v[206:207] op_sel_hi:[1,0]
    v_pk_mul_f32 v[20:21], v[20:21], v[206:207] op_sel_hi:[1,0]
    v_pk_mul_f32 v[22:23], v[22:23], v[206:207] op_sel_hi:[1,0]
    v_cvt_pk_bf16_f32 v8, v8, v9
    v_accvgpr_write_b32 a152, v8
    v_cvt_pk_bf16_f32 v10, v10, v11
    v_accvgpr_write_b32 a153, v10
    v_cvt_pk_bf16_f32 v20, v20, v21
    v_accvgpr_write_b32 a154, v20
    v_cvt_pk_bf16_f32 v22, v22, v23
    v_accvgpr_write_b32 a155, v22
    v_mul_f32 v96, v207, v96
    v_mul_f32 v97, v207, v97
    v_mul_f32 v98, v207, v98
    v_mul_f32 v99, v207, v99
    v_mul_f32 v100, v207, v100
    v_mul_f32 v101, v207, v101
    v_mul_f32 v102, v207, v102
    v_mul_f32 v103, v207, v103
    v_cvt_pk_bf16_f32 v208, v96, v97
    v_cvt_pk_bf16_f32 v209, v98, v99
    v_cvt_pk_bf16_f32 v210, v100, v101
    v_cvt_pk_bf16_f32 v211, v102, v103
    v_pk_mul_f32 v[24:25], v[24:25], v[204:205] op_sel_hi:[1,0]
    v_pk_mul_f32 v[26:27], v[26:27], v[204:205] op_sel_hi:[1,0]
    v_pk_mul_f32 v[36:37], v[36:37], v[204:205] op_sel_hi:[1,0]
    v_pk_mul_f32 v[38:39], v[38:39], v[204:205] op_sel_hi:[1,0]
    v_cvt_pk_bf16_f32 v24, v24, v25
    v_accvgpr_write_b32 a156, v24
    v_cvt_pk_bf16_f32 v26, v26, v27
    v_accvgpr_write_b32 a157, v26
    v_cvt_pk_bf16_f32 v36, v36, v37
    v_accvgpr_write_b32 a158, v36
    v_cvt_pk_bf16_f32 v38, v38, v39
    v_accvgpr_write_b32 a159, v38
    v_pk_mul_f32 v[28:29], v[28:29], v[204:205] op_sel:[0,1] op_sel_hi:[1,1]
    v_pk_mul_f32 v[30:31], v[30:31], v[204:205] op_sel:[0,1] op_sel_hi:[1,1]
    v_pk_mul_f32 v[40:41], v[40:41], v[204:205] op_sel:[0,1] op_sel_hi:[1,1]
    v_pk_mul_f32 v[42:43], v[42:43], v[204:205] op_sel:[0,1] op_sel_hi:[1,1]
    v_cvt_pk_bf16_f32 v28, v28, v29
    v_accvgpr_write_b32 a160, v28
    v_cvt_pk_bf16_f32 v30, v30, v31
    v_accvgpr_write_b32 a161, v30
    v_cvt_pk_bf16_f32 v40, v40, v41
    v_accvgpr_write_b32 a162, v40
    v_cvt_pk_bf16_f32 v42, v42, v43
    v_accvgpr_write_b32 a163, v42
    v_pk_mul_f32 v[32:33], v[32:33], v[206:207] op_sel_hi:[1,0]
    v_pk_mul_f32 v[34:35], v[34:35], v[206:207] op_sel_hi:[1,0]
    v_pk_mul_f32 v[44:45], v[44:45], v[206:207] op_sel_hi:[1,0]
    v_pk_mul_f32 v[46:47], v[46:47], v[206:207] op_sel_hi:[1,0]
    v_cvt_pk_bf16_f32 v32, v32, v33
    v_accvgpr_write_b32 a164, v32
    v_cvt_pk_bf16_f32 v34, v34, v35
    v_accvgpr_write_b32 a165, v34
    v_cvt_pk_bf16_f32 v44, v44, v45
    v_accvgpr_write_b32 a166, v44
    v_cvt_pk_bf16_f32 v46, v46, v47
    v_accvgpr_write_b32 a167, v46
    v_xor_b32 v236, v254, v236
    v_xor_b32 v237, v255, v237
    v_xor_b32 v238, v254, v238
    v_xor_b32 v239, v255, v239
    v_xor_b32 v240, v254, v240
    v_xor_b32 v241, v255, v241
    v_xor_b32 v242, v254, v242
    v_xor_b32 v243, v255, v243
    s_cmp_eq_u32 s37, 1
    s_cselect_b32 s46, 4096, 0
    s_add_u32 s55, s46, 24576
    s_cmp_eq_u32 s37, 2
    s_cselect_b32 s55, 0, s55
    s_mov_b32 s89, 0x1000
    s_add_u32 s37, s37, 1
    s_add_u32 s40, s40, 0x20000
    s_add_u32 s58, s58, 256
    s_branch L_head_end
L_spin0:
    s_mov_b32 s80, 1048576
L_spin0_loop:
    buffer_load_dword v244, v245, s[0:3], s57 offen sc1
    s_waitcnt vmcnt(0)
    v_cmp_le_u32 vcc, s79, v244
    s_nop 4
    s_cmp_eq_u64 vcc, -1
    s_cbranch_scc1 L_spin0_ret
    s_sub_u32 s80, s80, 1
    s_cmp_lg_u32 s80, 0
    s_cbranch_scc1 L_spin0_loop
    s_branch L_spin0_ret
L_spin1:
    s_mov_b32 s80, 1048576
L_spin1_loop:
    buffer_load_dword v244, v245, s[0:3], s57 offen sc1
    s_waitcnt vmcnt(0)
    v_cmp_le_u32 vcc, s79, v244
    s_nop 4
    s_cmp_eq_u64 vcc, -1
    s_cbranch_scc1 L_spin1_ret
    s_sub_u32 s80, s80, 1
    s_cmp_lg_u32 s80, 0
    s_cbranch_scc1 L_spin1_loop
    s_branch L_spin1_ret
L_spin2:
    s_mov_b32 s80, 1048576
L_spin2_loop:
    buffer_load_dword v244, v245, s[0:3], s57 offen sc1
    s_waitcnt vmcnt(0)
    v_cmp_le_u32 vcc, s79, v244
    s_nop 4
    s_cmp_eq_u64 vcc, -1
    s_cbranch_scc1 L_spin2_ret
    s_sub_u32 s80, s80, 1
    s_cmp_lg_u32 s80, 0
    s_cbranch_scc1 L_spin2_loop
    s_branch L_spin2_ret
L_ispin:
    s_mov_b32 s80, 1048576
L_ispin_loop:
    buffer_load_dwordx2 v[208:209], v210, s[4:7], 0 offen sc1
    s_waitcnt vmcnt(0)
    v_and_b32 v208, v208, v209
    v_cmp_ne_u32 vcc, 0x01010101, v208
    s_nop 4
    s_cbranch_vccz L_ispin_ret
    s_sub_u32 s80, s80, 1
    s_cmp_lg_u32 s80, 0
    s_cbranch_scc1 L_ispin_loop
    s_branch L_ispin_ret
L_code_end:
    s_endpgm
.section .rodata,"a"
.p2align 6
.amdhsa_kernel standalone__mha_block_cached__near_ridge_kernel
  .amdhsa_next_free_vgpr 512
  .amdhsa_next_free_sgpr 102
  .amdhsa_accum_offset 256
  .amdhsa_group_segment_fixed_size 0
  .amdhsa_kernarg_size 64
  .amdhsa_user_sgpr_count 2
  .amdhsa_user_sgpr_kernarg_segment_ptr 1
  .amdhsa_system_sgpr_workgroup_id_x 1
.end_amdhsa_kernel
```
